```python
import torch

def _softmax(x, axis=-1):
    return torch.softmax(x, dim=axis)
def _gelu(x):
    return torch.nn.functional.gelu(x, approximate="tanh")
def _silu(x):
    return torch.nn.functional.silu(x)
def _sigmoid(x):
    return torch.sigmoid(x)
def _layernorm(x, axis=-1, eps=1e-5):
    m = x.mean(dim=axis, keepdim=True)
    v = x.var(dim=axis, keepdim=True, unbiased=False)
    return (x - m) / torch.sqrt(v + eps)
def _scatter_add(tgt, idx, src, axis=0):
    return tgt.clone().index_add_(axis, idx, src)
def _segment_sum(src, seg, n):
    out = torch.zeros((n,) + src.shape[1:], dtype=src.dtype)
    return out.index_add_(0, seg, src)
def _pad(x, pw):
    flat = tuple(v for pair in reversed(pw) for v in pair)
    return torch.nn.functional.pad(x, flat)

kernel_name = 'sequential_preLN__linear_attn_block__glu_gated_reglu__prompt'

def setup_inputs():

    _w = (lambda a: (lambda t: t.to(torch.bfloat16) if t.is_floating_point() else t)(torch.as_tensor(a)))
    def _A_setup():
        B, S, D = 1, 2048, 640
        return {
            "x": _w((lambda *s: torch.randn(*s, dtype=torch.bfloat16) * 0.05)(B, S, D)),
            "wqkv": _w((lambda *s: torch.randn(*s, dtype=torch.bfloat16) * 0.05)(D, 3 * D)),
            "wo": _w((lambda *s: torch.randn(*s, dtype=torch.bfloat16) * 0.05)(D, D)),
        }
    _A_in = _A_setup()

    def _B_setup():
        B, S, D, F = 1, 2048, 640, 1728
        return {
            "x": _w((lambda *s: torch.randn(*s, dtype=torch.bfloat16) * 0.05)(B, S, D)),
            "W_gate": _w((lambda *s: torch.randn(*s, dtype=torch.bfloat16) * 0.2)(D, F) * (2.0 / D) ** 0.5),
            "W_up": _w((lambda *s: torch.randn(*s, dtype=torch.bfloat16) * 0.2)(D, F) * (2.0 / D) ** 0.5),
            "W_down": _w((lambda *s: torch.randn(*s, dtype=torch.bfloat16) * 0.2)(F, D) * (1.0 / F) ** 0.5),
        }
    _B_in = _B_setup()

    return {
        "A_x": _A_in["x"],
        "A_wqkv": _A_in["wqkv"],
        "A_wo": _A_in["wo"],
        "B_x": _B_in["x"],
        "B_W_gate": _B_in["W_gate"],
        "B_W_up": _B_in["W_up"],
        "B_W_down": _B_in["W_down"],
    }

def reference(A_x, A_wqkv, A_wo, B_x, B_W_gate, B_W_up, B_W_down):
    def _A_ref(x, wqkv, wo):
        B, S, D = x.shape
        H = 32; Dh = D // H
        qkv = (lambda x, *d: x.permute(*d))((x @ wqkv).reshape(B, S, 3, H, Dh), 2, 0, 3, 1, 4)
        q, k, v = qkv[0], qkv[1], qkv[2]
        phi = lambda t: torch.where(t > 0, t + 1, torch.exp(t)) + 1e-6
        pq, pk = phi(q), phi(k)
        kv = torch.einsum("bhsd,bhse->bhde", pk, v)
        z = torch.einsum("bhsd->bhd", pk)
        num = torch.einsum("bhqd,bhde->bhqe", pq, kv)
        den = torch.einsum("bhqd,bhd->bhq", pq, z)[..., None] + 1e-6
        o = num / den
        return (lambda x, *d: x.permute(*d))(o, 0, 2, 1, 3).reshape(B, S, D) @ wo

    def _B_ref(x, W_gate, W_up, W_down):
        gate = torch.einsum("bsd,df->bsf", x, W_gate)
        up = torch.einsum("bsd,df->bsf", x, W_up)
        gate = gate * (lambda x, dt: x.to(dt))(gate > 0, gate.dtype)
        h = gate * up
        return torch.einsum("bsf,fd->bsd", h, W_down)

    x = A_x
    h = x + _A_ref(_layernorm(x, axis=-1), A_wqkv, A_wo)
    h2 = h + _B_ref(_layernorm(h, axis=-1), B_W_gate, B_W_up, B_W_down)
    return h2
```

```asm
; @launch grid=(256,1,1) block=(256,1,1) lds=163840
.amdgcn_target "amdgcn-amd-amdhsa--gfx950"
.text
.globl sequential_preLN__linear_attn_block__glu_gated_reglu__prompt_kernel
.p2align 8
.type sequential_preLN__linear_attn_block__glu_gated_reglu__prompt_kernel,@function
sequential_preLN__linear_attn_block__glu_gated_reglu__prompt_kernel:
    s_cmp_ge_u32 s2, 256
    s_cbranch_scc1 L_end
    s_load_dwordx2 s[4:5], s[0:1], 0
    s_load_dwordx2 s[8:9], s[0:1], 8
    s_load_dwordx2 s[12:13], s[0:1], 16
    s_load_dwordx2 s[16:17], s[0:1], 32
    s_load_dwordx2 s[20:21], s[0:1], 40
    s_load_dwordx2 s[24:25], s[0:1], 48
    s_load_dwordx2 s[28:29], s[0:1], 56
    s_load_dwordx2 s[36:37], s[0:1], 64
    s_load_dwordx2 s[32:33], s[0:1], 72
    v_and_b32 v1, 63, v0
    v_lshrrev_b32 v4, 6, v0
    s_lshr_b32 s49, s2, 3
    s_getpc_b64 s[50:51]
    v_lshlrev_b32 v5, 2, v4
    v_add_u32 v5, v5, v1
    s_lshl_b32 s52, s49, 4
    v_add_u32 v5, s52, v5
    v_lshlrev_b32 v5, 7, v5
    s_mov_b32 s54, L_end-sequential_preLN__linear_attn_block__glu_gated_reglu__prompt_kernel-256
    v_cmp_gt_u32 vcc, 4, v1
    v_cmp_gt_u32 s[52:53], s54, v5
    s_and_b64 vcc, vcc, s[52:53]
    s_and_saveexec_b64 s[64:65], vcc
    s_cbranch_execz L_nocode_1
    global_load_dword v44, v5, s[50:51]
L_nocode_1:
    s_mov_b64 exec, s[64:65]
    v_readfirstlane_b32 s40, v4
    v_and_b32 v2, 31, v0
    v_bfe_u32 v3, v0, 5, 1
    s_and_b32 s48, s2, 7
    s_lshr_b32 s50, s48, 1
    s_lshl_b32 s50, s50, 2
    s_and_b32 s51, s49, 3
    s_or_b32 s41, s50, s51
    s_and_b32 s50, s48, 1
    s_lshl_b32 s50, s50, 3
    s_lshr_b32 s51, s49, 2
    s_or_b32 s42, s50, s51
    s_and_b32 s45, s42, 7
    s_lshl_b32 s46, s40, 12
    s_lshl_b32 s47, s40, 11
    s_mov_b32 s6, 2621440
    s_mov_b32 s7, 0x20000
    s_mov_b32 s10, 2457600
    s_mov_b32 s11, 0x20000
    s_mov_b32 s34, 16777216
    s_mov_b32 s35, 0x20000
    s_mov_b32 s38, 256
    s_mov_b32 s39, 0x20000
    s_mov_b32 s66, 0xf7ff7fff
    s_mov_b32 s67, 0xfff7ff7f
    s_mul_i32 s50, s41, 3
    s_add_u32 s50, s50, s45
    s_lshr_b32 s51, s42, 3
    s_lshl_b32 s51, s51, 1
    s_add_u32 s50, s50, s51
    s_mul_i32 s51, s50, 205
    s_lshr_b32 s51, s51, 11
    s_mul_i32 s51, s51, 10
    s_sub_u32 s50, s50, s51
    s_mov_b32 s101, s50
    s_lshl_b32 s92, s50, 7
    s_mul_i32 s93, s50, 245760
    s_waitcnt lgkmcnt(0)
    v_lshrrev_b32 v4, 3, v1
    s_lshl_b32 s48, s41, 7
    s_lshl_b32 s49, s40, 5
    s_add_u32 s48, s48, s49
    v_add_u32 v4, s48, v4
    v_mul_u32_u24 v4, 1280, v4
    v_and_b32 v5, 7, v1
    v_lshrrev_b32 v6, 4, v1
    v_xor_b32 v5, v5, v6
    v_lshlrev_b32 v5, 4, v5
    v_add_u32 v16, v4, v5
    v_xor_b32 v17, 64, v16
    s_cmp_ge_u32 s2, 16
    s_cbranch_scc1 L_noinit_2
    s_cmp_lg_u32 s40, 0
    s_cbranch_scc1 L_noinit_2
    v_lshlrev_b32 v4, 7, v1
    v_mov_b32 v5, 0
    s_lshl_b32 s3, s2, 13
    buffer_store_dword v5, v4, s[32:35], s3 offen sc1
    s_mov_b32 s3, 131072
    s_mov_b64 exec, 1
    buffer_store_dword v5, v4, s[32:35], s3 offen sc1
    s_mov_b64 exec, -1
L_noinit_2:
    s_add_u32 m0, s46, 0
    s_add_u32 s3, s92, 0
    buffer_load_dwordx4 v16, s[4:7], s3 offen lds
    s_add_u32 m0, s46, 1024
    s_add_u32 s3, s92, 10240
    buffer_load_dwordx4 v17, s[4:7], s3 offen lds
    s_add_u32 m0, s46, 2048
    s_add_u32 s3, s92, 20480
    buffer_load_dwordx4 v16, s[4:7], s3 offen lds
    s_add_u32 m0, s46, 3072
    s_add_u32 s3, s92, 30720
    buffer_load_dwordx4 v17, s[4:7], s3 offen lds
    v_lshrrev_b32 v4, 4, v1
    v_lshlrev_b32 v5, 2, v4
    v_and_b32 v6, 15, v1
    v_xor_b32 v5, v5, v6
    s_lshl_b32 s49, s40, 4
    v_add_u32 v4, s49, v4
    v_mul_u32_u24 v4, 3840, v4
    v_lshlrev_b32 v6, 4, v5
    v_add_u32 v4, v4, v6
    s_mul_i32 s49, s42, 80
    v_add_u32 v4, s49, v4
    v_mov_b32 v6, 1280
    v_mov_b32 v7, 2480
    v_cmp_lt_u32 vcc, 4, v5
    s_and_b32 s49, s42, 1
    s_mul_i32 s49, s49, -160
    s_add_u32 s49, s49, 4294967216
    v_cndmask_b32 v6, v6, v7, vcc
    v_mov_b32 v7, s49
    v_cmp_lt_u32 vcc, 9, v5
    s_nop 1
    v_cndmask_b32 v6, v6, v7, vcc
    v_add_u32 v18, v4, v6
    s_add_u32 m0, s46, 16384
    s_add_u32 s3, s93, 0
    s_mov_b64 exec, s[66:67]
    buffer_load_dwordx4 v18, s[8:11], s3 offen lds
    s_mov_b64 exec, -1
    s_add_u32 m0, s46, 17408
    s_add_u32 s3, s93, 15360
    s_mov_b64 exec, s[66:67]
    buffer_load_dwordx4 v18, s[8:11], s3 offen lds
    s_mov_b64 exec, -1
    s_add_u32 m0, s46, 18432
    s_add_u32 s3, s93, 30720
    s_mov_b64 exec, s[66:67]
    buffer_load_dwordx4 v18, s[8:11], s3 offen lds
    s_mov_b64 exec, -1
    s_add_u32 m0, s46, 19456
    s_add_u32 s3, s93, 46080
    s_mov_b64 exec, s[66:67]
    buffer_load_dwordx4 v18, s[8:11], s3 offen lds
    s_mov_b64 exec, -1
    s_add_u32 s92, s92, 128
    s_add_u32 s93, s93, 245760
    s_cmp_eq_u32 s92, 1280
    s_cselect_b32 s92, 0, s92
    s_cselect_b32 s93, 0, s93
    v_and_b32 v4, 63, v0
    v_and_b32 v5, 3, v4
    v_lshlrev_b32 v5, 2, v5
    v_xor_b32 v5, 15, v5
    v_lshlrev_b32 v5, 4, v5
    v_lshlrev_b32 v4, 8, v4
    v_add_u32 v4, v4, v5
    s_lshl_b32 s49, s40, 15
    s_add_u32 s49, s49, 16384
    v_add_u32 v4, s49, v4
    v_mov_b32 v8, 0x3f80
    v_mov_b32 v9, 0
    v_mov_b32 v10, 0x3f80
    v_mov_b32 v11, 0
    ds_write_b128 v4, v[8:11]
    v_lshrrev_b32 v4, 1, v2
    v_and_b32 v4, 7, v4
    v_xor_b32 v4, v4, v3
    v_lshlrev_b32 v4, 4, v4
    v_lshlrev_b32 v5, 7, v2
    v_add_u32 v4, v4, v5
    v_add_u32 v20, s46, v4
    v_xor_b32 v21, 32, v20
    v_xor_b32 v22, 64, v20
    v_xor_b32 v23, 96, v20
    v_add_u32 v24, 0x10000, v20
    v_add_u32 v25, 0x10000, v21
    v_add_u32 v26, 0x10000, v22
    v_add_u32 v27, 0x10000, v23
    v_lshrrev_b32 v4, 1, v2
    v_and_b32 v4, 7, v4
    v_lshlrev_b32 v4, 4, v4
    v_lshlrev_b32 v5, 7, v2
    v_add_u32 v4, v4, v5
    v_lshlrev_b32 v5, 3, v3
    v_add_u32 v4, v4, v5
    v_add_u32 v19, s46, v4
    v_bfe_u32 v4, v1, 2, 2
    v_lshlrev_b32 v5, 3, v3
    v_add_u32 v5, v5, v4
    v_lshlrev_b32 v5, 8, v5
    v_lshlrev_b32 v4, 6, v4
    v_add_u32 v5, v5, v4
    v_bfe_u32 v4, v1, 4, 1
    v_lshlrev_b32 v4, 5, v4
    v_add_u32 v5, v5, v4
    v_and_b32 v4, 3, v1
    v_lshlrev_b32 v4, 3, v4
    v_add_u32 v5, v5, v4
    v_add_u32 v28, 16384, v5
    v_xor_b32 v29, 64, v28
    v_xor_b32 v30, 128, v28
    v_xor_b32 v31, 192, v28
    v_add_u32 v32, 0x10000, v28
    v_add_u32 v33, 0x10000, v29
    v_add_u32 v34, 0x10000, v30
    v_add_u32 v35, 0x10000, v31
    s_lshl_b32 s49, s40, 6
    v_xor_b32 v36, s49, v28
    v_add_u32 v37, 0x10000, v36
    v_mov_b32 v4, 0x3f803f80
    v_accvgpr_write_b32 a28, v4
    v_accvgpr_write_b32 a29, v4
    v_accvgpr_write_b32 a30, v4
    v_accvgpr_write_b32 a31, v4
    s_lshr_b32 s50, s42, 3
    s_mul_i32 s51, s50, 5
    s_add_u32 s43, s51, s45
    s_mul_i32 s51, s50, 7
    s_add_u32 s44, s51, s45
    s_mov_b32 s14, 819200
    s_mov_b32 s15, 0x20000
    s_mov_b32 s18, 2211840
    s_mov_b32 s19, 0x20000
    s_mov_b32 s22, 2211840
    s_mov_b32 s23, 0x20000
    s_mov_b32 s26, 2211840
    s_mov_b32 s27, 0x20000
    s_mov_b32 s30, 2621440
    s_mov_b32 s31, 0x20000
    s_and_b32 s50, s41, 3
    s_and_b32 s51, s41, 3
    s_add_u32 s51, s51, s45
    s_cmp_ge_u32 s51, 6
    s_cselect_b32 s63, 6, 0
    s_sub_u32 s51, s51, s63
    s_mul_i32 s51, s51, 0
    s_lshl_b32 s63, s40, 1
    s_add_u32 s63, s63, s51
    s_cmp_ge_u32 s63, 48
    s_cselect_b32 s62, 48, 0
    s_sub_u32 s94, s63, s62
    s_and_b32 s50, s41, 3
    s_mul_i32 s51, s45, 0
    s_mul_i32 s52, s50, 0
    s_add_u32 s51, s51, s52
    s_cmp_ge_u32 s51, 20
    s_cselect_b32 s52, 20, 0
    s_sub_u32 s51, s51, s52
    s_mul_i32 s95, s51, 110592
    v_lshrrev_b32 v4, 3, v1
    v_mul_u32_u24 v4, 1280, v4
    v_bfe_u32 v5, v1, 4, 1
    v_lshlrev_b32 v5, 2, v5
    v_and_b32 v6, 7, v1
    v_xor_b32 v5, v5, v6
    v_lshlrev_b32 v5, 4, v5
    v_add_u32 v4, v4, v5
    s_lshl_b32 s48, s43, 7
    v_add_u32 v48, s48, v4
    v_lshrrev_b32 v4, 3, v1
    s_lshl_b32 s48, s40, 4
    v_add_u32 v4, s48, v4
    v_mul_u32_u24 v4, 3456, v4
    v_add_u32 v4, v4, v5
    s_lshl_b32 s48, s44, 8
    v_add_u32 v49, s48, v4
    v_bfe_u32 v4, v1, 2, 2
    v_lshlrev_b32 v5, 2, v3
    v_add_u32 v5, v5, v4
    v_bfe_u32 v6, v1, 4, 1
    v_lshlrev_b32 v6, 5, v6
    v_and_b32 v7, 3, v1
    v_lshlrev_b32 v7, 3, v7
    v_add_u32 v6, v6, v7
    v_lshlrev_b32 v7, 7, v5
    v_add_u32 v7, v7, v6
    v_lshrrev_b32 v8, 1, v4
    v_lshlrev_b32 v8, 6, v8
    v_add_u32 v50, v7, v8
    v_xor_b32 v51, 64, v50
    v_add_u32 v52, 0x10000, v50
    v_add_u32 v53, 0x10000, v51
    s_xor_b32 s68, s42, 1
    s_mov_b32 s69, 0x358637bd
    s_mov_b32 s70, 0x3acccccd
    s_mov_b32 s71, 0x3727c5ac
    s_lshl_b32 s48, s40, 7
    v_lshlrev_b32 v4, 4, v3
    v_add_u32 v225, 151552, v4
    v_add_u32 v224, s48, v225
    s_lshl_b32 s48, s40, 5
    v_add_u32 v4, s48, v2
    v_mul_u32_u24 v4, 160, v4
    v_lshlrev_b32 v5, 3, v3
    v_add_u32 v4, v4, v5
    v_add_u32 v226, 131072, v4
    v_lshrrev_b32 v5, 4, v1
    v_lshlrev_b32 v5, 2, v5
    v_bfe_u32 v6, v1, 2, 2
    v_add_u32 v5, v5, v6
    v_mul_u32_u24 v5, 160, v5
    v_and_b32 v6, 3, v1
    v_lshlrev_b32 v6, 3, v6
    v_add_u32 v5, v5, v6
    v_add_u32 v8, 131072, v5
    s_add_u32 s48, s40, 1
    s_lshr_b32 s48, s48, 1
    s_lshr_b32 s49, s40, 1
    s_lshl_b32 s49, s49, 1
    s_min_u32 s50, s40, 2
    s_cmp_eq_u32 s40, 3
    s_cselect_b32 s51, 2, 1
    s_lshl_b32 s53, s48, 5
    s_add_u32 s53, s53, 0
    v_add_u32 v227, s53, v8
    s_lshl_b32 s53, s49, 5
    s_add_u32 s53, s53, 80
    v_add_u32 v228, s53, v8
    s_lshl_b32 s53, s50, 5
    s_add_u32 s53, s53, 0
    v_add_u32 v229, s53, v8
    s_lshl_b32 s53, s51, 5
    s_add_u32 s53, s53, 80
    v_add_u32 v230, s53, v8
    v_and_b32 v5, 15, v1
    v_lshrrev_b32 v6, 4, v1
    v_lshlrev_b32 v6, 2, v6
    s_lshl_b32 s53, s49, 4
    v_add_u32 v7, s53, v5
    s_lshl_b32 s53, s48, 4
    v_add_u32 v11, s53, v6
    v_mul_u32_u24 v12, 20, v7
    v_add_u32 v12, v12, v11
    v_lshlrev_b32 v231, 2, v12
    v_cmp_gt_u32 s[56:57], 40, v7
    v_cmp_gt_u32 s[58:59], 40, v11
    s_and_b64 s[56:57], s[56:57], s[58:59]
    v_cmp_gt_u32 s[58:59], 20, v7
    v_cmp_gt_u32 s[60:61], 20, v11
    s_xnor_b64 s[58:59], s[58:59], s[60:61]
    s_and_b64 s[56:57], s[56:57], s[58:59]
    v_add_u32 v231, 159232, v231
    v_mov_b32 v12, 162688
    s_nop 0
    v_cndmask_b32 v231, v12, v231, s[56:57]
    s_lshl_b32 s53, s51, 4
    v_add_u32 v7, s53, v5
    s_lshl_b32 s53, s50, 4
    v_add_u32 v11, s53, v6
    v_mul_u32_u24 v12, 20, v7
    v_add_u32 v12, v12, v11
    v_lshlrev_b32 v232, 2, v12
    v_cmp_gt_u32 s[56:57], 40, v7
    v_cmp_gt_u32 s[58:59], 40, v11
    s_and_b64 s[56:57], s[56:57], s[58:59]
    v_cmp_gt_u32 s[58:59], 20, v7
    v_cmp_gt_u32 s[60:61], 20, v11
    s_xnor_b64 s[58:59], s[58:59], s[60:61]
    s_and_b64 s[56:57], s[56:57], s[58:59]
    s_cmp_eq_u32 s40, 3
    s_cselect_b64 s[56:57], 0, s[56:57]
    v_add_u32 v232, 159232, v232
    v_mov_b32 v12, 162688
    s_nop 0
    v_cndmask_b32 v232, v12, v232, s[56:57]
    s_lshl_b32 s53, s50, 4
    v_add_u32 v11, s53, v6
    v_cmp_lt_u32 vcc, 19, v11
    v_mov_b32 v12, 400
    v_mov_b32 v7, 800
    v_cndmask_b32 v12, v12, v7, vcc
    v_add_u32 v12, v12, v11
    v_lshlrev_b32 v233, 2, v12
    v_cmp_gt_u32 s[56:57], 40, v11
    v_cmp_eq_u32 s[58:59], 0, v5
    s_and_b64 s[56:57], s[56:57], s[58:59]
    s_cmp_eq_u32 s40, 3
    s_cselect_b64 s[56:57], 0, s[56:57]
    v_add_u32 v233, 159232, v233
    v_mov_b32 v12, 162688
    s_nop 0
    v_cndmask_b32 v233, v12, v233, s[56:57]
    v_mov_b32 v12, 0
    v_mov_b32 v13, 0
    v_mov_b32 v14, 0
    v_mov_b32 v15, 0
    v_lshlrev_b32 v4, 4, v0
    v_add_u32 v4, 152064, v4
    ds_write_b128 v4, v[12:15]
    v_cmp_gt_u32 vcc, 192, v0
    s_and_saveexec_b64 s[64:65], vcc
    s_cbranch_execz L_ktz_3
    ds_write_b128 v4, v[12:15] offset:4096
L_ktz_3:
    s_mov_b64 exec, s[64:65]
    v_cmp_lt_u32 vcc, 104, v0
    v_mov_b32 v5, 0
    v_mov_b32 v6, 1
    v_cndmask_b32 v5, v5, v6, vcc
    v_mul_u32_u24 v6, 105, v5
    v_sub_u32 v6, v0, v6
    v_mul_u32_u24 v7, 205, v6
    v_lshrrev_b32 v7, 10, v7
    v_mul_u32_u24 v11, 5, v7
    v_sub_u32 v11, v6, v11
    v_lshlrev_b32 v11, 2, v11
    v_mul_u32_u24 v12, 20, v5
    v_add_u32 v11, v11, v12
    v_lshrrev_b32 v13, 4, v11
    v_lshlrev_b32 v13, 5, v13
    v_bfe_u32 v14, v11, 2, 1
    v_lshlrev_b32 v14, 4, v14
    v_add_u32 v13, v13, v14
    v_bfe_u32 v14, v11, 3, 1
    v_lshlrev_b32 v14, 3, v14
    v_add_u32 v13, v13, v14
    v_add_u32 v12, v12, v7
    v_add_u32 v14, 40, v5
    v_add_u32 v15, 44, v5
    v_cmp_eq_u32 vcc, 20, v7
    v_mov_b32 v6, 63
    s_nop 0
    v_cndmask_b32 v12, v12, v14, vcc
    v_cndmask_b32 v15, v6, v15, vcc
    v_cmp_lt_u32 vcc, 209, v0
    v_mov_b32 v14, 0
    s_nop 0
    v_cndmask_b32 v12, v12, v6, vcc
    v_cndmask_b32 v15, v15, v6, vcc
    v_cndmask_b32 v13, v13, v14, vcc
    v_mul_u32_u24 v12, 112, v12
    v_mul_u32_u24 v15, 112, v15
    v_add_u32 v12, v12, v13
    v_add_u32 v15, v15, v13
    v_add_u32 v38, 152064, v12
    v_add_u32 v39, 152064, v15
    v_lshlrev_b32 v4, 4, v0
    v_mov_b32 v6, 2147483648
    v_cndmask_b32 v41, v4, v6, vcc
    v_mul_u32_u24 v4, 112, v2
    v_lshlrev_b32 v5, 4, v3
    v_add_u32 v4, v4, v5
    v_add_u32 v40, 152064, v4
    s_add_u32 m0, s46, 32768
    s_add_u32 s3, s92, 0
    buffer_load_dwordx4 v16, s[4:7], s3 offen lds
    s_add_u32 m0, s46, 33792
    s_add_u32 s3, s92, 10240
    buffer_load_dwordx4 v17, s[4:7], s3 offen lds
    s_add_u32 m0, s46, 34816
    s_add_u32 s3, s92, 20480
    buffer_load_dwordx4 v16, s[4:7], s3 offen lds
    s_add_u32 m0, s46, 35840
    s_add_u32 s3, s92, 30720
    buffer_load_dwordx4 v17, s[4:7], s3 offen lds
    s_add_u32 m0, s46, 49152
    s_add_u32 s3, s93, 0
    s_mov_b64 exec, s[66:67]
    buffer_load_dwordx4 v18, s[8:11], s3 offen lds
    s_mov_b64 exec, -1
    s_add_u32 m0, s46, 50176
    s_add_u32 s3, s93, 15360
    s_mov_b64 exec, s[66:67]
    buffer_load_dwordx4 v18, s[8:11], s3 offen lds
    s_mov_b64 exec, -1
    s_add_u32 m0, s46, 51200
    s_add_u32 s3, s93, 30720
    s_mov_b64 exec, s[66:67]
    buffer_load_dwordx4 v18, s[8:11], s3 offen lds
    s_mov_b64 exec, -1
    s_add_u32 m0, s46, 52224
    s_add_u32 s3, s93, 46080
    s_mov_b64 exec, s[66:67]
    buffer_load_dwordx4 v18, s[8:11], s3 offen lds
    s_mov_b64 exec, -1
    s_add_u32 s92, s92, 128
    s_add_u32 s93, s93, 245760
    s_cmp_eq_u32 s92, 1280
    s_cselect_b32 s92, 0, s92
    s_cselect_b32 s93, 0, s93
    s_waitcnt vmcnt(8)
    s_cmp_ge_u32 s2, 16
    s_cbranch_scc1 L_noinit_4
    s_cmp_lg_u32 s40, 0
    s_cbranch_scc1 L_noinit_4
    v_mov_b32 v5, 1
    s_lshl_b32 s3, s2, 2
    v_mov_b32 v4, s3
    s_mov_b64 exec, 1
    buffer_store_dword v5, v4, s[36:39], 0 offen sc1
    s_mov_b64 exec, -1
L_noinit_4:
    s_waitcnt lgkmcnt(0)
    s_barrier
    ds_read_b128 a[20:23], v20 offset:0
    ds_read_b64_tr_b16 a[0:1], v28 offset:0
    ds_read_b64_tr_b16 a[2:3], v28 offset:1024
    ds_read_b64_tr_b16 a[4:5], v29 offset:0
    ds_read_b64_tr_b16 a[6:7], v29 offset:1024
    ds_read_b64_tr_b16 a[8:9], v30 offset:0
    ds_read_b64_tr_b16 a[10:11], v30 offset:1024
    ds_read_b64_tr_b16 a[12:13], v31 offset:0
    ds_read_b64_tr_b16 a[14:15], v31 offset:1024
    ds_read_b64_tr_b16 a[16:17], v36 offset:0
    ds_read_b64_tr_b16 a[18:19], v36 offset:1024
    ds_read_b128 a[24:27], v21 offset:0
    s_waitcnt lgkmcnt(9)
    v_mfma_f32_32x32x16_bf16 v[64:79], a[0:3], a[20:23], 0
    ds_read_b64_tr_b16 a[0:1], v28 offset:4096
    ds_read_b64_tr_b16 a[2:3], v28 offset:5120
    s_add_u32 m0, s46, 65536
    s_add_u32 s3, s92, 0
    buffer_load_dwordx4 v16, s[4:7], s3 offen lds
    s_waitcnt lgkmcnt(9)
    v_mfma_f32_32x32x16_bf16 v[80:95], a[4:7], a[20:23], 0
    ds_read_b64_tr_b16 a[4:5], v29 offset:4096
    ds_read_b64_tr_b16 a[6:7], v29 offset:5120
    s_add_u32 m0, s46, 66560
    s_add_u32 s3, s92, 10240
    buffer_load_dwordx4 v17, s[4:7], s3 offen lds
    s_waitcnt lgkmcnt(9)
    v_mfma_f32_32x32x16_bf16 v[96:111], a[8:11], a[20:23], 0
    ds_read_b64_tr_b16 a[8:9], v30 offset:4096
    ds_read_b64_tr_b16 a[10:11], v30 offset:5120
    s_add_u32 m0, s46, 67584
    s_add_u32 s3, s92, 20480
    buffer_load_dwordx4 v16, s[4:7], s3 offen lds
    s_waitcnt lgkmcnt(9)
    v_mfma_f32_32x32x16_bf16 v[112:127], a[12:15], a[20:23], 0
    ds_read_b64_tr_b16 a[12:13], v31 offset:4096
    ds_read_b64_tr_b16 a[14:15], v31 offset:5120
    s_waitcnt lgkmcnt(9)
    v_mfma_f32_32x32x16_bf16 v[128:143], a[16:19], a[28:31], 0
    ds_read_b64_tr_b16 a[16:17], v36 offset:4096
    ds_read_b64_tr_b16 a[18:19], v36 offset:5120
    v_mfma_f32_32x32x16_bf16 v[144:159], a[20:23], a[20:23], 0
    ds_read_b128 a[20:23], v22 offset:0
    s_waitcnt lgkmcnt(9)
    v_mfma_f32_32x32x16_bf16 v[64:79], a[0:3], a[24:27], v[64:79]
    ds_read_b64_tr_b16 a[0:1], v28 offset:8192
    ds_read_b64_tr_b16 a[2:3], v28 offset:9216
    s_add_u32 m0, s46, 68608
    s_add_u32 s3, s92, 30720
    buffer_load_dwordx4 v17, s[4:7], s3 offen lds
    s_waitcnt lgkmcnt(9)
    v_mfma_f32_32x32x16_bf16 v[80:95], a[4:7], a[24:27], v[80:95]
    ds_read_b64_tr_b16 a[4:5], v29 offset:8192
    ds_read_b64_tr_b16 a[6:7], v29 offset:9216
    s_add_u32 m0, s46, 81920
    s_add_u32 s3, s93, 0
    s_mov_b64 exec, s[66:67]
    buffer_load_dwordx4 v18, s[8:11], s3 offen lds
    s_mov_b64 exec, -1
    s_waitcnt lgkmcnt(9)
    v_mfma_f32_32x32x16_bf16 v[96:111], a[8:11], a[24:27], v[96:111]
    ds_read_b64_tr_b16 a[8:9], v30 offset:8192
    ds_read_b64_tr_b16 a[10:11], v30 offset:9216
    s_add_u32 m0, s46, 82944
    s_add_u32 s3, s93, 15360
    s_mov_b64 exec, s[66:67]
    buffer_load_dwordx4 v18, s[8:11], s3 offen lds
    s_mov_b64 exec, -1
    s_waitcnt lgkmcnt(9)
    v_mfma_f32_32x32x16_bf16 v[112:127], a[12:15], a[24:27], v[112:127]
    ds_read_b64_tr_b16 a[12:13], v31 offset:8192
    ds_read_b64_tr_b16 a[14:15], v31 offset:9216
    s_add_u32 s3, s101, 0
    s_cmp_ge_u32 s3, 10
    s_cselect_b32 s99, 10, 0
    s_sub_u32 s3, s3, s99
    s_cmp_lg_u32 s3, s43
    s_cbranch_scc1 L_nores_5
    v_xor_b32 v45, 0, v19
    ds_read_b64 a[192:193], v45 offset:0
    v_xor_b32 v45, 16, v19
    ds_read_b64 a[194:195], v45 offset:0
    v_xor_b32 v45, 32, v19
    ds_read_b64 a[196:197], v45 offset:0
    v_xor_b32 v45, 48, v19
    ds_read_b64 a[198:199], v45 offset:0
    v_xor_b32 v45, 64, v19
    ds_read_b64 a[200:201], v45 offset:0
    v_xor_b32 v45, 80, v19
    ds_read_b64 a[202:203], v45 offset:0
    v_xor_b32 v45, 96, v19
    ds_read_b64 a[204:205], v45 offset:0
    v_xor_b32 v45, 112, v19
    ds_read_b64 a[206:207], v45 offset:0
    s_waitcnt lgkmcnt(0)
L_nores_5:
    s_waitcnt lgkmcnt(9)
    v_mfma_f32_32x32x16_bf16 v[128:143], a[16:19], a[28:31], v[128:143]
    ds_read_b64_tr_b16 a[16:17], v36 offset:8192
    ds_read_b64_tr_b16 a[18:19], v36 offset:9216
    v_mfma_f32_32x32x16_bf16 v[144:159], a[24:27], a[24:27], v[144:159]
    ds_read_b128 a[24:27], v23 offset:0
    s_waitcnt lgkmcnt(9)
    v_mfma_f32_32x32x16_bf16 v[64:79], a[0:3], a[20:23], v[64:79]
    ds_read_b64_tr_b16 a[0:1], v28 offset:12288
    ds_read_b64_tr_b16 a[2:3], v28 offset:13312
    s_add_u32 m0, s46, 83968
    s_add_u32 s3, s93, 30720
    s_mov_b64 exec, s[66:67]
    buffer_load_dwordx4 v18, s[8:11], s3 offen lds
    s_mov_b64 exec, -1
    s_waitcnt lgkmcnt(9)
    v_mfma_f32_32x32x16_bf16 v[80:95], a[4:7], a[20:23], v[80:95]
    ds_read_b64_tr_b16 a[4:5], v29 offset:12288
    ds_read_b64_tr_b16 a[6:7], v29 offset:13312
    s_add_u32 m0, s46, 84992
    s_add_u32 s3, s93, 46080
    s_mov_b64 exec, s[66:67]
    buffer_load_dwordx4 v18, s[8:11], s3 offen lds
    s_mov_b64 exec, -1
    s_add_u32 s92, s92, 128
    s_add_u32 s93, s93, 245760
    s_cmp_eq_u32 s92, 1280
    s_cselect_b32 s92, 0, s92
    s_cselect_b32 s93, 0, s93
    s_waitcnt lgkmcnt(9)
    v_mfma_f32_32x32x16_bf16 v[96:111], a[8:11], a[20:23], v[96:111]
    ds_read_b64_tr_b16 a[8:9], v30 offset:12288
    ds_read_b64_tr_b16 a[10:11], v30 offset:13312
    s_waitcnt lgkmcnt(9)
    v_mfma_f32_32x32x16_bf16 v[112:127], a[12:15], a[20:23], v[112:127]
    ds_read_b64_tr_b16 a[12:13], v31 offset:12288
    ds_read_b64_tr_b16 a[14:15], v31 offset:13312
    s_waitcnt lgkmcnt(9)
    v_mfma_f32_32x32x16_bf16 v[128:143], a[16:19], a[28:31], v[128:143]
    ds_read_b64_tr_b16 a[16:17], v36 offset:12288
    ds_read_b64_tr_b16 a[18:19], v36 offset:13312
    v_mfma_f32_32x32x16_bf16 v[144:159], a[20:23], a[20:23], v[144:159]
    s_waitcnt vmcnt(8)
    s_barrier
    ds_read_b128 a[20:23], v20 offset:32768
    s_waitcnt lgkmcnt(9)
    v_mfma_f32_32x32x16_bf16 v[64:79], a[0:3], a[24:27], v[64:79]
    ds_read_b64_tr_b16 a[0:1], v28 offset:32768
    ds_read_b64_tr_b16 a[2:3], v28 offset:33792
    s_add_u32 m0, s46, 98304
    s_add_u32 s3, s92, 0
    buffer_load_dwordx4 v16, s[4:7], s3 offen lds
    s_waitcnt lgkmcnt(9)
    v_mfma_f32_32x32x16_bf16 v[80:95], a[4:7], a[24:27], v[80:95]
    ds_read_b64_tr_b16 a[4:5], v29 offset:32768
    ds_read_b64_tr_b16 a[6:7], v29 offset:33792
    s_waitcnt lgkmcnt(9)
    v_mfma_f32_32x32x16_bf16 v[96:111], a[8:11], a[24:27], v[96:111]
    ds_read_b64_tr_b16 a[8:9], v30 offset:32768
    ds_read_b64_tr_b16 a[10:11], v30 offset:33792
    s_add_u32 m0, s46, 99328
    s_add_u32 s3, s92, 10240
    buffer_load_dwordx4 v17, s[4:7], s3 offen lds
    s_waitcnt lgkmcnt(9)
    v_mfma_f32_32x32x16_bf16 v[112:127], a[12:15], a[24:27], v[112:127]
    ds_read_b64_tr_b16 a[12:13], v31 offset:32768
    ds_read_b64_tr_b16 a[14:15], v31 offset:33792
    s_waitcnt lgkmcnt(9)
    v_mfma_f32_32x32x16_bf16 v[128:143], a[16:19], a[28:31], v[128:143]
    ds_read_b64_tr_b16 a[16:17], v36 offset:32768
    ds_read_b64_tr_b16 a[18:19], v36 offset:33792
    v_mfma_f32_32x32x16_bf16 v[144:159], a[24:27], a[24:27], v[144:159]
    ds_read_b128 a[24:27], v21 offset:32768
    s_waitcnt lgkmcnt(9)
    v_mfma_f32_32x32x16_bf16 v[64:79], a[0:3], a[20:23], v[64:79]
    ds_read_b64_tr_b16 a[0:1], v28 offset:36864
    ds_read_b64_tr_b16 a[2:3], v28 offset:37888
    s_add_u32 m0, s46, 100352
    s_add_u32 s3, s92, 20480
    buffer_load_dwordx4 v16, s[4:7], s3 offen lds
    s_waitcnt lgkmcnt(9)
    v_mfma_f32_32x32x16_bf16 v[80:95], a[4:7], a[20:23], v[80:95]
    ds_read_b64_tr_b16 a[4:5], v29 offset:36864
    ds_read_b64_tr_b16 a[6:7], v29 offset:37888
    s_waitcnt lgkmcnt(9)
    v_mfma_f32_32x32x16_bf16 v[96:111], a[8:11], a[20:23], v[96:111]
    ds_read_b64_tr_b16 a[8:9], v30 offset:36864
    ds_read_b64_tr_b16 a[10:11], v30 offset:37888
    s_add_u32 m0, s46, 101376
    s_add_u32 s3, s92, 30720
    buffer_load_dwordx4 v17, s[4:7], s3 offen lds
    s_waitcnt lgkmcnt(9)
    v_mfma_f32_32x32x16_bf16 v[112:127], a[12:15], a[20:23], v[112:127]
    ds_read_b64_tr_b16 a[12:13], v31 offset:36864
    ds_read_b64_tr_b16 a[14:15], v31 offset:37888
    s_waitcnt lgkmcnt(9)
    v_mfma_f32_32x32x16_bf16 v[128:143], a[16:19], a[28:31], v[128:143]
    ds_read_b64_tr_b16 a[16:17], v36 offset:36864
    ds_read_b64_tr_b16 a[18:19], v36 offset:37888
    v_mfma_f32_32x32x16_bf16 v[144:159], a[20:23], a[20:23], v[144:159]
    ds_read_b128 a[20:23], v22 offset:32768
    s_waitcnt lgkmcnt(9)
    v_mfma_f32_32x32x16_bf16 v[64:79], a[0:3], a[24:27], v[64:79]
    ds_read_b64_tr_b16 a[0:1], v28 offset:40960
    ds_read_b64_tr_b16 a[2:3], v28 offset:41984
    s_add_u32 m0, s46, 114688
    s_add_u32 s3, s93, 0
    s_mov_b64 exec, s[66:67]
    buffer_load_dwordx4 v18, s[8:11], s3 offen lds
    s_mov_b64 exec, -1
    s_waitcnt lgkmcnt(9)
    v_mfma_f32_32x32x16_bf16 v[80:95], a[4:7], a[24:27], v[80:95]
    ds_read_b64_tr_b16 a[4:5], v29 offset:40960
    ds_read_b64_tr_b16 a[6:7], v29 offset:41984
    s_waitcnt lgkmcnt(9)
    v_mfma_f32_32x32x16_bf16 v[96:111], a[8:11], a[24:27], v[96:111]
    ds_read_b64_tr_b16 a[8:9], v30 offset:40960
    ds_read_b64_tr_b16 a[10:11], v30 offset:41984
    s_add_u32 m0, s46, 115712
    s_add_u32 s3, s93, 15360
    s_mov_b64 exec, s[66:67]
    buffer_load_dwordx4 v18, s[8:11], s3 offen lds
    s_mov_b64 exec, -1
    s_waitcnt lgkmcnt(9)
    v_mfma_f32_32x32x16_bf16 v[112:127], a[12:15], a[24:27], v[112:127]
    ds_read_b64_tr_b16 a[12:13], v31 offset:40960
    ds_read_b64_tr_b16 a[14:15], v31 offset:41984
    s_add_u32 s3, s101, 1
    s_cmp_ge_u32 s3, 10
    s_cselect_b32 s99, 10, 0
    s_sub_u32 s3, s3, s99
    s_cmp_lg_u32 s3, s43
    s_cbranch_scc1 L_nores_6
    v_xor_b32 v45, 0, v19
    ds_read_b64 a[192:193], v45 offset:32768
    v_xor_b32 v45, 16, v19
    ds_read_b64 a[194:195], v45 offset:32768
    v_xor_b32 v45, 32, v19
    ds_read_b64 a[196:197], v45 offset:32768
    v_xor_b32 v45, 48, v19
    ds_read_b64 a[198:199], v45 offset:32768
    v_xor_b32 v45, 64, v19
    ds_read_b64 a[200:201], v45 offset:32768
    v_xor_b32 v45, 80, v19
    ds_read_b64 a[202:203], v45 offset:32768
    v_xor_b32 v45, 96, v19
    ds_read_b64 a[204:205], v45 offset:32768
    v_xor_b32 v45, 112, v19
    ds_read_b64 a[206:207], v45 offset:32768
    s_waitcnt lgkmcnt(0)
L_nores_6:
    s_waitcnt lgkmcnt(9)
    v_mfma_f32_32x32x16_bf16 v[128:143], a[16:19], a[28:31], v[128:143]
    ds_read_b64_tr_b16 a[16:17], v36 offset:40960
    ds_read_b64_tr_b16 a[18:19], v36 offset:41984
    v_mfma_f32_32x32x16_bf16 v[144:159], a[24:27], a[24:27], v[144:159]
    ds_read_b128 a[24:27], v23 offset:32768
    s_waitcnt lgkmcnt(9)
    v_mfma_f32_32x32x16_bf16 v[64:79], a[0:3], a[20:23], v[64:79]
    ds_read_b64_tr_b16 a[0:1], v28 offset:45056
    ds_read_b64_tr_b16 a[2:3], v28 offset:46080
    s_add_u32 m0, s46, 116736
    s_add_u32 s3, s93, 30720
    s_mov_b64 exec, s[66:67]
    buffer_load_dwordx4 v18, s[8:11], s3 offen lds
    s_mov_b64 exec, -1
    s_waitcnt lgkmcnt(9)
    v_mfma_f32_32x32x16_bf16 v[80:95], a[4:7], a[20:23], v[80:95]
    ds_read_b64_tr_b16 a[4:5], v29 offset:45056
    ds_read_b64_tr_b16 a[6:7], v29 offset:46080
    s_waitcnt lgkmcnt(9)
    v_mfma_f32_32x32x16_bf16 v[96:111], a[8:11], a[20:23], v[96:111]
    ds_read_b64_tr_b16 a[8:9], v30 offset:45056
    ds_read_b64_tr_b16 a[10:11], v30 offset:46080
    s_add_u32 m0, s46, 117760
    s_add_u32 s3, s93, 46080
    s_mov_b64 exec, s[66:67]
    buffer_load_dwordx4 v18, s[8:11], s3 offen lds
    s_mov_b64 exec, -1
    s_add_u32 s92, s92, 128
    s_add_u32 s93, s93, 245760
    s_cmp_eq_u32 s92, 1280
    s_cselect_b32 s92, 0, s92
    s_cselect_b32 s93, 0, s93
    s_waitcnt lgkmcnt(9)
    v_mfma_f32_32x32x16_bf16 v[112:127], a[12:15], a[20:23], v[112:127]
    ds_read_b64_tr_b16 a[12:13], v31 offset:45056
    ds_read_b64_tr_b16 a[14:15], v31 offset:46080
    s_waitcnt lgkmcnt(9)
    v_mfma_f32_32x32x16_bf16 v[128:143], a[16:19], a[28:31], v[128:143]
    ds_read_b64_tr_b16 a[16:17], v36 offset:45056
    ds_read_b64_tr_b16 a[18:19], v36 offset:46080
    v_mfma_f32_32x32x16_bf16 v[144:159], a[20:23], a[20:23], v[144:159]
    s_waitcnt vmcnt(8)
    s_barrier
    ds_read_b128 a[20:23], v24 offset:0
    s_waitcnt lgkmcnt(9)
    v_mfma_f32_32x32x16_bf16 v[64:79], a[0:3], a[24:27], v[64:79]
    ds_read_b64_tr_b16 a[0:1], v32 offset:0
    ds_read_b64_tr_b16 a[2:3], v32 offset:1024
    s_add_u32 m0, s46, 0
    s_add_u32 s3, s92, 0
    buffer_load_dwordx4 v16, s[4:7], s3 offen lds
    s_waitcnt lgkmcnt(9)
    v_mfma_f32_32x32x16_bf16 v[80:95], a[4:7], a[24:27], v[80:95]
    ds_read_b64_tr_b16 a[4:5], v33 offset:0
    ds_read_b64_tr_b16 a[6:7], v33 offset:1024
    s_waitcnt lgkmcnt(9)
    v_mfma_f32_32x32x16_bf16 v[96:111], a[8:11], a[24:27], v[96:111]
    ds_read_b64_tr_b16 a[8:9], v34 offset:0
    ds_read_b64_tr_b16 a[10:11], v34 offset:1024
    s_add_u32 m0, s46, 1024
    s_add_u32 s3, s92, 10240
    buffer_load_dwordx4 v17, s[4:7], s3 offen lds
    s_waitcnt lgkmcnt(9)
    v_mfma_f32_32x32x16_bf16 v[112:127], a[12:15], a[24:27], v[112:127]
    ds_read_b64_tr_b16 a[12:13], v35 offset:0
    ds_read_b64_tr_b16 a[14:15], v35 offset:1024
    s_waitcnt lgkmcnt(9)
    v_mfma_f32_32x32x16_bf16 v[128:143], a[16:19], a[28:31], v[128:143]
    ds_read_b64_tr_b16 a[16:17], v37 offset:0
    ds_read_b64_tr_b16 a[18:19], v37 offset:1024
    v_mfma_f32_32x32x16_bf16 v[144:159], a[24:27], a[24:27], v[144:159]
    ds_read_b128 a[24:27], v25 offset:0
    s_waitcnt lgkmcnt(9)
    v_mfma_f32_32x32x16_bf16 v[64:79], a[0:3], a[20:23], v[64:79]
    ds_read_b64_tr_b16 a[0:1], v32 offset:4096
    ds_read_b64_tr_b16 a[2:3], v32 offset:5120
    s_add_u32 m0, s46, 2048
    s_add_u32 s3, s92, 20480
    buffer_load_dwordx4 v16, s[4:7], s3 offen lds
    s_waitcnt lgkmcnt(9)
    v_mfma_f32_32x32x16_bf16 v[80:95], a[4:7], a[20:23], v[80:95]
    ds_read_b64_tr_b16 a[4:5], v33 offset:4096
    ds_read_b64_tr_b16 a[6:7], v33 offset:5120
    s_waitcnt lgkmcnt(9)
    v_mfma_f32_32x32x16_bf16 v[96:111], a[8:11], a[20:23], v[96:111]
    ds_read_b64_tr_b16 a[8:9], v34 offset:4096
    ds_read_b64_tr_b16 a[10:11], v34 offset:5120
    s_add_u32 m0, s46, 3072
    s_add_u32 s3, s92, 30720
    buffer_load_dwordx4 v17, s[4:7], s3 offen lds
    s_waitcnt lgkmcnt(9)
    v_mfma_f32_32x32x16_bf16 v[112:127], a[12:15], a[20:23], v[112:127]
    ds_read_b64_tr_b16 a[12:13], v35 offset:4096
    ds_read_b64_tr_b16 a[14:15], v35 offset:5120
    s_waitcnt lgkmcnt(9)
    v_mfma_f32_32x32x16_bf16 v[128:143], a[16:19], a[28:31], v[128:143]
    ds_read_b64_tr_b16 a[16:17], v37 offset:4096
    ds_read_b64_tr_b16 a[18:19], v37 offset:5120
    v_mfma_f32_32x32x16_bf16 v[144:159], a[20:23], a[20:23], v[144:159]
    ds_read_b128 a[20:23], v26 offset:0
    s_waitcnt lgkmcnt(9)
    v_mfma_f32_32x32x16_bf16 v[64:79], a[0:3], a[24:27], v[64:79]
    ds_read_b64_tr_b16 a[0:1], v32 offset:8192
    ds_read_b64_tr_b16 a[2:3], v32 offset:9216
    s_add_u32 m0, s46, 16384
    s_add_u32 s3, s93, 0
    s_mov_b64 exec, s[66:67]
    buffer_load_dwordx4 v18, s[8:11], s3 offen lds
    s_mov_b64 exec, -1
    s_waitcnt lgkmcnt(9)
    v_mfma_f32_32x32x16_bf16 v[80:95], a[4:7], a[24:27], v[80:95]
    ds_read_b64_tr_b16 a[4:5], v33 offset:8192
    ds_read_b64_tr_b16 a[6:7], v33 offset:9216
    s_waitcnt lgkmcnt(9)
    v_mfma_f32_32x32x16_bf16 v[96:111], a[8:11], a[24:27], v[96:111]
    ds_read_b64_tr_b16 a[8:9], v34 offset:8192
    ds_read_b64_tr_b16 a[10:11], v34 offset:9216
    s_add_u32 m0, s46, 17408
    s_add_u32 s3, s93, 15360
    s_mov_b64 exec, s[66:67]
    buffer_load_dwordx4 v18, s[8:11], s3 offen lds
    s_mov_b64 exec, -1
    s_waitcnt lgkmcnt(9)
    v_mfma_f32_32x32x16_bf16 v[112:127], a[12:15], a[24:27], v[112:127]
    ds_read_b64_tr_b16 a[12:13], v35 offset:8192
    ds_read_b64_tr_b16 a[14:15], v35 offset:9216
    s_add_u32 s3, s101, 2
    s_cmp_ge_u32 s3, 10
    s_cselect_b32 s99, 10, 0
    s_sub_u32 s3, s3, s99
    s_cmp_lg_u32 s3, s43
    s_cbranch_scc1 L_nores_7
    v_xor_b32 v45, 0, v19
    v_add_u32 v45, 0x10000, v45
    ds_read_b64 a[192:193], v45 offset:0
    v_xor_b32 v45, 16, v19
    v_add_u32 v45, 0x10000, v45
    ds_read_b64 a[194:195], v45 offset:0
    v_xor_b32 v45, 32, v19
    v_add_u32 v45, 0x10000, v45
    ds_read_b64 a[196:197], v45 offset:0
    v_xor_b32 v45, 48, v19
    v_add_u32 v45, 0x10000, v45
    ds_read_b64 a[198:199], v45 offset:0
    v_xor_b32 v45, 64, v19
    v_add_u32 v45, 0x10000, v45
    ds_read_b64 a[200:201], v45 offset:0
    v_xor_b32 v45, 80, v19
    v_add_u32 v45, 0x10000, v45
    ds_read_b64 a[202:203], v45 offset:0
    v_xor_b32 v45, 96, v19
    v_add_u32 v45, 0x10000, v45
    ds_read_b64 a[204:205], v45 offset:0
    v_xor_b32 v45, 112, v19
    v_add_u32 v45, 0x10000, v45
    ds_read_b64 a[206:207], v45 offset:0
    s_waitcnt lgkmcnt(0)
L_nores_7:
    s_waitcnt lgkmcnt(9)
    v_mfma_f32_32x32x16_bf16 v[128:143], a[16:19], a[28:31], v[128:143]
    ds_read_b64_tr_b16 a[16:17], v37 offset:8192
    ds_read_b64_tr_b16 a[18:19], v37 offset:9216
    v_mfma_f32_32x32x16_bf16 v[144:159], a[24:27], a[24:27], v[144:159]
    ds_read_b128 a[24:27], v27 offset:0
    s_waitcnt lgkmcnt(9)
    v_mfma_f32_32x32x16_bf16 v[64:79], a[0:3], a[20:23], v[64:79]
    ds_read_b64_tr_b16 a[0:1], v32 offset:12288
    ds_read_b64_tr_b16 a[2:3], v32 offset:13312
    s_add_u32 m0, s46, 18432
    s_add_u32 s3, s93, 30720
    s_mov_b64 exec, s[66:67]
    buffer_load_dwordx4 v18, s[8:11], s3 offen lds
    s_mov_b64 exec, -1
    s_waitcnt lgkmcnt(9)
    v_mfma_f32_32x32x16_bf16 v[80:95], a[4:7], a[20:23], v[80:95]
    ds_read_b64_tr_b16 a[4:5], v33 offset:12288
    ds_read_b64_tr_b16 a[6:7], v33 offset:13312
    s_waitcnt lgkmcnt(9)
    v_mfma_f32_32x32x16_bf16 v[96:111], a[8:11], a[20:23], v[96:111]
    ds_read_b64_tr_b16 a[8:9], v34 offset:12288
    ds_read_b64_tr_b16 a[10:11], v34 offset:13312
    s_add_u32 m0, s46, 19456
    s_add_u32 s3, s93, 46080
    s_mov_b64 exec, s[66:67]
    buffer_load_dwordx4 v18, s[8:11], s3 offen lds
    s_mov_b64 exec, -1
    s_add_u32 s92, s92, 128
    s_add_u32 s93, s93, 245760
    s_cmp_eq_u32 s92, 1280
    s_cselect_b32 s92, 0, s92
    s_cselect_b32 s93, 0, s93
    s_waitcnt lgkmcnt(9)
    v_mfma_f32_32x32x16_bf16 v[112:127], a[12:15], a[20:23], v[112:127]
    ds_read_b64_tr_b16 a[12:13], v35 offset:12288
    ds_read_b64_tr_b16 a[14:15], v35 offset:13312
    s_mul_i32 s3, s2, 25
    s_mul_i32 s99, s40, 7
    s_add_u32 s3, s3, s99
    v_add_u32 v45, s3, v1
    v_lshlrev_b32 v45, 7, v45
    s_mov_b64 exec, 127
    buffer_load_dword v43, v45, s[12:15], 0 offen
    s_mov_b64 exec, -1
    s_waitcnt lgkmcnt(9)
    v_mfma_f32_32x32x16_bf16 v[128:143], a[16:19], a[28:31], v[128:143]
    ds_read_b64_tr_b16 a[16:17], v37 offset:12288
    ds_read_b64_tr_b16 a[18:19], v37 offset:13312
    v_mfma_f32_32x32x16_bf16 v[144:159], a[20:23], a[20:23], v[144:159]
    s_waitcnt vmcnt(9)
    s_barrier
    ds_read_b128 a[20:23], v24 offset:32768
    s_waitcnt lgkmcnt(9)
    v_mfma_f32_32x32x16_bf16 v[64:79], a[0:3], a[24:27], v[64:79]
    ds_read_b64_tr_b16 a[0:1], v32 offset:32768
    ds_read_b64_tr_b16 a[2:3], v32 offset:33792
    s_add_u32 m0, s46, 32768
    s_add_u32 s3, s92, 0
    buffer_load_dwordx4 v16, s[4:7], s3 offen lds
    s_waitcnt lgkmcnt(9)
    v_mfma_f32_32x32x16_bf16 v[80:95], a[4:7], a[24:27], v[80:95]
    ds_read_b64_tr_b16 a[4:5], v33 offset:32768
    ds_read_b64_tr_b16 a[6:7], v33 offset:33792
    s_waitcnt lgkmcnt(9)
    v_mfma_f32_32x32x16_bf16 v[96:111], a[8:11], a[24:27], v[96:111]
    ds_read_b64_tr_b16 a[8:9], v34 offset:32768
    ds_read_b64_tr_b16 a[10:11], v34 offset:33792
    s_add_u32 m0, s46, 33792
    s_add_u32 s3, s92, 10240
    buffer_load_dwordx4 v17, s[4:7], s3 offen lds
    s_waitcnt lgkmcnt(9)
    v_mfma_f32_32x32x16_bf16 v[112:127], a[12:15], a[24:27], v[112:127]
    ds_read_b64_tr_b16 a[12:13], v35 offset:32768
    ds_read_b64_tr_b16 a[14:15], v35 offset:33792
    s_waitcnt lgkmcnt(9)
    v_mfma_f32_32x32x16_bf16 v[128:143], a[16:19], a[28:31], v[128:143]
    ds_read_b64_tr_b16 a[16:17], v37 offset:32768
    ds_read_b64_tr_b16 a[18:19], v37 offset:33792
    v_mfma_f32_32x32x16_bf16 v[144:159], a[24:27], a[24:27], v[144:159]
    ds_read_b128 a[24:27], v25 offset:32768
    s_waitcnt lgkmcnt(9)
    v_mfma_f32_32x32x16_bf16 v[64:79], a[0:3], a[20:23], v[64:79]
    ds_read_b64_tr_b16 a[0:1], v32 offset:36864
    ds_read_b64_tr_b16 a[2:3], v32 offset:37888
    s_add_u32 m0, s46, 34816
    s_add_u32 s3, s92, 20480
    buffer_load_dwordx4 v16, s[4:7], s3 offen lds
    s_waitcnt lgkmcnt(9)
    v_mfma_f32_32x32x16_bf16 v[80:95], a[4:7], a[20:23], v[80:95]
    ds_read_b64_tr_b16 a[4:5], v33 offset:36864
    ds_read_b64_tr_b16 a[6:7], v33 offset:37888
    s_waitcnt lgkmcnt(9)
    v_mfma_f32_32x32x16_bf16 v[96:111], a[8:11], a[20:23], v[96:111]
    ds_read_b64_tr_b16 a[8:9], v34 offset:36864
    ds_read_b64_tr_b16 a[10:11], v34 offset:37888
    s_add_u32 m0, s46, 35840
    s_add_u32 s3, s92, 30720
    buffer_load_dwordx4 v17, s[4:7], s3 offen lds
    s_waitcnt lgkmcnt(9)
    v_mfma_f32_32x32x16_bf16 v[112:127], a[12:15], a[20:23], v[112:127]
    ds_read_b64_tr_b16 a[12:13], v35 offset:36864
    ds_read_b64_tr_b16 a[14:15], v35 offset:37888
    s_waitcnt lgkmcnt(9)
    v_mfma_f32_32x32x16_bf16 v[128:143], a[16:19], a[28:31], v[128:143]
    ds_read_b64_tr_b16 a[16:17], v37 offset:36864
    ds_read_b64_tr_b16 a[18:19], v37 offset:37888
    v_mfma_f32_32x32x16_bf16 v[144:159], a[20:23], a[20:23], v[144:159]
    ds_read_b128 a[20:23], v26 offset:32768
    s_waitcnt lgkmcnt(9)
    v_mfma_f32_32x32x16_bf16 v[64:79], a[0:3], a[24:27], v[64:79]
    ds_read_b64_tr_b16 a[0:1], v32 offset:40960
    ds_read_b64_tr_b16 a[2:3], v32 offset:41984
    s_add_u32 m0, s46, 49152
    s_add_u32 s3, s93, 0
    s_mov_b64 exec, s[66:67]
    buffer_load_dwordx4 v18, s[8:11], s3 offen lds
    s_mov_b64 exec, -1
    s_waitcnt lgkmcnt(9)
    v_mfma_f32_32x32x16_bf16 v[80:95], a[4:7], a[24:27], v[80:95]
    ds_read_b64_tr_b16 a[4:5], v33 offset:40960
    ds_read_b64_tr_b16 a[6:7], v33 offset:41984
    s_waitcnt lgkmcnt(9)
    v_mfma_f32_32x32x16_bf16 v[96:111], a[8:11], a[24:27], v[96:111]
    ds_read_b64_tr_b16 a[8:9], v34 offset:40960
    ds_read_b64_tr_b16 a[10:11], v34 offset:41984
    s_add_u32 m0, s46, 50176
    s_add_u32 s3, s93, 15360
    s_mov_b64 exec, s[66:67]
    buffer_load_dwordx4 v18, s[8:11], s3 offen lds
    s_mov_b64 exec, -1
    s_waitcnt lgkmcnt(9)
    v_mfma_f32_32x32x16_bf16 v[112:127], a[12:15], a[24:27], v[112:127]
    ds_read_b64_tr_b16 a[12:13], v35 offset:40960
    ds_read_b64_tr_b16 a[14:15], v35 offset:41984
    s_add_u32 s3, s101, 3
    s_cmp_ge_u32 s3, 10
    s_cselect_b32 s99, 10, 0
    s_sub_u32 s3, s3, s99
    s_cmp_lg_u32 s3, s43
    s_cbranch_scc1 L_nores_8
    v_xor_b32 v45, 0, v19
    v_add_u32 v45, 0x10000, v45
    ds_read_b64 a[192:193], v45 offset:32768
    v_xor_b32 v45, 16, v19
    v_add_u32 v45, 0x10000, v45
    ds_read_b64 a[194:195], v45 offset:32768
    v_xor_b32 v45, 32, v19
    v_add_u32 v45, 0x10000, v45
    ds_read_b64 a[196:197], v45 offset:32768
    v_xor_b32 v45, 48, v19
    v_add_u32 v45, 0x10000, v45
    ds_read_b64 a[198:199], v45 offset:32768
    v_xor_b32 v45, 64, v19
    v_add_u32 v45, 0x10000, v45
    ds_read_b64 a[200:201], v45 offset:32768
    v_xor_b32 v45, 80, v19
    v_add_u32 v45, 0x10000, v45
    ds_read_b64 a[202:203], v45 offset:32768
    v_xor_b32 v45, 96, v19
    v_add_u32 v45, 0x10000, v45
    ds_read_b64 a[204:205], v45 offset:32768
    v_xor_b32 v45, 112, v19
    v_add_u32 v45, 0x10000, v45
    ds_read_b64 a[206:207], v45 offset:32768
    s_waitcnt lgkmcnt(0)
L_nores_8:
    s_waitcnt lgkmcnt(9)
    v_mfma_f32_32x32x16_bf16 v[128:143], a[16:19], a[28:31], v[128:143]
    ds_read_b64_tr_b16 a[16:17], v37 offset:40960
    ds_read_b64_tr_b16 a[18:19], v37 offset:41984
    v_mfma_f32_32x32x16_bf16 v[144:159], a[24:27], a[24:27], v[144:159]
    ds_read_b128 a[24:27], v27 offset:32768
    s_waitcnt lgkmcnt(9)
    v_mfma_f32_32x32x16_bf16 v[64:79], a[0:3], a[20:23], v[64:79]
    ds_read_b64_tr_b16 a[0:1], v32 offset:45056
    ds_read_b64_tr_b16 a[2:3], v32 offset:46080
    s_add_u32 m0, s46, 51200
    s_add_u32 s3, s93, 30720
    s_mov_b64 exec, s[66:67]
    buffer_load_dwordx4 v18, s[8:11], s3 offen lds
    s_mov_b64 exec, -1
    s_waitcnt lgkmcnt(9)
    v_mfma_f32_32x32x16_bf16 v[80:95], a[4:7], a[20:23], v[80:95]
    ds_read_b64_tr_b16 a[4:5], v33 offset:45056
    ds_read_b64_tr_b16 a[6:7], v33 offset:46080
    s_waitcnt lgkmcnt(9)
    v_mfma_f32_32x32x16_bf16 v[96:111], a[8:11], a[20:23], v[96:111]
    ds_read_b64_tr_b16 a[8:9], v34 offset:45056
    ds_read_b64_tr_b16 a[10:11], v34 offset:46080
    s_add_u32 m0, s46, 52224
    s_add_u32 s3, s93, 46080
    s_mov_b64 exec, s[66:67]
    buffer_load_dwordx4 v18, s[8:11], s3 offen lds
    s_mov_b64 exec, -1
    s_add_u32 s92, s92, 128
    s_add_u32 s93, s93, 245760
    s_cmp_eq_u32 s92, 1280
    s_cselect_b32 s92, 0, s92
    s_cselect_b32 s93, 0, s93
    s_waitcnt lgkmcnt(9)
    v_mfma_f32_32x32x16_bf16 v[112:127], a[12:15], a[20:23], v[112:127]
    ds_read_b64_tr_b16 a[12:13], v35 offset:45056
    ds_read_b64_tr_b16 a[14:15], v35 offset:46080
    s_waitcnt lgkmcnt(9)
    v_mfma_f32_32x32x16_bf16 v[128:143], a[16:19], a[28:31], v[128:143]
    ds_read_b64_tr_b16 a[16:17], v37 offset:45056
    ds_read_b64_tr_b16 a[18:19], v37 offset:46080
    v_mfma_f32_32x32x16_bf16 v[144:159], a[20:23], a[20:23], v[144:159]
    s_waitcnt vmcnt(9)
    s_barrier
    ds_read_b128 a[20:23], v20 offset:0
    s_waitcnt lgkmcnt(9)
    v_mfma_f32_32x32x16_bf16 v[64:79], a[0:3], a[24:27], v[64:79]
    ds_read_b64_tr_b16 a[0:1], v28 offset:0
    ds_read_b64_tr_b16 a[2:3], v28 offset:1024
    s_add_u32 m0, s46, 65536
    s_add_u32 s3, s92, 0
    buffer_load_dwordx4 v16, s[4:7], s3 offen lds
    s_waitcnt lgkmcnt(9)
    v_mfma_f32_32x32x16_bf16 v[80:95], a[4:7], a[24:27], v[80:95]
    ds_read_b64_tr_b16 a[4:5], v29 offset:0
    ds_read_b64_tr_b16 a[6:7], v29 offset:1024
    s_waitcnt lgkmcnt(9)
    v_mfma_f32_32x32x16_bf16 v[96:111], a[8:11], a[24:27], v[96:111]
    ds_read_b64_tr_b16 a[8:9], v30 offset:0
    ds_read_b64_tr_b16 a[10:11], v30 offset:1024
    s_add_u32 m0, s46, 66560
    s_add_u32 s3, s92, 10240
    buffer_load_dwordx4 v17, s[4:7], s3 offen lds
    s_waitcnt lgkmcnt(9)
    v_mfma_f32_32x32x16_bf16 v[112:127], a[12:15], a[24:27], v[112:127]
    ds_read_b64_tr_b16 a[12:13], v31 offset:0
    ds_read_b64_tr_b16 a[14:15], v31 offset:1024
    s_waitcnt lgkmcnt(9)
    v_mfma_f32_32x32x16_bf16 v[128:143], a[16:19], a[28:31], v[128:143]
    ds_read_b64_tr_b16 a[16:17], v36 offset:0
    ds_read_b64_tr_b16 a[18:19], v36 offset:1024
    v_mfma_f32_32x32x16_bf16 v[144:159], a[24:27], a[24:27], v[144:159]
    ds_read_b128 a[24:27], v21 offset:0
    s_waitcnt lgkmcnt(9)
    v_mfma_f32_32x32x16_bf16 v[64:79], a[0:3], a[20:23], v[64:79]
    ds_read_b64_tr_b16 a[0:1], v28 offset:4096
    ds_read_b64_tr_b16 a[2:3], v28 offset:5120
    s_add_u32 m0, s46, 67584
    s_add_u32 s3, s92, 20480
    buffer_load_dwordx4 v16, s[4:7], s3 offen lds
    s_waitcnt lgkmcnt(9)
    v_mfma_f32_32x32x16_bf16 v[80:95], a[4:7], a[20:23], v[80:95]
    ds_read_b64_tr_b16 a[4:5], v29 offset:4096
    ds_read_b64_tr_b16 a[6:7], v29 offset:5120
    s_waitcnt lgkmcnt(9)
    v_mfma_f32_32x32x16_bf16 v[96:111], a[8:11], a[20:23], v[96:111]
    ds_read_b64_tr_b16 a[8:9], v30 offset:4096
    ds_read_b64_tr_b16 a[10:11], v30 offset:5120
    s_add_u32 m0, s46, 68608
    s_add_u32 s3, s92, 30720
    buffer_load_dwordx4 v17, s[4:7], s3 offen lds
    s_waitcnt lgkmcnt(9)
    v_mfma_f32_32x32x16_bf16 v[112:127], a[12:15], a[20:23], v[112:127]
    ds_read_b64_tr_b16 a[12:13], v31 offset:4096
    ds_read_b64_tr_b16 a[14:15], v31 offset:5120
    s_waitcnt lgkmcnt(9)
    v_mfma_f32_32x32x16_bf16 v[128:143], a[16:19], a[28:31], v[128:143]
    ds_read_b64_tr_b16 a[16:17], v36 offset:4096
    ds_read_b64_tr_b16 a[18:19], v36 offset:5120
    v_mfma_f32_32x32x16_bf16 v[144:159], a[20:23], a[20:23], v[144:159]
    ds_read_b128 a[20:23], v22 offset:0
    s_waitcnt lgkmcnt(9)
    v_mfma_f32_32x32x16_bf16 v[64:79], a[0:3], a[24:27], v[64:79]
    ds_read_b64_tr_b16 a[0:1], v28 offset:8192
    ds_read_b64_tr_b16 a[2:3], v28 offset:9216
    s_add_u32 m0, s46, 81920
    s_add_u32 s3, s93, 0
    s_mov_b64 exec, s[66:67]
    buffer_load_dwordx4 v18, s[8:11], s3 offen lds
    s_mov_b64 exec, -1
    s_waitcnt lgkmcnt(9)
    v_mfma_f32_32x32x16_bf16 v[80:95], a[4:7], a[24:27], v[80:95]
    ds_read_b64_tr_b16 a[4:5], v29 offset:8192
    ds_read_b64_tr_b16 a[6:7], v29 offset:9216
    s_waitcnt lgkmcnt(9)
    v_mfma_f32_32x32x16_bf16 v[96:111], a[8:11], a[24:27], v[96:111]
    ds_read_b64_tr_b16 a[8:9], v30 offset:8192
    ds_read_b64_tr_b16 a[10:11], v30 offset:9216
    s_add_u32 m0, s46, 82944
    s_add_u32 s3, s93, 15360
    s_mov_b64 exec, s[66:67]
    buffer_load_dwordx4 v18, s[8:11], s3 offen lds
    s_mov_b64 exec, -1
    s_waitcnt lgkmcnt(9)
    v_mfma_f32_32x32x16_bf16 v[112:127], a[12:15], a[24:27], v[112:127]
    ds_read_b64_tr_b16 a[12:13], v31 offset:8192
    ds_read_b64_tr_b16 a[14:15], v31 offset:9216
    s_add_u32 s3, s101, 4
    s_cmp_ge_u32 s3, 10
    s_cselect_b32 s99, 10, 0
    s_sub_u32 s3, s3, s99
    s_cmp_lg_u32 s3, s43
    s_cbranch_scc1 L_nores_9
    v_xor_b32 v45, 0, v19
    ds_read_b64 a[192:193], v45 offset:0
    v_xor_b32 v45, 16, v19
    ds_read_b64 a[194:195], v45 offset:0
    v_xor_b32 v45, 32, v19
    ds_read_b64 a[196:197], v45 offset:0
    v_xor_b32 v45, 48, v19
    ds_read_b64 a[198:199], v45 offset:0
    v_xor_b32 v45, 64, v19
    ds_read_b64 a[200:201], v45 offset:0
    v_xor_b32 v45, 80, v19
    ds_read_b64 a[202:203], v45 offset:0
    v_xor_b32 v45, 96, v19
    ds_read_b64 a[204:205], v45 offset:0
    v_xor_b32 v45, 112, v19
    ds_read_b64 a[206:207], v45 offset:0
    s_waitcnt lgkmcnt(0)
L_nores_9:
    s_waitcnt lgkmcnt(9)
    v_mfma_f32_32x32x16_bf16 v[128:143], a[16:19], a[28:31], v[128:143]
    ds_read_b64_tr_b16 a[16:17], v36 offset:8192
    ds_read_b64_tr_b16 a[18:19], v36 offset:9216
    v_mfma_f32_32x32x16_bf16 v[144:159], a[24:27], a[24:27], v[144:159]
    ds_read_b128 a[24:27], v23 offset:0
    s_waitcnt lgkmcnt(9)
    v_mfma_f32_32x32x16_bf16 v[64:79], a[0:3], a[20:23], v[64:79]
    ds_read_b64_tr_b16 a[0:1], v28 offset:12288
    ds_read_b64_tr_b16 a[2:3], v28 offset:13312
    s_add_u32 m0, s46, 83968
    s_add_u32 s3, s93, 30720
    s_mov_b64 exec, s[66:67]
    buffer_load_dwordx4 v18, s[8:11], s3 offen lds
    s_mov_b64 exec, -1
    s_waitcnt lgkmcnt(9)
    v_mfma_f32_32x32x16_bf16 v[80:95], a[4:7], a[20:23], v[80:95]
    ds_read_b64_tr_b16 a[4:5], v29 offset:12288
    ds_read_b64_tr_b16 a[6:7], v29 offset:13312
    s_waitcnt lgkmcnt(9)
    v_mfma_f32_32x32x16_bf16 v[96:111], a[8:11], a[20:23], v[96:111]
    ds_read_b64_tr_b16 a[8:9], v30 offset:12288
    ds_read_b64_tr_b16 a[10:11], v30 offset:13312
    s_add_u32 m0, s46, 84992
    s_add_u32 s3, s93, 46080
    s_mov_b64 exec, s[66:67]
    buffer_load_dwordx4 v18, s[8:11], s3 offen lds
    s_mov_b64 exec, -1
    s_add_u32 s92, s92, 128
    s_add_u32 s93, s93, 245760
    s_cmp_eq_u32 s92, 1280
    s_cselect_b32 s92, 0, s92
    s_cselect_b32 s93, 0, s93
    s_waitcnt lgkmcnt(9)
    v_mfma_f32_32x32x16_bf16 v[112:127], a[12:15], a[20:23], v[112:127]
    ds_read_b64_tr_b16 a[12:13], v31 offset:12288
    ds_read_b64_tr_b16 a[14:15], v31 offset:13312
    s_waitcnt lgkmcnt(9)
    v_mfma_f32_32x32x16_bf16 v[128:143], a[16:19], a[28:31], v[128:143]
    ds_read_b64_tr_b16 a[16:17], v36 offset:12288
    ds_read_b64_tr_b16 a[18:19], v36 offset:13312
    v_mfma_f32_32x32x16_bf16 v[144:159], a[20:23], a[20:23], v[144:159]
    s_waitcnt vmcnt(8)
    s_barrier
    ds_read_b128 a[20:23], v20 offset:32768
    s_waitcnt lgkmcnt(9)
    v_mfma_f32_32x32x16_bf16 v[64:79], a[0:3], a[24:27], v[64:79]
    ds_read_b64_tr_b16 a[0:1], v28 offset:32768
    ds_read_b64_tr_b16 a[2:3], v28 offset:33792
    s_add_u32 m0, s46, 98304
    s_add_u32 s3, s92, 0
    buffer_load_dwordx4 v16, s[4:7], s3 offen lds
    s_waitcnt lgkmcnt(9)
    v_mfma_f32_32x32x16_bf16 v[80:95], a[4:7], a[24:27], v[80:95]
    ds_read_b64_tr_b16 a[4:5], v29 offset:32768
    ds_read_b64_tr_b16 a[6:7], v29 offset:33792
    s_waitcnt lgkmcnt(9)
    v_mfma_f32_32x32x16_bf16 v[96:111], a[8:11], a[24:27], v[96:111]
    ds_read_b64_tr_b16 a[8:9], v30 offset:32768
    ds_read_b64_tr_b16 a[10:11], v30 offset:33792
    s_add_u32 m0, s46, 99328
    s_add_u32 s3, s92, 10240
    buffer_load_dwordx4 v17, s[4:7], s3 offen lds
    s_waitcnt lgkmcnt(9)
    v_mfma_f32_32x32x16_bf16 v[112:127], a[12:15], a[24:27], v[112:127]
    ds_read_b64_tr_b16 a[12:13], v31 offset:32768
    ds_read_b64_tr_b16 a[14:15], v31 offset:33792
    s_waitcnt lgkmcnt(9)
    v_mfma_f32_32x32x16_bf16 v[128:143], a[16:19], a[28:31], v[128:143]
    ds_read_b64_tr_b16 a[16:17], v36 offset:32768
    ds_read_b64_tr_b16 a[18:19], v36 offset:33792
    v_mfma_f32_32x32x16_bf16 v[144:159], a[24:27], a[24:27], v[144:159]
    ds_read_b128 a[24:27], v21 offset:32768
    s_waitcnt lgkmcnt(9)
    v_mfma_f32_32x32x16_bf16 v[64:79], a[0:3], a[20:23], v[64:79]
    ds_read_b64_tr_b16 a[0:1], v28 offset:36864
    ds_read_b64_tr_b16 a[2:3], v28 offset:37888
    s_add_u32 m0, s46, 100352
    s_add_u32 s3, s92, 20480
    buffer_load_dwordx4 v16, s[4:7], s3 offen lds
    s_waitcnt lgkmcnt(9)
    v_mfma_f32_32x32x16_bf16 v[80:95], a[4:7], a[20:23], v[80:95]
    ds_read_b64_tr_b16 a[4:5], v29 offset:36864
    ds_read_b64_tr_b16 a[6:7], v29 offset:37888
    s_waitcnt lgkmcnt(9)
    v_mfma_f32_32x32x16_bf16 v[96:111], a[8:11], a[20:23], v[96:111]
    ds_read_b64_tr_b16 a[8:9], v30 offset:36864
    ds_read_b64_tr_b16 a[10:11], v30 offset:37888
    s_add_u32 m0, s46, 101376
    s_add_u32 s3, s92, 30720
    buffer_load_dwordx4 v17, s[4:7], s3 offen lds
    s_waitcnt lgkmcnt(9)
    v_mfma_f32_32x32x16_bf16 v[112:127], a[12:15], a[20:23], v[112:127]
    ds_read_b64_tr_b16 a[12:13], v31 offset:36864
    ds_read_b64_tr_b16 a[14:15], v31 offset:37888
    s_waitcnt lgkmcnt(9)
    v_mfma_f32_32x32x16_bf16 v[128:143], a[16:19], a[28:31], v[128:143]
    ds_read_b64_tr_b16 a[16:17], v36 offset:36864
    ds_read_b64_tr_b16 a[18:19], v36 offset:37888
    v_mfma_f32_32x32x16_bf16 v[144:159], a[20:23], a[20:23], v[144:159]
    ds_read_b128 a[20:23], v22 offset:32768
    s_waitcnt lgkmcnt(9)
    v_mfma_f32_32x32x16_bf16 v[64:79], a[0:3], a[24:27], v[64:79]
    ds_read_b64_tr_b16 a[0:1], v28 offset:40960
    ds_read_b64_tr_b16 a[2:3], v28 offset:41984
    s_add_u32 m0, s46, 114688
    s_add_u32 s3, s93, 0
    s_mov_b64 exec, s[66:67]
    buffer_load_dwordx4 v18, s[8:11], s3 offen lds
    s_mov_b64 exec, -1
    s_waitcnt lgkmcnt(9)
    v_mfma_f32_32x32x16_bf16 v[80:95], a[4:7], a[24:27], v[80:95]
    ds_read_b64_tr_b16 a[4:5], v29 offset:40960
    ds_read_b64_tr_b16 a[6:7], v29 offset:41984
    s_waitcnt lgkmcnt(9)
    v_mfma_f32_32x32x16_bf16 v[96:111], a[8:11], a[24:27], v[96:111]
    ds_read_b64_tr_b16 a[8:9], v30 offset:40960
    ds_read_b64_tr_b16 a[10:11], v30 offset:41984
    s_add_u32 m0, s46, 115712
    s_add_u32 s3, s93, 15360
    s_mov_b64 exec, s[66:67]
    buffer_load_dwordx4 v18, s[8:11], s3 offen lds
    s_mov_b64 exec, -1
    s_waitcnt lgkmcnt(9)
    v_mfma_f32_32x32x16_bf16 v[112:127], a[12:15], a[24:27], v[112:127]
    ds_read_b64_tr_b16 a[12:13], v31 offset:40960
    ds_read_b64_tr_b16 a[14:15], v31 offset:41984
    s_add_u32 s3, s101, 5
    s_cmp_ge_u32 s3, 10
    s_cselect_b32 s99, 10, 0
    s_sub_u32 s3, s3, s99
    s_cmp_lg_u32 s3, s43
    s_cbranch_scc1 L_nores_10
    v_xor_b32 v45, 0, v19
    ds_read_b64 a[192:193], v45 offset:32768
    v_xor_b32 v45, 16, v19
    ds_read_b64 a[194:195], v45 offset:32768
    v_xor_b32 v45, 32, v19
    ds_read_b64 a[196:197], v45 offset:32768
    v_xor_b32 v45, 48, v19
    ds_read_b64 a[198:199], v45 offset:32768
    v_xor_b32 v45, 64, v19
    ds_read_b64 a[200:201], v45 offset:32768
    v_xor_b32 v45, 80, v19
    ds_read_b64 a[202:203], v45 offset:32768
    v_xor_b32 v45, 96, v19
    ds_read_b64 a[204:205], v45 offset:32768
    v_xor_b32 v45, 112, v19
    ds_read_b64 a[206:207], v45 offset:32768
    s_waitcnt lgkmcnt(0)
L_nores_10:
    s_waitcnt lgkmcnt(9)
    v_mfma_f32_32x32x16_bf16 v[128:143], a[16:19], a[28:31], v[128:143]
    ds_read_b64_tr_b16 a[16:17], v36 offset:40960
    ds_read_b64_tr_b16 a[18:19], v36 offset:41984
    v_mfma_f32_32x32x16_bf16 v[144:159], a[24:27], a[24:27], v[144:159]
    ds_read_b128 a[24:27], v23 offset:32768
    s_waitcnt lgkmcnt(9)
    v_mfma_f32_32x32x16_bf16 v[64:79], a[0:3], a[20:23], v[64:79]
    ds_read_b64_tr_b16 a[0:1], v28 offset:45056
    ds_read_b64_tr_b16 a[2:3], v28 offset:46080
    s_add_u32 m0, s46, 116736
    s_add_u32 s3, s93, 30720
    s_mov_b64 exec, s[66:67]
    buffer_load_dwordx4 v18, s[8:11], s3 offen lds
    s_mov_b64 exec, -1
    s_waitcnt lgkmcnt(9)
    v_mfma_f32_32x32x16_bf16 v[80:95], a[4:7], a[20:23], v[80:95]
    ds_read_b64_tr_b16 a[4:5], v29 offset:45056
    ds_read_b64_tr_b16 a[6:7], v29 offset:46080
    s_waitcnt lgkmcnt(9)
    v_mfma_f32_32x32x16_bf16 v[96:111], a[8:11], a[20:23], v[96:111]
    ds_read_b64_tr_b16 a[8:9], v30 offset:45056
    ds_read_b64_tr_b16 a[10:11], v30 offset:46080
    s_add_u32 m0, s46, 117760
    s_add_u32 s3, s93, 46080
    s_mov_b64 exec, s[66:67]
    buffer_load_dwordx4 v18, s[8:11], s3 offen lds
    s_mov_b64 exec, -1
    s_add_u32 s92, s92, 128
    s_add_u32 s93, s93, 245760
    s_cmp_eq_u32 s92, 1280
    s_cselect_b32 s92, 0, s92
    s_cselect_b32 s93, 0, s93
    s_waitcnt lgkmcnt(9)
    v_mfma_f32_32x32x16_bf16 v[112:127], a[12:15], a[20:23], v[112:127]
    ds_read_b64_tr_b16 a[12:13], v31 offset:45056
    ds_read_b64_tr_b16 a[14:15], v31 offset:46080
    s_waitcnt lgkmcnt(9)
    v_mfma_f32_32x32x16_bf16 v[128:143], a[16:19], a[28:31], v[128:143]
    ds_read_b64_tr_b16 a[16:17], v36 offset:45056
    ds_read_b64_tr_b16 a[18:19], v36 offset:46080
    v_mfma_f32_32x32x16_bf16 v[144:159], a[20:23], a[20:23], v[144:159]
    s_waitcnt vmcnt(8)
    s_barrier
    ds_read_b128 a[20:23], v24 offset:0
    s_waitcnt lgkmcnt(9)
    v_mfma_f32_32x32x16_bf16 v[64:79], a[0:3], a[24:27], v[64:79]
    ds_read_b64_tr_b16 a[0:1], v32 offset:0
    ds_read_b64_tr_b16 a[2:3], v32 offset:1024
    s_add_u32 m0, s46, 0
    s_add_u32 s3, s92, 0
    buffer_load_dwordx4 v16, s[4:7], s3 offen lds
    s_waitcnt lgkmcnt(9)
    v_mfma_f32_32x32x16_bf16 v[80:95], a[4:7], a[24:27], v[80:95]
    ds_read_b64_tr_b16 a[4:5], v33 offset:0
    ds_read_b64_tr_b16 a[6:7], v33 offset:1024
    s_waitcnt lgkmcnt(9)
    v_mfma_f32_32x32x16_bf16 v[96:111], a[8:11], a[24:27], v[96:111]
    ds_read_b64_tr_b16 a[8:9], v34 offset:0
    ds_read_b64_tr_b16 a[10:11], v34 offset:1024
    s_add_u32 m0, s46, 1024
    s_add_u32 s3, s92, 10240
    buffer_load_dwordx4 v17, s[4:7], s3 offen lds
    s_waitcnt lgkmcnt(9)
    v_mfma_f32_32x32x16_bf16 v[112:127], a[12:15], a[24:27], v[112:127]
    ds_read_b64_tr_b16 a[12:13], v35 offset:0
    ds_read_b64_tr_b16 a[14:15], v35 offset:1024
    s_waitcnt lgkmcnt(9)
    v_mfma_f32_32x32x16_bf16 v[128:143], a[16:19], a[28:31], v[128:143]
    ds_read_b64_tr_b16 a[16:17], v37 offset:0
    ds_read_b64_tr_b16 a[18:19], v37 offset:1024
    v_mfma_f32_32x32x16_bf16 v[144:159], a[24:27], a[24:27], v[144:159]
    ds_read_b128 a[24:27], v25 offset:0
    s_waitcnt lgkmcnt(9)
    v_mfma_f32_32x32x16_bf16 v[64:79], a[0:3], a[20:23], v[64:79]
    ds_read_b64_tr_b16 a[0:1], v32 offset:4096
    ds_read_b64_tr_b16 a[2:3], v32 offset:5120
    s_add_u32 m0, s46, 2048
    s_add_u32 s3, s92, 20480
    buffer_load_dwordx4 v16, s[4:7], s3 offen lds
    s_waitcnt lgkmcnt(9)
    v_mfma_f32_32x32x16_bf16 v[80:95], a[4:7], a[20:23], v[80:95]
    ds_read_b64_tr_b16 a[4:5], v33 offset:4096
    ds_read_b64_tr_b16 a[6:7], v33 offset:5120
    s_waitcnt lgkmcnt(9)
    v_mfma_f32_32x32x16_bf16 v[96:111], a[8:11], a[20:23], v[96:111]
    ds_read_b64_tr_b16 a[8:9], v34 offset:4096
    ds_read_b64_tr_b16 a[10:11], v34 offset:5120
    s_add_u32 m0, s46, 3072
    s_add_u32 s3, s92, 30720
    buffer_load_dwordx4 v17, s[4:7], s3 offen lds
    s_waitcnt lgkmcnt(9)
    v_mfma_f32_32x32x16_bf16 v[112:127], a[12:15], a[20:23], v[112:127]
    ds_read_b64_tr_b16 a[12:13], v35 offset:4096
    ds_read_b64_tr_b16 a[14:15], v35 offset:5120
    s_waitcnt lgkmcnt(9)
    v_mfma_f32_32x32x16_bf16 v[128:143], a[16:19], a[28:31], v[128:143]
    ds_read_b64_tr_b16 a[16:17], v37 offset:4096
    ds_read_b64_tr_b16 a[18:19], v37 offset:5120
    v_mfma_f32_32x32x16_bf16 v[144:159], a[20:23], a[20:23], v[144:159]
    ds_read_b128 a[20:23], v26 offset:0
    s_waitcnt lgkmcnt(9)
    v_mfma_f32_32x32x16_bf16 v[64:79], a[0:3], a[24:27], v[64:79]
    ds_read_b64_tr_b16 a[0:1], v32 offset:8192
    ds_read_b64_tr_b16 a[2:3], v32 offset:9216
    s_add_u32 m0, s46, 16384
    s_add_u32 s3, s93, 0
    s_mov_b64 exec, s[66:67]
    buffer_load_dwordx4 v18, s[8:11], s3 offen lds
    s_mov_b64 exec, -1
    s_waitcnt lgkmcnt(9)
    v_mfma_f32_32x32x16_bf16 v[80:95], a[4:7], a[24:27], v[80:95]
    ds_read_b64_tr_b16 a[4:5], v33 offset:8192
    ds_read_b64_tr_b16 a[6:7], v33 offset:9216
    s_waitcnt lgkmcnt(9)
    v_mfma_f32_32x32x16_bf16 v[96:111], a[8:11], a[24:27], v[96:111]
    ds_read_b64_tr_b16 a[8:9], v34 offset:8192
    ds_read_b64_tr_b16 a[10:11], v34 offset:9216
    s_add_u32 m0, s46, 17408
    s_add_u32 s3, s93, 15360
    s_mov_b64 exec, s[66:67]
    buffer_load_dwordx4 v18, s[8:11], s3 offen lds
    s_mov_b64 exec, -1
    s_waitcnt lgkmcnt(9)
    v_mfma_f32_32x32x16_bf16 v[112:127], a[12:15], a[24:27], v[112:127]
    ds_read_b64_tr_b16 a[12:13], v35 offset:8192
    ds_read_b64_tr_b16 a[14:15], v35 offset:9216
    s_add_u32 s3, s101, 6
    s_cmp_ge_u32 s3, 10
    s_cselect_b32 s99, 10, 0
    s_sub_u32 s3, s3, s99
    s_cmp_lg_u32 s3, s43
    s_cbranch_scc1 L_nores_11
    v_xor_b32 v45, 0, v19
    v_add_u32 v45, 0x10000, v45
    ds_read_b64 a[192:193], v45 offset:0
    v_xor_b32 v45, 16, v19
    v_add_u32 v45, 0x10000, v45
    ds_read_b64 a[194:195], v45 offset:0
    v_xor_b32 v45, 32, v19
    v_add_u32 v45, 0x10000, v45
    ds_read_b64 a[196:197], v45 offset:0
    v_xor_b32 v45, 48, v19
    v_add_u32 v45, 0x10000, v45
    ds_read_b64 a[198:199], v45 offset:0
    v_xor_b32 v45, 64, v19
    v_add_u32 v45, 0x10000, v45
    ds_read_b64 a[200:201], v45 offset:0
    v_xor_b32 v45, 80, v19
    v_add_u32 v45, 0x10000, v45
    ds_read_b64 a[202:203], v45 offset:0
    v_xor_b32 v45, 96, v19
    v_add_u32 v45, 0x10000, v45
    ds_read_b64 a[204:205], v45 offset:0
    v_xor_b32 v45, 112, v19
    v_add_u32 v45, 0x10000, v45
    ds_read_b64 a[206:207], v45 offset:0
    s_waitcnt lgkmcnt(0)
L_nores_11:
    s_waitcnt lgkmcnt(9)
    v_mfma_f32_32x32x16_bf16 v[128:143], a[16:19], a[28:31], v[128:143]
    ds_read_b64_tr_b16 a[16:17], v37 offset:8192
    ds_read_b64_tr_b16 a[18:19], v37 offset:9216
    v_mfma_f32_32x32x16_bf16 v[144:159], a[24:27], a[24:27], v[144:159]
    ds_read_b128 a[24:27], v27 offset:0
    s_waitcnt lgkmcnt(9)
    v_mfma_f32_32x32x16_bf16 v[64:79], a[0:3], a[20:23], v[64:79]
    ds_read_b64_tr_b16 a[0:1], v32 offset:12288
    ds_read_b64_tr_b16 a[2:3], v32 offset:13312
    s_add_u32 m0, s46, 18432
    s_add_u32 s3, s93, 30720
    s_mov_b64 exec, s[66:67]
    buffer_load_dwordx4 v18, s[8:11], s3 offen lds
    s_mov_b64 exec, -1
    s_waitcnt lgkmcnt(9)
    v_mfma_f32_32x32x16_bf16 v[80:95], a[4:7], a[20:23], v[80:95]
    ds_read_b64_tr_b16 a[4:5], v33 offset:12288
    ds_read_b64_tr_b16 a[6:7], v33 offset:13312
    s_waitcnt lgkmcnt(9)
    v_mfma_f32_32x32x16_bf16 v[96:111], a[8:11], a[20:23], v[96:111]
    ds_read_b64_tr_b16 a[8:9], v34 offset:12288
    ds_read_b64_tr_b16 a[10:11], v34 offset:13312
    s_add_u32 m0, s46, 19456
    s_add_u32 s3, s93, 46080
    s_mov_b64 exec, s[66:67]
    buffer_load_dwordx4 v18, s[8:11], s3 offen lds
    s_mov_b64 exec, -1
    s_add_u32 s92, s92, 128
    s_add_u32 s93, s93, 245760
    s_cmp_eq_u32 s92, 1280
    s_cselect_b32 s92, 0, s92
    s_cselect_b32 s93, 0, s93
    s_waitcnt lgkmcnt(9)
    v_mfma_f32_32x32x16_bf16 v[112:127], a[12:15], a[20:23], v[112:127]
    ds_read_b64_tr_b16 a[12:13], v35 offset:12288
    ds_read_b64_tr_b16 a[14:15], v35 offset:13312
    s_waitcnt lgkmcnt(9)
    v_mfma_f32_32x32x16_bf16 v[128:143], a[16:19], a[28:31], v[128:143]
    ds_read_b64_tr_b16 a[16:17], v37 offset:12288
    ds_read_b64_tr_b16 a[18:19], v37 offset:13312
    v_mfma_f32_32x32x16_bf16 v[144:159], a[20:23], a[20:23], v[144:159]
    s_waitcnt vmcnt(8)
    s_barrier
    ds_read_b128 a[20:23], v24 offset:32768
    s_waitcnt lgkmcnt(9)
    v_mfma_f32_32x32x16_bf16 v[64:79], a[0:3], a[24:27], v[64:79]
    ds_read_b64_tr_b16 a[0:1], v32 offset:32768
    ds_read_b64_tr_b16 a[2:3], v32 offset:33792
    s_add_u32 m0, s46, 32768
    s_add_u32 s3, s92, 0
    buffer_load_dwordx4 v16, s[4:7], s3 offen lds
    s_waitcnt lgkmcnt(9)
    v_mfma_f32_32x32x16_bf16 v[80:95], a[4:7], a[24:27], v[80:95]
    ds_read_b64_tr_b16 a[4:5], v33 offset:32768
    ds_read_b64_tr_b16 a[6:7], v33 offset:33792
    s_waitcnt lgkmcnt(9)
    v_mfma_f32_32x32x16_bf16 v[96:111], a[8:11], a[24:27], v[96:111]
    ds_read_b64_tr_b16 a[8:9], v34 offset:32768
    ds_read_b64_tr_b16 a[10:11], v34 offset:33792
    s_add_u32 m0, s46, 33792
    s_add_u32 s3, s92, 10240
    buffer_load_dwordx4 v17, s[4:7], s3 offen lds
    s_waitcnt lgkmcnt(9)
    v_mfma_f32_32x32x16_bf16 v[112:127], a[12:15], a[24:27], v[112:127]
    ds_read_b64_tr_b16 a[12:13], v35 offset:32768
    ds_read_b64_tr_b16 a[14:15], v35 offset:33792
    s_waitcnt lgkmcnt(9)
    v_mfma_f32_32x32x16_bf16 v[128:143], a[16:19], a[28:31], v[128:143]
    ds_read_b64_tr_b16 a[16:17], v37 offset:32768
    ds_read_b64_tr_b16 a[18:19], v37 offset:33792
    v_mfma_f32_32x32x16_bf16 v[144:159], a[24:27], a[24:27], v[144:159]
    ds_read_b128 a[24:27], v25 offset:32768
    s_waitcnt lgkmcnt(9)
    v_mfma_f32_32x32x16_bf16 v[64:79], a[0:3], a[20:23], v[64:79]
    ds_read_b64_tr_b16 a[0:1], v32 offset:36864
    ds_read_b64_tr_b16 a[2:3], v32 offset:37888
    s_add_u32 m0, s46, 34816
    s_add_u32 s3, s92, 20480
    buffer_load_dwordx4 v16, s[4:7], s3 offen lds
    s_waitcnt lgkmcnt(9)
    v_mfma_f32_32x32x16_bf16 v[80:95], a[4:7], a[20:23], v[80:95]
    ds_read_b64_tr_b16 a[4:5], v33 offset:36864
    ds_read_b64_tr_b16 a[6:7], v33 offset:37888
    s_waitcnt lgkmcnt(9)
    v_mfma_f32_32x32x16_bf16 v[96:111], a[8:11], a[20:23], v[96:111]
    ds_read_b64_tr_b16 a[8:9], v34 offset:36864
    ds_read_b64_tr_b16 a[10:11], v34 offset:37888
    s_add_u32 m0, s46, 35840
    s_add_u32 s3, s92, 30720
    buffer_load_dwordx4 v17, s[4:7], s3 offen lds
    s_waitcnt lgkmcnt(9)
    v_mfma_f32_32x32x16_bf16 v[112:127], a[12:15], a[20:23], v[112:127]
    ds_read_b64_tr_b16 a[12:13], v35 offset:36864
    ds_read_b64_tr_b16 a[14:15], v35 offset:37888
    s_waitcnt lgkmcnt(9)
    v_mfma_f32_32x32x16_bf16 v[128:143], a[16:19], a[28:31], v[128:143]
    ds_read_b64_tr_b16 a[16:17], v37 offset:36864
    ds_read_b64_tr_b16 a[18:19], v37 offset:37888
    v_mfma_f32_32x32x16_bf16 v[144:159], a[20:23], a[20:23], v[144:159]
    ds_read_b128 a[20:23], v26 offset:32768
    s_waitcnt lgkmcnt(9)
    v_mfma_f32_32x32x16_bf16 v[64:79], a[0:3], a[24:27], v[64:79]
    ds_read_b64_tr_b16 a[0:1], v32 offset:40960
    ds_read_b64_tr_b16 a[2:3], v32 offset:41984
    s_add_u32 m0, s46, 49152
    s_add_u32 s3, s93, 0
    s_mov_b64 exec, s[66:67]
    buffer_load_dwordx4 v18, s[8:11], s3 offen lds
    s_mov_b64 exec, -1
    s_waitcnt lgkmcnt(9)
    v_mfma_f32_32x32x16_bf16 v[80:95], a[4:7], a[24:27], v[80:95]
    ds_read_b64_tr_b16 a[4:5], v33 offset:40960
    ds_read_b64_tr_b16 a[6:7], v33 offset:41984
    s_waitcnt lgkmcnt(9)
    v_mfma_f32_32x32x16_bf16 v[96:111], a[8:11], a[24:27], v[96:111]
    ds_read_b64_tr_b16 a[8:9], v34 offset:40960
    ds_read_b64_tr_b16 a[10:11], v34 offset:41984
    s_add_u32 m0, s46, 50176
    s_add_u32 s3, s93, 15360
    s_mov_b64 exec, s[66:67]
    buffer_load_dwordx4 v18, s[8:11], s3 offen lds
    s_mov_b64 exec, -1
    s_waitcnt lgkmcnt(9)
    v_mfma_f32_32x32x16_bf16 v[112:127], a[12:15], a[24:27], v[112:127]
    ds_read_b64_tr_b16 a[12:13], v35 offset:40960
    ds_read_b64_tr_b16 a[14:15], v35 offset:41984
    s_add_u32 s3, s101, 7
    s_cmp_ge_u32 s3, 10
    s_cselect_b32 s99, 10, 0
    s_sub_u32 s3, s3, s99
    s_cmp_lg_u32 s3, s43
    s_cbranch_scc1 L_nores_12
    v_xor_b32 v45, 0, v19
    v_add_u32 v45, 0x10000, v45
    ds_read_b64 a[192:193], v45 offset:32768
    v_xor_b32 v45, 16, v19
    v_add_u32 v45, 0x10000, v45
    ds_read_b64 a[194:195], v45 offset:32768
    v_xor_b32 v45, 32, v19
    v_add_u32 v45, 0x10000, v45
    ds_read_b64 a[196:197], v45 offset:32768
    v_xor_b32 v45, 48, v19
    v_add_u32 v45, 0x10000, v45
    ds_read_b64 a[198:199], v45 offset:32768
    v_xor_b32 v45, 64, v19
    v_add_u32 v45, 0x10000, v45
    ds_read_b64 a[200:201], v45 offset:32768
    v_xor_b32 v45, 80, v19
    v_add_u32 v45, 0x10000, v45
    ds_read_b64 a[202:203], v45 offset:32768
    v_xor_b32 v45, 96, v19
    v_add_u32 v45, 0x10000, v45
    ds_read_b64 a[204:205], v45 offset:32768
    v_xor_b32 v45, 112, v19
    v_add_u32 v45, 0x10000, v45
    ds_read_b64 a[206:207], v45 offset:32768
    s_waitcnt lgkmcnt(0)
L_nores_12:
    s_waitcnt lgkmcnt(9)
    v_mfma_f32_32x32x16_bf16 v[128:143], a[16:19], a[28:31], v[128:143]
    ds_read_b64_tr_b16 a[16:17], v37 offset:40960
    ds_read_b64_tr_b16 a[18:19], v37 offset:41984
    v_mfma_f32_32x32x16_bf16 v[144:159], a[24:27], a[24:27], v[144:159]
    ds_read_b128 a[24:27], v27 offset:32768
    s_waitcnt lgkmcnt(9)
    v_mfma_f32_32x32x16_bf16 v[64:79], a[0:3], a[20:23], v[64:79]
    ds_read_b64_tr_b16 a[0:1], v32 offset:45056
    ds_read_b64_tr_b16 a[2:3], v32 offset:46080
    s_add_u32 m0, s46, 51200
    s_add_u32 s3, s93, 30720
    s_mov_b64 exec, s[66:67]
    buffer_load_dwordx4 v18, s[8:11], s3 offen lds
    s_mov_b64 exec, -1
    s_waitcnt lgkmcnt(9)
    v_mfma_f32_32x32x16_bf16 v[80:95], a[4:7], a[20:23], v[80:95]
    ds_read_b64_tr_b16 a[4:5], v33 offset:45056
    ds_read_b64_tr_b16 a[6:7], v33 offset:46080
    s_waitcnt lgkmcnt(9)
    v_mfma_f32_32x32x16_bf16 v[96:111], a[8:11], a[20:23], v[96:111]
    ds_read_b64_tr_b16 a[8:9], v34 offset:45056
    ds_read_b64_tr_b16 a[10:11], v34 offset:46080
    s_add_u32 m0, s46, 52224
    s_add_u32 s3, s93, 46080
    s_mov_b64 exec, s[66:67]
    buffer_load_dwordx4 v18, s[8:11], s3 offen lds
    s_mov_b64 exec, -1
    s_add_u32 s92, s92, 128
    s_add_u32 s93, s93, 245760
    s_cmp_eq_u32 s92, 1280
    s_cselect_b32 s92, 0, s92
    s_cselect_b32 s93, 0, s93
    s_waitcnt lgkmcnt(9)
    v_mfma_f32_32x32x16_bf16 v[112:127], a[12:15], a[20:23], v[112:127]
    ds_read_b64_tr_b16 a[12:13], v35 offset:45056
    ds_read_b64_tr_b16 a[14:15], v35 offset:46080
    s_waitcnt lgkmcnt(9)
    v_mfma_f32_32x32x16_bf16 v[128:143], a[16:19], a[28:31], v[128:143]
    ds_read_b64_tr_b16 a[16:17], v37 offset:45056
    ds_read_b64_tr_b16 a[18:19], v37 offset:46080
    v_mfma_f32_32x32x16_bf16 v[144:159], a[20:23], a[20:23], v[144:159]
    s_waitcnt vmcnt(8)
    s_barrier
    ds_read_b128 a[20:23], v20 offset:0
    s_waitcnt lgkmcnt(9)
    v_mfma_f32_32x32x16_bf16 v[64:79], a[0:3], a[24:27], v[64:79]
    ds_read_b64_tr_b16 a[0:1], v28 offset:0
    ds_read_b64_tr_b16 a[2:3], v28 offset:1024
    s_waitcnt lgkmcnt(9)
    v_mfma_f32_32x32x16_bf16 v[80:95], a[4:7], a[24:27], v[80:95]
    ds_read_b64_tr_b16 a[4:5], v29 offset:0
    ds_read_b64_tr_b16 a[6:7], v29 offset:1024
    s_waitcnt lgkmcnt(9)
    v_mfma_f32_32x32x16_bf16 v[96:111], a[8:11], a[24:27], v[96:111]
    ds_read_b64_tr_b16 a[8:9], v30 offset:0
    ds_read_b64_tr_b16 a[10:11], v30 offset:1024
    s_waitcnt lgkmcnt(9)
    v_mfma_f32_32x32x16_bf16 v[112:127], a[12:15], a[24:27], v[112:127]
    ds_read_b64_tr_b16 a[12:13], v31 offset:0
    ds_read_b64_tr_b16 a[14:15], v31 offset:1024
    s_waitcnt lgkmcnt(9)
    v_mfma_f32_32x32x16_bf16 v[128:143], a[16:19], a[28:31], v[128:143]
    ds_read_b64_tr_b16 a[16:17], v36 offset:0
    ds_read_b64_tr_b16 a[18:19], v36 offset:1024
    v_mfma_f32_32x32x16_bf16 v[144:159], a[24:27], a[24:27], v[144:159]
    ds_read_b128 a[24:27], v21 offset:0
    s_waitcnt lgkmcnt(9)
    v_mfma_f32_32x32x16_bf16 v[64:79], a[0:3], a[20:23], v[64:79]
    ds_read_b64_tr_b16 a[0:1], v28 offset:4096
    ds_read_b64_tr_b16 a[2:3], v28 offset:5120
    s_waitcnt lgkmcnt(9)
    v_mfma_f32_32x32x16_bf16 v[80:95], a[4:7], a[20:23], v[80:95]
    ds_read_b64_tr_b16 a[4:5], v29 offset:4096
    ds_read_b64_tr_b16 a[6:7], v29 offset:5120
    s_waitcnt lgkmcnt(9)
    v_mfma_f32_32x32x16_bf16 v[96:111], a[8:11], a[20:23], v[96:111]
    ds_read_b64_tr_b16 a[8:9], v30 offset:4096
    ds_read_b64_tr_b16 a[10:11], v30 offset:5120
    s_waitcnt lgkmcnt(9)
    v_mfma_f32_32x32x16_bf16 v[112:127], a[12:15], a[20:23], v[112:127]
    ds_read_b64_tr_b16 a[12:13], v31 offset:4096
    ds_read_b64_tr_b16 a[14:15], v31 offset:5120
    s_waitcnt lgkmcnt(9)
    v_mfma_f32_32x32x16_bf16 v[128:143], a[16:19], a[28:31], v[128:143]
    ds_read_b64_tr_b16 a[16:17], v36 offset:4096
    ds_read_b64_tr_b16 a[18:19], v36 offset:5120
    v_mfma_f32_32x32x16_bf16 v[144:159], a[20:23], a[20:23], v[144:159]
    ds_read_b128 a[20:23], v22 offset:0
    s_waitcnt lgkmcnt(9)
    v_mfma_f32_32x32x16_bf16 v[64:79], a[0:3], a[24:27], v[64:79]
    ds_read_b64_tr_b16 a[0:1], v28 offset:8192
    ds_read_b64_tr_b16 a[2:3], v28 offset:9216
    s_waitcnt lgkmcnt(9)
    v_mfma_f32_32x32x16_bf16 v[80:95], a[4:7], a[24:27], v[80:95]
    ds_read_b64_tr_b16 a[4:5], v29 offset:8192
    ds_read_b64_tr_b16 a[6:7], v29 offset:9216
    s_waitcnt lgkmcnt(9)
    v_mfma_f32_32x32x16_bf16 v[96:111], a[8:11], a[24:27], v[96:111]
    ds_read_b64_tr_b16 a[8:9], v30 offset:8192
    ds_read_b64_tr_b16 a[10:11], v30 offset:9216
    s_waitcnt lgkmcnt(9)
    v_mfma_f32_32x32x16_bf16 v[112:127], a[12:15], a[24:27], v[112:127]
    ds_read_b64_tr_b16 a[12:13], v31 offset:8192
    ds_read_b64_tr_b16 a[14:15], v31 offset:9216
    s_add_u32 s3, s101, 8
    s_cmp_ge_u32 s3, 10
    s_cselect_b32 s99, 10, 0
    s_sub_u32 s3, s3, s99
    s_cmp_lg_u32 s3, s43
    s_cbranch_scc1 L_nores_13
    v_xor_b32 v45, 0, v19
    ds_read_b64 a[192:193], v45 offset:0
    v_xor_b32 v45, 16, v19
    ds_read_b64 a[194:195], v45 offset:0
    v_xor_b32 v45, 32, v19
    ds_read_b64 a[196:197], v45 offset:0
    v_xor_b32 v45, 48, v19
    ds_read_b64 a[198:199], v45 offset:0
    v_xor_b32 v45, 64, v19
    ds_read_b64 a[200:201], v45 offset:0
    v_xor_b32 v45, 80, v19
    ds_read_b64 a[202:203], v45 offset:0
    v_xor_b32 v45, 96, v19
    ds_read_b64 a[204:205], v45 offset:0
    v_xor_b32 v45, 112, v19
    ds_read_b64 a[206:207], v45 offset:0
    s_waitcnt lgkmcnt(0)
L_nores_13:
    v_and_b32 v45, 15, v1
    v_lshlrev_b32 v45, 2, v45
    buffer_load_dword v42, v45, s[36:39], 0 offen sc1
    s_waitcnt lgkmcnt(9)
    v_mfma_f32_32x32x16_bf16 v[128:143], a[16:19], a[28:31], v[128:143]
    ds_read_b64_tr_b16 a[16:17], v36 offset:8192
    ds_read_b64_tr_b16 a[18:19], v36 offset:9216
    v_mfma_f32_32x32x16_bf16 v[144:159], a[24:27], a[24:27], v[144:159]
    ds_read_b128 a[24:27], v23 offset:0
    s_waitcnt lgkmcnt(9)
    v_mfma_f32_32x32x16_bf16 v[64:79], a[0:3], a[20:23], v[64:79]
    ds_read_b64_tr_b16 a[0:1], v28 offset:12288
    ds_read_b64_tr_b16 a[2:3], v28 offset:13312
    s_waitcnt lgkmcnt(9)
    v_mfma_f32_32x32x16_bf16 v[80:95], a[4:7], a[20:23], v[80:95]
    ds_read_b64_tr_b16 a[4:5], v29 offset:12288
    ds_read_b64_tr_b16 a[6:7], v29 offset:13312
    s_waitcnt lgkmcnt(9)
    v_mfma_f32_32x32x16_bf16 v[96:111], a[8:11], a[20:23], v[96:111]
    ds_read_b64_tr_b16 a[8:9], v30 offset:12288
    ds_read_b64_tr_b16 a[10:11], v30 offset:13312
    s_waitcnt lgkmcnt(9)
    v_mfma_f32_32x32x16_bf16 v[112:127], a[12:15], a[20:23], v[112:127]
    ds_read_b64_tr_b16 a[12:13], v31 offset:12288
    ds_read_b64_tr_b16 a[14:15], v31 offset:13312
    s_waitcnt lgkmcnt(9)
    v_mfma_f32_32x32x16_bf16 v[128:143], a[16:19], a[28:31], v[128:143]
    ds_read_b64_tr_b16 a[16:17], v36 offset:12288
    ds_read_b64_tr_b16 a[18:19], v36 offset:13312
    v_mfma_f32_32x32x16_bf16 v[144:159], a[20:23], a[20:23], v[144:159]
    s_waitcnt vmcnt(1)
    s_barrier
    ds_read_b128 a[20:23], v20 offset:32768
    s_waitcnt lgkmcnt(9)
    v_mfma_f32_32x32x16_bf16 v[64:79], a[0:3], a[24:27], v[64:79]
    ds_read_b64_tr_b16 a[0:1], v28 offset:32768
    ds_read_b64_tr_b16 a[2:3], v28 offset:33792
    s_waitcnt lgkmcnt(9)
    v_mfma_f32_32x32x16_bf16 v[80:95], a[4:7], a[24:27], v[80:95]
    ds_read_b64_tr_b16 a[4:5], v29 offset:32768
    ds_read_b64_tr_b16 a[6:7], v29 offset:33792
    s_waitcnt lgkmcnt(9)
    v_mfma_f32_32x32x16_bf16 v[96:111], a[8:11], a[24:27], v[96:111]
    ds_read_b64_tr_b16 a[8:9], v30 offset:32768
    ds_read_b64_tr_b16 a[10:11], v30 offset:33792
    s_waitcnt lgkmcnt(9)
    v_mfma_f32_32x32x16_bf16 v[112:127], a[12:15], a[24:27], v[112:127]
    ds_read_b64_tr_b16 a[12:13], v31 offset:32768
    ds_read_b64_tr_b16 a[14:15], v31 offset:33792
    s_waitcnt lgkmcnt(9)
    v_mfma_f32_32x32x16_bf16 v[128:143], a[16:19], a[28:31], v[128:143]
    ds_read_b64_tr_b16 a[16:17], v36 offset:32768
    ds_read_b64_tr_b16 a[18:19], v36 offset:33792
    v_mfma_f32_32x32x16_bf16 v[144:159], a[24:27], a[24:27], v[144:159]
    ds_read_b128 a[24:27], v21 offset:32768
    s_waitcnt lgkmcnt(9)
    v_mfma_f32_32x32x16_bf16 v[64:79], a[0:3], a[20:23], v[64:79]
    ds_read_b64_tr_b16 a[0:1], v28 offset:36864
    ds_read_b64_tr_b16 a[2:3], v28 offset:37888
    s_waitcnt lgkmcnt(9)
    v_mfma_f32_32x32x16_bf16 v[80:95], a[4:7], a[20:23], v[80:95]
    ds_read_b64_tr_b16 a[4:5], v29 offset:36864
    ds_read_b64_tr_b16 a[6:7], v29 offset:37888
    s_waitcnt lgkmcnt(9)
    v_mfma_f32_32x32x16_bf16 v[96:111], a[8:11], a[20:23], v[96:111]
    ds_read_b64_tr_b16 a[8:9], v30 offset:36864
    ds_read_b64_tr_b16 a[10:11], v30 offset:37888
    s_waitcnt lgkmcnt(9)
    v_mfma_f32_32x32x16_bf16 v[112:127], a[12:15], a[20:23], v[112:127]
    ds_read_b64_tr_b16 a[12:13], v31 offset:36864
    ds_read_b64_tr_b16 a[14:15], v31 offset:37888
    s_waitcnt lgkmcnt(9)
    v_mfma_f32_32x32x16_bf16 v[128:143], a[16:19], a[28:31], v[128:143]
    ds_read_b64_tr_b16 a[16:17], v36 offset:36864
    ds_read_b64_tr_b16 a[18:19], v36 offset:37888
    v_mfma_f32_32x32x16_bf16 v[144:159], a[20:23], a[20:23], v[144:159]
    ds_read_b128 a[20:23], v22 offset:32768
    s_waitcnt lgkmcnt(9)
    v_mfma_f32_32x32x16_bf16 v[64:79], a[0:3], a[24:27], v[64:79]
    ds_read_b64_tr_b16 a[0:1], v28 offset:40960
    ds_read_b64_tr_b16 a[2:3], v28 offset:41984
    s_waitcnt lgkmcnt(9)
    v_mfma_f32_32x32x16_bf16 v[80:95], a[4:7], a[24:27], v[80:95]
    ds_read_b64_tr_b16 a[4:5], v29 offset:40960
    ds_read_b64_tr_b16 a[6:7], v29 offset:41984
    s_waitcnt lgkmcnt(9)
    v_mfma_f32_32x32x16_bf16 v[96:111], a[8:11], a[24:27], v[96:111]
    ds_read_b64_tr_b16 a[8:9], v30 offset:40960
    ds_read_b64_tr_b16 a[10:11], v30 offset:41984
    s_waitcnt lgkmcnt(9)
    v_mfma_f32_32x32x16_bf16 v[112:127], a[12:15], a[24:27], v[112:127]
    ds_read_b64_tr_b16 a[12:13], v31 offset:40960
    ds_read_b64_tr_b16 a[14:15], v31 offset:41984
    s_add_u32 s3, s101, 9
    s_cmp_ge_u32 s3, 10
    s_cselect_b32 s99, 10, 0
    s_sub_u32 s3, s3, s99
    s_cmp_lg_u32 s3, s43
    s_cbranch_scc1 L_nores_14
    v_xor_b32 v45, 0, v19
    ds_read_b64 a[192:193], v45 offset:32768
    v_xor_b32 v45, 16, v19
    ds_read_b64 a[194:195], v45 offset:32768
    v_xor_b32 v45, 32, v19
    ds_read_b64 a[196:197], v45 offset:32768
    v_xor_b32 v45, 48, v19
    ds_read_b64 a[198:199], v45 offset:32768
    v_xor_b32 v45, 64, v19
    ds_read_b64 a[200:201], v45 offset:32768
    v_xor_b32 v45, 80, v19
    ds_read_b64 a[202:203], v45 offset:32768
    v_xor_b32 v45, 96, v19
    ds_read_b64 a[204:205], v45 offset:32768
    v_xor_b32 v45, 112, v19
    ds_read_b64 a[206:207], v45 offset:32768
    s_waitcnt lgkmcnt(0)
L_nores_14:
    s_waitcnt lgkmcnt(9)
    v_mfma_f32_32x32x16_bf16 v[128:143], a[16:19], a[28:31], v[128:143]
    ds_read_b64_tr_b16 a[16:17], v36 offset:40960
    ds_read_b64_tr_b16 a[18:19], v36 offset:41984
    v_mfma_f32_32x32x16_bf16 v[144:159], a[24:27], a[24:27], v[144:159]
    ds_read_b128 a[24:27], v23 offset:32768
    s_waitcnt lgkmcnt(9)
    v_mfma_f32_32x32x16_bf16 v[64:79], a[0:3], a[20:23], v[64:79]
    ds_read_b64_tr_b16 a[0:1], v28 offset:45056
    ds_read_b64_tr_b16 a[2:3], v28 offset:46080
    s_waitcnt lgkmcnt(9)
    v_mfma_f32_32x32x16_bf16 v[80:95], a[4:7], a[20:23], v[80:95]
    ds_read_b64_tr_b16 a[4:5], v29 offset:45056
    ds_read_b64_tr_b16 a[6:7], v29 offset:46080
    s_waitcnt lgkmcnt(9)
    v_mfma_f32_32x32x16_bf16 v[96:111], a[8:11], a[20:23], v[96:111]
    ds_read_b64_tr_b16 a[8:9], v30 offset:45056
    ds_read_b64_tr_b16 a[10:11], v30 offset:46080
    s_waitcnt lgkmcnt(9)
    v_mfma_f32_32x32x16_bf16 v[112:127], a[12:15], a[20:23], v[112:127]
    ds_read_b64_tr_b16 a[12:13], v31 offset:45056
    ds_read_b64_tr_b16 a[14:15], v31 offset:46080
    s_waitcnt lgkmcnt(9)
    v_mfma_f32_32x32x16_bf16 v[128:143], a[16:19], a[28:31], v[128:143]
    ds_read_b64_tr_b16 a[16:17], v36 offset:45056
    ds_read_b64_tr_b16 a[18:19], v36 offset:46080
    v_mfma_f32_32x32x16_bf16 v[144:159], a[20:23], a[20:23], v[144:159]
    s_waitcnt lgkmcnt(8)
    v_mfma_f32_32x32x16_bf16 v[64:79], a[0:3], a[24:27], v[64:79]
    s_waitcnt lgkmcnt(6)
    v_mfma_f32_32x32x16_bf16 v[80:95], a[4:7], a[24:27], v[80:95]
    s_waitcnt lgkmcnt(4)
    v_mfma_f32_32x32x16_bf16 v[96:111], a[8:11], a[24:27], v[96:111]
    s_waitcnt lgkmcnt(2)
    v_mfma_f32_32x32x16_bf16 v[112:127], a[12:15], a[24:27], v[112:127]
    s_waitcnt lgkmcnt(0)
    v_mfma_f32_32x32x16_bf16 v[128:143], a[16:19], a[28:31], v[128:143]
    v_mfma_f32_32x32x16_bf16 v[144:159], a[24:27], a[24:27], v[144:159]
    v_lshrrev_b32 v4, 3, v2
    v_and_b32 v5, 3, v2
    v_cmp_eq_u32 s[48:49], 1, v4
    v_cmp_eq_u32 s[50:51], 2, v4
    v_cmp_eq_u32 s[52:53], 3, v4
    v_cmp_eq_u32 s[54:55], 1, v5
    v_cmp_eq_u32 s[56:57], 2, v5
    v_cmp_eq_u32 s[58:59], 3, v5
    v_bfe_u32 v7, v2, 2, 1
    v_cmp_eq_u32 s[60:61], 1, v7
    v_mov_b32 v14, 0x3fb8aa3b
    v_mov_b32 v12, s69
    s_mov_b32 exec_lo, 1
    s_mov_b32 exec_hi, 1
    ds_write_b128 v224, v[128:131] offset:0
    ds_write_b128 v224, v[132:135] offset:32
    ds_write_b128 v224, v[136:139] offset:64
    ds_write_b128 v224, v[140:143] offset:96
    s_mov_b64 exec, -1
    v_cndmask_b32 v144, v144, v148, s[48:49]
    v_cndmask_b32 v144, v144, v152, s[50:51]
    v_cndmask_b32 v144, v144, v156, s[52:53]
    v_cndmask_b32 v145, v145, v149, s[48:49]
    v_cndmask_b32 v145, v145, v153, s[50:51]
    v_cndmask_b32 v145, v145, v157, s[52:53]
    v_cndmask_b32 v146, v146, v150, s[48:49]
    v_cndmask_b32 v146, v146, v154, s[50:51]
    v_cndmask_b32 v146, v146, v158, s[52:53]
    v_cndmask_b32 v147, v147, v151, s[48:49]
    v_cndmask_b32 v147, v147, v155, s[50:51]
    v_cndmask_b32 v147, v147, v159, s[52:53]
    v_cndmask_b32 v144, v144, v145, s[54:55]
    v_cndmask_b32 v144, v144, v146, s[56:57]
    v_cndmask_b32 v144, v144, v147, s[58:59]
    v_mov_b32 v6, v144
    v_mov_b32 v7, v144
    v_mul_f32 v8, s70, v124
    s_nop 0
    v_permlane32_swap_b32 v6, v7
    v_cndmask_b32 v6, v6, v7, s[60:61]
    v_mul_f32 v6, s70, v6
    v_fma_f32 v6, -v8, v8, v6
    v_max_f32 v6, 0, v6
    v_add_f32 v6, s71, v6
    v_rsq_f32 v10, v6
    v_sub_f32 v8, 0, v8
    s_waitcnt lgkmcnt(0)
    s_barrier
    v_mul_f32 v14, v14, v10
    ds_read_b128 v[160:163], v225 offset:0
    ds_read_b128 v[164:167], v225 offset:32
    ds_read_b128 v[168:171], v225 offset:64
    ds_read_b128 v[172:175], v225 offset:96
    ds_read_b128 v[176:179], v225 offset:128
    ds_read_b128 v[180:183], v225 offset:160
    ds_read_b128 v[184:187], v225 offset:192
    ds_read_b128 v[188:191], v225 offset:224
    ds_read_b128 v[192:195], v225 offset:256
    ds_read_b128 v[196:199], v225 offset:288
    s_waitcnt lgkmcnt(9)
    v_pk_fma_f32 v[64:65], v[160:161], v[8:9], v[64:65] op_sel_hi:[1,0,1]
    v_pk_fma_f32 v[66:67], v[162:163], v[8:9], v[66:67] op_sel_hi:[1,0,1]
    v_min_f32 v4, 0, v64
    v_min_f32 v5, 0, v65
    v_pk_mul_f32 v[4:5], v[4:5], v[14:15] op_sel_hi:[1,0]
    v_max_f32 v64, 0, v64
    v_exp_f32 v4, v4
    v_exp_f32 v5, v5
    v_max_f32 v65, 0, v65
    v_pk_fma_f32 v[64:65], v[64:65], v[10:11], v[12:13] op_sel_hi:[1,0,0]
    v_pk_add_f32 v[64:65], v[64:65], v[4:5]
    v_min_f32 v6, 0, v66
    v_min_f32 v7, 0, v67
    v_pk_mul_f32 v[6:7], v[6:7], v[14:15] op_sel_hi:[1,0]
    v_max_f32 v66, 0, v66
    v_exp_f32 v6, v6
    v_exp_f32 v7, v7
    v_max_f32 v67, 0, v67
    v_pk_fma_f32 v[66:67], v[66:67], v[10:11], v[12:13] op_sel_hi:[1,0,0]
    v_pk_add_f32 v[66:67], v[66:67], v[6:7]
    s_waitcnt lgkmcnt(8)
    v_pk_fma_f32 v[68:69], v[164:165], v[8:9], v[68:69] op_sel_hi:[1,0,1]
    v_pk_fma_f32 v[70:71], v[166:167], v[8:9], v[70:71] op_sel_hi:[1,0,1]
    v_min_f32 v4, 0, v68
    v_min_f32 v5, 0, v69
    v_pk_mul_f32 v[4:5], v[4:5], v[14:15] op_sel_hi:[1,0]
    v_max_f32 v68, 0, v68
    v_exp_f32 v4, v4
    v_exp_f32 v5, v5
    v_max_f32 v69, 0, v69
    v_pk_fma_f32 v[68:69], v[68:69], v[10:11], v[12:13] op_sel_hi:[1,0,0]
    v_pk_add_f32 v[68:69], v[68:69], v[4:5]
    v_min_f32 v6, 0, v70
    v_min_f32 v7, 0, v71
    v_pk_mul_f32 v[6:7], v[6:7], v[14:15] op_sel_hi:[1,0]
    v_max_f32 v70, 0, v70
    v_exp_f32 v6, v6
    v_exp_f32 v7, v7
    v_max_f32 v71, 0, v71
    v_pk_fma_f32 v[70:71], v[70:71], v[10:11], v[12:13] op_sel_hi:[1,0,0]
    v_pk_add_f32 v[70:71], v[70:71], v[6:7]
    s_waitcnt lgkmcnt(7)
    v_pk_fma_f32 v[72:73], v[168:169], v[8:9], v[72:73] op_sel_hi:[1,0,1]
    v_pk_fma_f32 v[74:75], v[170:171], v[8:9], v[74:75] op_sel_hi:[1,0,1]
    v_min_f32 v4, 0, v72
    v_min_f32 v5, 0, v73
    v_pk_mul_f32 v[4:5], v[4:5], v[14:15] op_sel_hi:[1,0]
    v_max_f32 v72, 0, v72
    v_exp_f32 v4, v4
    v_exp_f32 v5, v5
    v_max_f32 v73, 0, v73
    v_pk_fma_f32 v[72:73], v[72:73], v[10:11], v[12:13] op_sel_hi:[1,0,0]
    v_pk_add_f32 v[72:73], v[72:73], v[4:5]
    v_min_f32 v6, 0, v74
    v_min_f32 v7, 0, v75
    v_pk_mul_f32 v[6:7], v[6:7], v[14:15] op_sel_hi:[1,0]
    v_max_f32 v74, 0, v74
    v_exp_f32 v6, v6
    v_exp_f32 v7, v7
    v_max_f32 v75, 0, v75
    v_pk_fma_f32 v[74:75], v[74:75], v[10:11], v[12:13] op_sel_hi:[1,0,0]
    v_pk_add_f32 v[74:75], v[74:75], v[6:7]
    s_waitcnt lgkmcnt(6)
    v_pk_fma_f32 v[76:77], v[172:173], v[8:9], v[76:77] op_sel_hi:[1,0,1]
    v_pk_fma_f32 v[78:79], v[174:175], v[8:9], v[78:79] op_sel_hi:[1,0,1]
    v_min_f32 v4, 0, v76
    v_min_f32 v5, 0, v77
    v_pk_mul_f32 v[4:5], v[4:5], v[14:15] op_sel_hi:[1,0]
    v_max_f32 v76, 0, v76
    v_exp_f32 v4, v4
    v_exp_f32 v5, v5
    v_max_f32 v77, 0, v77
    v_pk_fma_f32 v[76:77], v[76:77], v[10:11], v[12:13] op_sel_hi:[1,0,0]
    v_pk_add_f32 v[76:77], v[76:77], v[4:5]
    v_min_f32 v6, 0, v78
    v_min_f32 v7, 0, v79
    v_pk_mul_f32 v[6:7], v[6:7], v[14:15] op_sel_hi:[1,0]
    v_max_f32 v78, 0, v78
    v_exp_f32 v6, v6
    v_exp_f32 v7, v7
    v_max_f32 v79, 0, v79
    v_pk_fma_f32 v[78:79], v[78:79], v[10:11], v[12:13] op_sel_hi:[1,0,0]
    v_pk_add_f32 v[78:79], v[78:79], v[6:7]
    s_waitcnt lgkmcnt(5)
    v_pk_fma_f32 v[80:81], v[176:177], v[8:9], v[80:81] op_sel_hi:[1,0,1]
    v_pk_fma_f32 v[82:83], v[178:179], v[8:9], v[82:83] op_sel_hi:[1,0,1]
    v_min_f32 v4, 0, v80
    v_min_f32 v5, 0, v81
    v_pk_mul_f32 v[4:5], v[4:5], v[14:15] op_sel_hi:[1,0]
    v_max_f32 v80, 0, v80
    v_exp_f32 v4, v4
    v_exp_f32 v5, v5
    v_max_f32 v81, 0, v81
    v_pk_fma_f32 v[80:81], v[80:81], v[10:11], v[12:13] op_sel_hi:[1,0,0]
    v_pk_add_f32 v[80:81], v[80:81], v[4:5]
    v_min_f32 v6, 0, v82
    v_min_f32 v7, 0, v83
    v_pk_mul_f32 v[6:7], v[6:7], v[14:15] op_sel_hi:[1,0]
    v_max_f32 v82, 0, v82
    v_exp_f32 v6, v6
    v_exp_f32 v7, v7
    v_max_f32 v83, 0, v83
    v_pk_fma_f32 v[82:83], v[82:83], v[10:11], v[12:13] op_sel_hi:[1,0,0]
    v_pk_add_f32 v[82:83], v[82:83], v[6:7]
    s_waitcnt lgkmcnt(4)
    v_pk_fma_f32 v[84:85], v[180:181], v[8:9], v[84:85] op_sel_hi:[1,0,1]
    v_pk_fma_f32 v[86:87], v[182:183], v[8:9], v[86:87] op_sel_hi:[1,0,1]
    v_pk_mul_f32 v[84:85], v[84:85], v[10:11] op_sel_hi:[1,0]
    v_pk_mul_f32 v[86:87], v[86:87], v[10:11] op_sel_hi:[1,0]
    s_waitcnt lgkmcnt(3)
    v_pk_fma_f32 v[88:89], v[184:185], v[8:9], v[88:89] op_sel_hi:[1,0,1]
    v_pk_fma_f32 v[90:91], v[186:187], v[8:9], v[90:91] op_sel_hi:[1,0,1]
    v_pk_mul_f32 v[88:89], v[88:89], v[10:11] op_sel_hi:[1,0]
    v_pk_mul_f32 v[90:91], v[90:91], v[10:11] op_sel_hi:[1,0]
    s_waitcnt lgkmcnt(2)
    v_pk_fma_f32 v[92:93], v[188:189], v[8:9], v[92:93] op_sel_hi:[1,0,1]
    v_pk_fma_f32 v[94:95], v[190:191], v[8:9], v[94:95] op_sel_hi:[1,0,1]
    v_pk_mul_f32 v[92:93], v[92:93], v[10:11] op_sel_hi:[1,0]
    v_pk_mul_f32 v[94:95], v[94:95], v[10:11] op_sel_hi:[1,0]
    s_waitcnt lgkmcnt(1)
    v_pk_fma_f32 v[96:97], v[192:193], v[8:9], v[96:97] op_sel_hi:[1,0,1]
    v_pk_fma_f32 v[98:99], v[194:195], v[8:9], v[98:99] op_sel_hi:[1,0,1]
    v_pk_mul_f32 v[96:97], v[96:97], v[10:11] op_sel_hi:[1,0]
    v_pk_mul_f32 v[98:99], v[98:99], v[10:11] op_sel_hi:[1,0]
    s_waitcnt lgkmcnt(0)
    v_pk_fma_f32 v[100:101], v[196:197], v[8:9], v[100:101] op_sel_hi:[1,0,1]
    v_pk_fma_f32 v[102:103], v[198:199], v[8:9], v[102:103] op_sel_hi:[1,0,1]
    v_pk_mul_f32 v[100:101], v[100:101], v[10:11] op_sel_hi:[1,0]
    v_pk_mul_f32 v[102:103], v[102:103], v[10:11] op_sel_hi:[1,0]
    v_cvt_pk_bf16_f32 v4, v64, v65
    v_cvt_pk_bf16_f32 v5, v66, v67
    ds_write_b64 v226, v[4:5] offset:0
    v_cvt_pk_bf16_f32 v6, v68, v69
    v_cvt_pk_bf16_f32 v7, v70, v71
    ds_write_b64 v226, v[6:7] offset:16
    v_cvt_pk_bf16_f32 v4, v72, v73
    v_cvt_pk_bf16_f32 v5, v74, v75
    ds_write_b64 v226, v[4:5] offset:32
    v_cvt_pk_bf16_f32 v6, v76, v77
    v_cvt_pk_bf16_f32 v7, v78, v79
    ds_write_b64 v226, v[6:7] offset:48
    v_cvt_pk_bf16_f32 v4, v80, v81
    v_cvt_pk_bf16_f32 v5, v82, v83
    ds_write_b64 v226, v[4:5] offset:64
    v_cvt_pk_bf16_f32 v6, v84, v85
    v_cvt_pk_bf16_f32 v7, v86, v87
    ds_write_b64 v226, v[6:7] offset:80
    v_cvt_pk_bf16_f32 v4, v88, v89
    v_cvt_pk_bf16_f32 v5, v90, v91
    ds_write_b64 v226, v[4:5] offset:96
    v_cvt_pk_bf16_f32 v6, v92, v93
    v_cvt_pk_bf16_f32 v7, v94, v95
    ds_write_b64 v226, v[6:7] offset:112
    v_cvt_pk_bf16_f32 v4, v96, v97
    v_cvt_pk_bf16_f32 v5, v98, v99
    ds_write_b64 v226, v[4:5] offset:128
    v_cvt_pk_bf16_f32 v6, v100, v101
    v_cvt_pk_bf16_f32 v7, v102, v103
    ds_write_b64 v226, v[6:7] offset:144
    s_waitcnt lgkmcnt(0)
    s_barrier
    ds_read_b64_tr_b16 a[32:33], v227 offset:0
    ds_read_b64_tr_b16 a[34:35], v227 offset:2560
    ds_read_b64_tr_b16 a[36:37], v228 offset:0
    ds_read_b64_tr_b16 a[38:39], v228 offset:2560
    ds_read_b64_tr_b16 a[40:41], v229 offset:0
    ds_read_b64_tr_b16 a[42:43], v229 offset:2560
    ds_read_b64_tr_b16 a[44:45], v230 offset:0
    ds_read_b64_tr_b16 a[46:47], v230 offset:2560
    ds_read_b64_tr_b16 a[48:49], v227 offset:5120
    ds_read_b64_tr_b16 a[50:51], v227 offset:7680
    ds_read_b64_tr_b16 a[52:53], v228 offset:5120
    ds_read_b64_tr_b16 a[54:55], v228 offset:7680
    ds_read_b64_tr_b16 a[56:57], v229 offset:5120
    ds_read_b64_tr_b16 a[58:59], v229 offset:7680
    ds_read_b64_tr_b16 a[60:61], v230 offset:5120
    ds_read_b64_tr_b16 a[62:63], v230 offset:7680
    s_waitcnt lgkmcnt(12)
    v_mfma_f32_16x16x32_bf16 v[160:163], a[32:35], a[36:39], 0
    s_waitcnt lgkmcnt(8)
    v_mfma_f32_16x16x32_bf16 v[164:167], a[40:43], a[44:47], 0
    v_mfma_f32_16x16x32_bf16 v[168:171], a[40:43], a[28:31], 0
    ds_read_b64_tr_b16 a[64:65], v227 offset:10240
    ds_read_b64_tr_b16 a[66:67], v227 offset:12800
    ds_read_b64_tr_b16 a[68:69], v228 offset:10240
    ds_read_b64_tr_b16 a[70:71], v228 offset:12800
    ds_read_b64_tr_b16 a[72:73], v229 offset:10240
    ds_read_b64_tr_b16 a[74:75], v229 offset:12800
    ds_read_b64_tr_b16 a[76:77], v230 offset:10240
    ds_read_b64_tr_b16 a[78:79], v230 offset:12800
    s_waitcnt lgkmcnt(12)
    v_mfma_f32_16x16x32_bf16 v[160:163], a[48:51], a[52:55], v[160:163]
    s_waitcnt lgkmcnt(8)
    v_mfma_f32_16x16x32_bf16 v[164:167], a[56:59], a[60:63], v[164:167]
    v_mfma_f32_16x16x32_bf16 v[168:171], a[56:59], a[28:31], v[168:171]
    ds_read_b64_tr_b16 a[80:81], v227 offset:15360
    ds_read_b64_tr_b16 a[82:83], v227 offset:17920
    ds_read_b64_tr_b16 a[84:85], v228 offset:15360
    ds_read_b64_tr_b16 a[86:87], v228 offset:17920
    ds_read_b64_tr_b16 a[88:89], v229 offset:15360
    ds_read_b64_tr_b16 a[90:91], v229 offset:17920
    ds_read_b64_tr_b16 a[92:93], v230 offset:15360
    ds_read_b64_tr_b16 a[94:95], v230 offset:17920
    s_waitcnt lgkmcnt(12)
    v_mfma_f32_16x16x32_bf16 v[160:163], a[64:67], a[68:71], v[160:163]
    s_waitcnt lgkmcnt(8)
    v_mfma_f32_16x16x32_bf16 v[164:167], a[72:75], a[76:79], v[164:167]
    v_mfma_f32_16x16x32_bf16 v[168:171], a[72:75], a[28:31], v[168:171]
    s_waitcnt lgkmcnt(4)
    v_mfma_f32_16x16x32_bf16 v[160:163], a[80:83], a[84:87], v[160:163]
    s_waitcnt lgkmcnt(0)
    v_mfma_f32_16x16x32_bf16 v[164:167], a[88:91], a[92:95], v[164:167]
    v_mfma_f32_16x16x32_bf16 v[168:171], a[88:91], a[28:31], v[168:171]
    s_lshl_b32 s54, s42, 16
    s_lshl_b32 s55, s41, 12
    s_add_u32 s54, s54, s55
    s_add_u32 s54, s54, 196608
    s_waitcnt vmcnt(0)
    v_cmp_eq_u32 vcc, 1, v42
    s_mov_b32 s100, 0
    s_nop 0
    s_cmp_eq_u64 vcc, -1
    s_cbranch_scc1 L_flagok_15
    v_and_b32 v45, 15, v1
    v_lshlrev_b32 v45, 2, v45
L_flagspin_16:
    buffer_load_dword v42, v45, s[36:39], 0 offen sc1
    s_add_u32 s100, s100, 1
    s_waitcnt vmcnt(0)
    v_cmp_eq_u32 vcc, 1, v42
    s_cmp_ge_u32 s100, 400000
    s_cbranch_scc1 L_flagok_15
    s_cmp_eq_u64 vcc, -1
    s_cbranch_scc0 L_flagspin_16
L_flagok_15:
    ds_write_b128 v231, v[160:163]
    ds_write_b128 v232, v[164:167]
    ds_write_b128 v233, v[168:171]
    s_waitcnt lgkmcnt(0)
    s_barrier
    v_lshlrev_b32 v4, 4, v0
    v_add_u32 v5, 159232, v4
    v_cmp_gt_u32 vcc, 216, v0
    ds_read_b128 v[20:23], v5
    v_mov_b32 v6, 2147483648
    s_waitcnt lgkmcnt(0)
    v_cndmask_b32 v4, v6, v4, vcc
    buffer_store_dwordx4 v[20:23], v4, s[32:35], s54 offen sc1
    ds_read_b128 v[192:195], v225 offset:320
    ds_read_b128 v[196:199], v225 offset:352
    ds_read_b128 v[200:203], v225 offset:384
    ds_read_b128 v[204:207], v225 offset:416
    ds_read_b128 v[208:211], v225 offset:448
    s_waitcnt lgkmcnt(4)
    v_pk_fma_f32 v[104:105], v[192:193], v[8:9], v[104:105] op_sel_hi:[1,0,1]
    v_pk_fma_f32 v[106:107], v[194:195], v[8:9], v[106:107] op_sel_hi:[1,0,1]
    v_min_f32 v4, 0, v104
    v_min_f32 v5, 0, v105
    v_pk_mul_f32 v[4:5], v[4:5], v[14:15] op_sel_hi:[1,0]
    v_max_f32 v104, 0, v104
    v_exp_f32 v4, v4
    v_exp_f32 v5, v5
    v_max_f32 v105, 0, v105
    v_pk_fma_f32 v[104:105], v[104:105], v[10:11], v[12:13] op_sel_hi:[1,0,0]
    v_pk_add_f32 v[104:105], v[104:105], v[4:5]
    v_min_f32 v6, 0, v106
    v_min_f32 v7, 0, v107
    v_pk_mul_f32 v[6:7], v[6:7], v[14:15] op_sel_hi:[1,0]
    v_max_f32 v106, 0, v106
    v_exp_f32 v6, v6
    v_exp_f32 v7, v7
    v_max_f32 v107, 0, v107
    v_pk_fma_f32 v[106:107], v[106:107], v[10:11], v[12:13] op_sel_hi:[1,0,0]
    v_pk_add_f32 v[106:107], v[106:107], v[6:7]
    s_waitcnt lgkmcnt(3)
    v_pk_fma_f32 v[108:109], v[196:197], v[8:9], v[108:109] op_sel_hi:[1,0,1]
    v_pk_fma_f32 v[110:111], v[198:199], v[8:9], v[110:111] op_sel_hi:[1,0,1]
    v_min_f32 v4, 0, v108
    v_min_f32 v5, 0, v109
    v_pk_mul_f32 v[4:5], v[4:5], v[14:15] op_sel_hi:[1,0]
    v_max_f32 v108, 0, v108
    v_exp_f32 v4, v4
    v_exp_f32 v5, v5
    v_max_f32 v109, 0, v109
    v_pk_fma_f32 v[108:109], v[108:109], v[10:11], v[12:13] op_sel_hi:[1,0,0]
    v_pk_add_f32 v[108:109], v[108:109], v[4:5]
    v_min_f32 v6, 0, v110
    v_min_f32 v7, 0, v111
    v_pk_mul_f32 v[6:7], v[6:7], v[14:15] op_sel_hi:[1,0]
    v_max_f32 v110, 0, v110
    v_exp_f32 v6, v6
    v_exp_f32 v7, v7
    v_max_f32 v111, 0, v111
    v_pk_fma_f32 v[110:111], v[110:111], v[10:11], v[12:13] op_sel_hi:[1,0,0]
    v_pk_add_f32 v[110:111], v[110:111], v[6:7]
    s_waitcnt lgkmcnt(2)
    v_pk_fma_f32 v[112:113], v[200:201], v[8:9], v[112:113] op_sel_hi:[1,0,1]
    v_pk_fma_f32 v[114:115], v[202:203], v[8:9], v[114:115] op_sel_hi:[1,0,1]
    v_min_f32 v4, 0, v112
    v_min_f32 v5, 0, v113
    v_pk_mul_f32 v[4:5], v[4:5], v[14:15] op_sel_hi:[1,0]
    v_max_f32 v112, 0, v112
    v_exp_f32 v4, v4
    v_exp_f32 v5, v5
    v_max_f32 v113, 0, v113
    v_pk_fma_f32 v[112:113], v[112:113], v[10:11], v[12:13] op_sel_hi:[1,0,0]
    v_pk_add_f32 v[112:113], v[112:113], v[4:5]
    v_min_f32 v6, 0, v114
    v_min_f32 v7, 0, v115
    v_pk_mul_f32 v[6:7], v[6:7], v[14:15] op_sel_hi:[1,0]
    v_max_f32 v114, 0, v114
    v_exp_f32 v6, v6
    v_exp_f32 v7, v7
    v_max_f32 v115, 0, v115
    v_pk_fma_f32 v[114:115], v[114:115], v[10:11], v[12:13] op_sel_hi:[1,0,0]
    v_pk_add_f32 v[114:115], v[114:115], v[6:7]
    s_waitcnt lgkmcnt(1)
    v_pk_fma_f32 v[116:117], v[204:205], v[8:9], v[116:117] op_sel_hi:[1,0,1]
    v_pk_fma_f32 v[118:119], v[206:207], v[8:9], v[118:119] op_sel_hi:[1,0,1]
    v_min_f32 v4, 0, v116
    v_min_f32 v5, 0, v117
    v_pk_mul_f32 v[4:5], v[4:5], v[14:15] op_sel_hi:[1,0]
    v_max_f32 v116, 0, v116
    v_exp_f32 v4, v4
    v_exp_f32 v5, v5
    v_max_f32 v117, 0, v117
    v_pk_fma_f32 v[116:117], v[116:117], v[10:11], v[12:13] op_sel_hi:[1,0,0]
    v_pk_add_f32 v[116:117], v[116:117], v[4:5]
    v_min_f32 v6, 0, v118
    v_min_f32 v7, 0, v119
    v_pk_mul_f32 v[6:7], v[6:7], v[14:15] op_sel_hi:[1,0]
    v_max_f32 v118, 0, v118
    v_exp_f32 v6, v6
    v_exp_f32 v7, v7
    v_max_f32 v119, 0, v119
    v_pk_fma_f32 v[118:119], v[118:119], v[10:11], v[12:13] op_sel_hi:[1,0,0]
    v_pk_add_f32 v[118:119], v[118:119], v[6:7]
    s_waitcnt lgkmcnt(0)
    v_pk_fma_f32 v[120:121], v[208:209], v[8:9], v[120:121] op_sel_hi:[1,0,1]
    v_pk_fma_f32 v[122:123], v[210:211], v[8:9], v[122:123] op_sel_hi:[1,0,1]
    v_min_f32 v4, 0, v120
    v_min_f32 v5, 0, v121
    v_pk_mul_f32 v[4:5], v[4:5], v[14:15] op_sel_hi:[1,0]
    v_max_f32 v120, 0, v120
    v_exp_f32 v4, v4
    v_exp_f32 v5, v5
    v_max_f32 v121, 0, v121
    v_pk_fma_f32 v[120:121], v[120:121], v[10:11], v[12:13] op_sel_hi:[1,0,0]
    v_pk_add_f32 v[120:121], v[120:121], v[4:5]
    v_min_f32 v6, 0, v122
    v_min_f32 v7, 0, v123
    v_pk_mul_f32 v[6:7], v[6:7], v[14:15] op_sel_hi:[1,0]
    v_max_f32 v122, 0, v122
    v_exp_f32 v6, v6
    v_exp_f32 v7, v7
    v_max_f32 v123, 0, v123
    v_pk_fma_f32 v[122:123], v[122:123], v[10:11], v[12:13] op_sel_hi:[1,0,0]
    v_pk_add_f32 v[122:123], v[122:123], v[6:7]
    v_cvt_pk_bf16_f32 v176, v104, v105
    v_cvt_pk_bf16_f32 v177, v106, v107
    v_cvt_pk_bf16_f32 v178, v108, v109
    v_cvt_pk_bf16_f32 v179, v110, v111
    v_cvt_pk_bf16_f32 v180, v112, v113
    v_cvt_pk_bf16_f32 v181, v114, v115
    v_cvt_pk_bf16_f32 v182, v116, v117
    v_cvt_pk_bf16_f32 v183, v118, v119
    v_cvt_pk_bf16_f32 v184, v120, v121
    v_cvt_pk_bf16_f32 v185, v122, v123
    v_cvt_pk_bf16_f32 v186, v124, v125
    v_cvt_pk_bf16_f32 v187, v126, v127
    s_lshl_b32 s63, s42, 11
    v_lshlrev_b32 v46, 7, v1
    v_add_u32 v46, s63, v46
    v_mov_b32 v47, 1
    s_waitcnt vmcnt(0)
    s_barrier
    s_cmp_lg_u32 s40, 0
    s_cbranch_scc1 L_arr_17
    s_mov_b64 exec, 0xffff
    buffer_atomic_add v47, v46, s[32:35], 0 offen
    s_mov_b64 exec, -1
L_arr_17:
    s_cmp_ge_u32 s45, 7
    s_cbranch_scc1 L_ringI_19
    s_cmp_ge_u32 s45, 5
    s_cbranch_scc1 L_ringM_18
    s_add_u32 m0, s46, 0
    s_mul_i32 s99, s94, 171
    s_lshr_b32 s99, s99, 9
    s_mul_i32 s99, s99, -10240
    s_mul_i32 s3, s94, 20480
    s_add_u32 s99, s99, s3
    s_mov_b32 s3, s99
    buffer_load_dwordx4 v48, s[12:15], s3 offen lds
    s_add_u32 m0, s46, 1024
    s_add_u32 s3, s99, 10240
    buffer_load_dwordx4 v48, s[12:15], s3 offen lds
    s_add_u32 m0, s46, 2048
    s_add_u32 s101, s94, 1
    s_cmp_eq_u32 s101, 48
    s_cselect_b32 s101, 0, s101
    s_mul_i32 s99, s101, 171
    s_lshr_b32 s99, s99, 9
    s_mul_i32 s99, s99, -10240
    s_mul_i32 s3, s101, 20480
    s_add_u32 s99, s99, s3
    s_mov_b32 s3, s99
    buffer_load_dwordx4 v48, s[12:15], s3 offen lds
    s_add_u32 m0, s46, 3072
    s_add_u32 s3, s99, 10240
    buffer_load_dwordx4 v48, s[12:15], s3 offen lds
    s_add_u32 s94, s94, 8
    s_cmp_ge_u32 s94, 48
    s_cselect_b32 s3, 48, 0
    s_sub_u32 s94, s94, s3
    s_add_u32 m0, s46, 16384
    s_mul_i32 s99, s94, 171
    s_lshr_b32 s99, s99, 9
    s_mul_i32 s99, s99, -10240
    s_mul_i32 s3, s94, 20480
    s_add_u32 s99, s99, s3
    s_mov_b32 s3, s99
    buffer_load_dwordx4 v48, s[12:15], s3 offen lds
    s_add_u32 m0, s46, 17408
    s_add_u32 s3, s99, 10240
    buffer_load_dwordx4 v48, s[12:15], s3 offen lds
    s_add_u32 m0, s46, 18432
    s_add_u32 s101, s94, 1
    s_cmp_eq_u32 s101, 48
    s_cselect_b32 s101, 0, s101
    s_mul_i32 s99, s101, 171
    s_lshr_b32 s99, s99, 9
    s_mul_i32 s99, s99, -10240
    s_mul_i32 s3, s101, 20480
    s_add_u32 s99, s99, s3
    s_mov_b32 s3, s99
    buffer_load_dwordx4 v48, s[12:15], s3 offen lds
    s_add_u32 m0, s46, 19456
    s_add_u32 s3, s99, 10240
    buffer_load_dwordx4 v48, s[12:15], s3 offen lds
    s_add_u32 s94, s94, 8
    s_cmp_ge_u32 s94, 48
    s_cselect_b32 s3, 48, 0
    s_sub_u32 s94, s94, s3
    s_branch L_ringD_20
L_ringM_18:
    s_add_u32 m0, s47, 98304
    s_mov_b32 s3, 0
    buffer_load_dwordx4 v49, s[16:19], s3 offen lds
    s_add_u32 m0, s47, 99328
    s_mov_b32 s3, 27648
    buffer_load_dwordx4 v49, s[16:19], s3 offen lds
    s_add_u32 m0, s47, 106496
    s_mov_b32 s3, 0
    buffer_load_dwordx4 v49, s[20:23], s3 offen lds
    s_add_u32 m0, s47, 107520
    s_mov_b32 s3, 27648
    buffer_load_dwordx4 v49, s[20:23], s3 offen lds
    s_add_u32 m0, s47, 114688
    s_mov_b32 s3, 221184
    buffer_load_dwordx4 v49, s[16:19], s3 offen lds
    s_add_u32 m0, s47, 115712
    s_mov_b32 s3, 248832
    buffer_load_dwordx4 v49, s[16:19], s3 offen lds
    s_add_u32 m0, s47, 122880
    s_mov_b32 s3, 221184
    buffer_load_dwordx4 v49, s[20:23], s3 offen lds
    s_add_u32 m0, s47, 123904
    s_mov_b32 s3, 248832
    buffer_load_dwordx4 v49, s[20:23], s3 offen lds
    s_branch L_ringD_20
L_ringI_19:
L_ringD_20:
    s_lshl_b32 s54, s68, 16
    s_add_u32 s54, s54, 196608
    s_lshl_b32 s63, s68, 11
    s_lshl_b32 s62, s41, 7
    s_add_u32 s63, s63, s62
    s_cmp_lg_u32 s40, 0
    s_cbranch_scc1 L_polld_22
    v_mov_b32 v4, 0
    s_mov_b32 s100, 0
    s_mov_b64 exec, 1
L_poll_21:
    buffer_load_dword v5, v4, s[32:35], s63 offen sc1
    s_add_u32 s100, s100, 1
    s_waitcnt vmcnt(0)
    v_readfirstlane_b32 s62, v5
    s_cmp_ge_u32 s100, 400000
    s_cbranch_scc1 L_polld_22x
    s_cmp_ge_u32 s62, 16
    s_cbranch_scc1 L_polld_22x
    s_branch L_poll_21
L_polld_22x:
    s_waitcnt vmcnt(0)
    s_mov_b64 exec, -1
L_polld_22:
    s_waitcnt vmcnt(0)
    s_barrier
    s_add_u32 s55, s54, 0
    buffer_load_dwordx4 v[192:195], v41, s[32:35], s55 offen sc1
    s_add_u32 s55, s54, 4096
    buffer_load_dwordx4 v[196:199], v41, s[32:35], s55 offen sc1
    s_add_u32 s55, s54, 8192
    buffer_load_dwordx4 v[200:203], v41, s[32:35], s55 offen sc1
    s_add_u32 s55, s54, 12288
    buffer_load_dwordx4 v[204:207], v41, s[32:35], s55 offen sc1
    s_add_u32 s55, s54, 16384
    buffer_load_dwordx4 v[208:211], v41, s[32:35], s55 offen sc1
    s_add_u32 s55, s54, 20480
    buffer_load_dwordx4 v[212:215], v41, s[32:35], s55 offen sc1
    s_add_u32 s55, s54, 24576
    buffer_load_dwordx4 v[216:219], v41, s[32:35], s55 offen sc1
    s_add_u32 s55, s54, 28672
    buffer_load_dwordx4 v[220:223], v41, s[32:35], s55 offen sc1
    s_add_u32 s55, s54, 32768
    buffer_load_dwordx4 v[224:227], v41, s[32:35], s55 offen sc1
    s_add_u32 s55, s54, 36864
    buffer_load_dwordx4 v[228:231], v41, s[32:35], s55 offen sc1
    s_add_u32 s55, s54, 40960
    buffer_load_dwordx4 v[232:235], v41, s[32:35], s55 offen sc1
    s_add_u32 s55, s54, 45056
    buffer_load_dwordx4 v[236:239], v41, s[32:35], s55 offen sc1
    s_add_u32 s55, s54, 49152
    buffer_load_dwordx4 v[240:243], v41, s[32:35], s55 offen sc1
    s_add_u32 s55, s54, 53248
    buffer_load_dwordx4 v[244:247], v41, s[32:35], s55 offen sc1
    s_add_u32 s55, s54, 57344
    buffer_load_dwordx4 v[248:251], v41, s[32:35], s55 offen sc1
    s_add_u32 s55, s54, 61440
    buffer_load_dwordx4 v[252:255], v41, s[32:35], s55 offen sc1
    s_waitcnt vmcnt(14)
    v_pk_add_f32 v[192:193], v[192:193], v[196:197]
    v_pk_add_f32 v[194:195], v[194:195], v[198:199]
    s_waitcnt vmcnt(13)
    v_pk_add_f32 v[192:193], v[192:193], v[200:201]
    v_pk_add_f32 v[194:195], v[194:195], v[202:203]
    s_waitcnt vmcnt(12)
    v_pk_add_f32 v[192:193], v[192:193], v[204:205]
    v_pk_add_f32 v[194:195], v[194:195], v[206:207]
    s_waitcnt vmcnt(11)
    v_pk_add_f32 v[192:193], v[192:193], v[208:209]
    v_pk_add_f32 v[194:195], v[194:195], v[210:211]
    s_waitcnt vmcnt(10)
    v_pk_add_f32 v[192:193], v[192:193], v[212:213]
    v_pk_add_f32 v[194:195], v[194:195], v[214:215]
    s_waitcnt vmcnt(9)
    v_pk_add_f32 v[192:193], v[192:193], v[216:217]
    v_pk_add_f32 v[194:195], v[194:195], v[218:219]
    s_waitcnt vmcnt(8)
    v_pk_add_f32 v[192:193], v[192:193], v[220:221]
    v_pk_add_f32 v[194:195], v[194:195], v[222:223]
    s_waitcnt vmcnt(7)
    v_pk_add_f32 v[192:193], v[192:193], v[224:225]
    v_pk_add_f32 v[194:195], v[194:195], v[226:227]
    s_waitcnt vmcnt(6)
    v_pk_add_f32 v[192:193], v[192:193], v[228:229]
    v_pk_add_f32 v[194:195], v[194:195], v[230:231]
    s_waitcnt vmcnt(5)
    v_pk_add_f32 v[192:193], v[192:193], v[232:233]
    v_pk_add_f32 v[194:195], v[194:195], v[234:235]
    s_waitcnt vmcnt(4)
    v_pk_add_f32 v[192:193], v[192:193], v[236:237]
    v_pk_add_f32 v[194:195], v[194:195], v[238:239]
    s_waitcnt vmcnt(3)
    v_pk_add_f32 v[192:193], v[192:193], v[240:241]
    v_pk_add_f32 v[194:195], v[194:195], v[242:243]
    s_waitcnt vmcnt(2)
    v_pk_add_f32 v[192:193], v[192:193], v[244:245]
    v_pk_add_f32 v[194:195], v[194:195], v[246:247]
    s_waitcnt vmcnt(1)
    v_pk_add_f32 v[192:193], v[192:193], v[248:249]
    v_pk_add_f32 v[194:195], v[194:195], v[250:251]
    s_waitcnt vmcnt(0)
    v_pk_add_f32 v[192:193], v[192:193], v[252:253]
    v_pk_add_f32 v[194:195], v[194:195], v[254:255]
    s_cmp_ge_u32 s45, 7
    s_cbranch_scc1 L_ringI_24
    s_cmp_ge_u32 s45, 5
    s_cbranch_scc1 L_ringM_23
    s_add_u32 m0, s46, 32768
    s_mul_i32 s99, s94, 171
    s_lshr_b32 s99, s99, 9
    s_mul_i32 s99, s99, -10240
    s_mul_i32 s3, s94, 20480
    s_add_u32 s99, s99, s3
    s_mov_b32 s3, s99
    buffer_load_dwordx4 v48, s[12:15], s3 offen lds
    s_add_u32 m0, s46, 33792
    s_add_u32 s3, s99, 10240
    buffer_load_dwordx4 v48, s[12:15], s3 offen lds
    s_add_u32 m0, s46, 34816
    s_add_u32 s101, s94, 1
    s_cmp_eq_u32 s101, 48
    s_cselect_b32 s101, 0, s101
    s_mul_i32 s99, s101, 171
    s_lshr_b32 s99, s99, 9
    s_mul_i32 s99, s99, -10240
    s_mul_i32 s3, s101, 20480
    s_add_u32 s99, s99, s3
    s_mov_b32 s3, s99
    buffer_load_dwordx4 v48, s[12:15], s3 offen lds
    s_add_u32 m0, s46, 35840
    s_add_u32 s3, s99, 10240
    buffer_load_dwordx4 v48, s[12:15], s3 offen lds
    s_add_u32 s94, s94, 8
    s_cmp_ge_u32 s94, 48
    s_cselect_b32 s3, 48, 0
    s_sub_u32 s94, s94, s3
    s_add_u32 m0, s46, 49152
    s_mul_i32 s99, s94, 171
    s_lshr_b32 s99, s99, 9
    s_mul_i32 s99, s99, -10240
    s_mul_i32 s3, s94, 20480
    s_add_u32 s99, s99, s3
    s_mov_b32 s3, s99
    buffer_load_dwordx4 v48, s[12:15], s3 offen lds
    s_add_u32 m0, s46, 50176
    s_add_u32 s3, s99, 10240
    buffer_load_dwordx4 v48, s[12:15], s3 offen lds
    s_add_u32 m0, s46, 51200
    s_add_u32 s101, s94, 1
    s_cmp_eq_u32 s101, 48
    s_cselect_b32 s101, 0, s101
    s_mul_i32 s99, s101, 171
    s_lshr_b32 s99, s99, 9
    s_mul_i32 s99, s99, -10240
    s_mul_i32 s3, s101, 20480
    s_add_u32 s99, s99, s3
    s_mov_b32 s3, s99
    buffer_load_dwordx4 v48, s[12:15], s3 offen lds
    s_add_u32 m0, s46, 52224
    s_add_u32 s3, s99, 10240
    buffer_load_dwordx4 v48, s[12:15], s3 offen lds
    s_add_u32 s94, s94, 8
    s_cmp_ge_u32 s94, 48
    s_cselect_b32 s3, 48, 0
    s_sub_u32 s94, s94, s3
    s_branch L_ringD_25
L_ringM_23:
    s_add_u32 m0, s47, 0
    s_mov_b32 s3, 442368
    buffer_load_dwordx4 v49, s[16:19], s3 offen lds
    s_add_u32 m0, s47, 1024
    s_mov_b32 s3, 470016
    buffer_load_dwordx4 v49, s[16:19], s3 offen lds
    s_add_u32 m0, s47, 8192
    s_mov_b32 s3, 442368
    buffer_load_dwordx4 v49, s[20:23], s3 offen lds
    s_add_u32 m0, s47, 9216
    s_mov_b32 s3, 470016
    buffer_load_dwordx4 v49, s[20:23], s3 offen lds
    s_add_u32 m0, s47, 16384
    s_mov_b32 s3, 663552
    buffer_load_dwordx4 v49, s[16:19], s3 offen lds
    s_add_u32 m0, s47, 17408
    s_mov_b32 s3, 691200
    buffer_load_dwordx4 v49, s[16:19], s3 offen lds
    s_add_u32 m0, s47, 24576
    s_mov_b32 s3, 663552
    buffer_load_dwordx4 v49, s[20:23], s3 offen lds
    s_add_u32 m0, s47, 25600
    s_mov_b32 s3, 691200
    buffer_load_dwordx4 v49, s[20:23], s3 offen lds
    s_branch L_ringD_25
L_ringI_24:
L_ringD_25:
    v_cvt_pk_bf16_f32 v6, v192, v193
    v_cvt_pk_bf16_f32 v7, v194, v195
    ds_write_b64 v38, v[6:7]
    ds_write_b64 v39, v[6:7]
    s_waitcnt lgkmcnt(0)
    s_barrier
    ds_read_b128 a[44:47], v40 offset:3584
    ds_read_b128 a[48:51], v40 offset:3616
    ds_read_b128 a[52:55], v40 offset:3648
    ds_read_b128 a[32:35], v40 offset:0
    ds_read_b128 a[36:39], v40 offset:32
    ds_read_b128 a[40:43], v40 offset:64
    s_waitcnt lgkmcnt(5)
    v_mfma_f32_32x32x16_bf16 v[208:223], a[44:47], v[176:179], 0
    s_waitcnt lgkmcnt(4)
    v_mfma_f32_32x32x16_bf16 v[208:223], a[48:51], v[180:183], v[208:223]
    s_waitcnt lgkmcnt(3)
    v_mfma_f32_32x32x16_bf16 v[208:223], a[52:55], v[184:187], v[208:223]
    s_waitcnt lgkmcnt(2)
    v_mfma_f32_32x32x16_bf16 v[192:207], a[32:35], v[176:179], 0
    s_waitcnt lgkmcnt(1)
    v_mfma_f32_32x32x16_bf16 v[192:207], a[36:39], v[180:183], v[192:207]
    s_waitcnt lgkmcnt(0)
    v_mfma_f32_32x32x16_bf16 v[192:207], a[40:43], v[184:187], v[192:207]
    s_lshl_b32 s48, s41, 2
    s_add_u32 s48, s48, s40
    s_mul_i32 s48, s48, 49152
    s_mul_i32 s49, s68, 3072
    s_add_u32 s48, s48, s49
    s_add_u32 s48, s48, 1310720
    v_lshlrev_b32 v4, 4, v1
    v_cmp_eq_u32 vcc, 1, v3
    s_nop 2
    v_add_f32 v8, s69, v212
    v_add_f32 v10, s69, v213
    v_rcp_f32 v8, v8
    v_rcp_f32 v10, v10
    v_mov_b32 v26, 0
    v_cndmask_b32 v12, v8, v10, vcc
    v_mov_b32 v27, 0
    s_nop 0
    v_pk_mul_f32 v[192:193], v[192:193], v[8:9] op_sel_hi:[1,0]
    v_pk_mul_f32 v[194:195], v[194:195], v[8:9] op_sel_hi:[1,0]
    v_cvt_pk_bf16_f32 v16, v192, v193
    v_cvt_pk_bf16_f32 v17, v194, v195
    v_pk_mul_f32 v[196:197], v[196:197], v[8:9] op_sel_hi:[1,0]
    v_pk_mul_f32 v[198:199], v[198:199], v[8:9] op_sel_hi:[1,0]
    v_cvt_pk_bf16_f32 v18, v196, v197
    v_cvt_pk_bf16_f32 v19, v198, v199
    buffer_store_dwordx4 v[16:19], v4, s[32:35], s48 offen offset:0 sc1
    v_pk_mul_f32 v[200:201], v[200:201], v[12:13] op_sel_hi:[1,0]
    v_pk_mul_f32 v[202:203], v[202:203], v[12:13] op_sel_hi:[1,0]
    v_cvt_pk_bf16_f32 v20, v200, v201
    v_cvt_pk_bf16_f32 v21, v202, v203
    v_pk_mul_f32 v[204:205], v[204:205], v[10:11] op_sel_hi:[1,0]
    v_pk_mul_f32 v[206:207], v[206:207], v[10:11] op_sel_hi:[1,0]
    v_cvt_pk_bf16_f32 v22, v204, v205
    v_cvt_pk_bf16_f32 v23, v206, v207
    buffer_store_dwordx4 v[20:23], v4, s[32:35], s48 offen offset:1024 sc1
    v_pk_mul_f32 v[208:209], v[208:209], v[10:11] op_sel_hi:[1,0]
    v_pk_mul_f32 v[210:211], v[210:211], v[10:11] op_sel_hi:[1,0]
    v_cvt_pk_bf16_f32 v24, v208, v209
    v_cvt_pk_bf16_f32 v25, v210, v211
    buffer_store_dwordx4 v[24:27], v4, s[32:35], s48 offen offset:2048 sc1
    s_lshl_b32 s63, s41, 11
    s_add_u32 s63, s63, 32768
    v_lshlrev_b32 v46, 7, v1
    v_add_u32 v46, s63, v46
    v_mov_b32 v47, 1
    s_waitcnt vmcnt(0)
    s_barrier
    s_cmp_lg_u32 s40, 0
    s_cbranch_scc1 L_arr_26
    s_mov_b64 exec, 0xffff
    buffer_atomic_add v47, v46, s[32:35], 0 offen
    s_mov_b64 exec, -1
L_arr_26:
    s_cmp_ge_u32 s45, 7
    s_cbranch_scc1 L_ringI_28
    s_cmp_ge_u32 s45, 5
    s_cbranch_scc1 L_ringM_27
    s_add_u32 m0, s46, 65536
    s_mul_i32 s99, s94, 171
    s_lshr_b32 s99, s99, 9
    s_mul_i32 s99, s99, -10240
    s_mul_i32 s3, s94, 20480
    s_add_u32 s99, s99, s3
    s_mov_b32 s3, s99
    buffer_load_dwordx4 v48, s[12:15], s3 offen lds
    s_add_u32 m0, s46, 66560
    s_add_u32 s3, s99, 10240
    buffer_load_dwordx4 v48, s[12:15], s3 offen lds
    s_add_u32 m0, s46, 67584
    s_add_u32 s101, s94, 1
    s_cmp_eq_u32 s101, 48
    s_cselect_b32 s101, 0, s101
    s_mul_i32 s99, s101, 171
    s_lshr_b32 s99, s99, 9
    s_mul_i32 s99, s99, -10240
    s_mul_i32 s3, s101, 20480
    s_add_u32 s99, s99, s3
    s_mov_b32 s3, s99
    buffer_load_dwordx4 v48, s[12:15], s3 offen lds
    s_add_u32 m0, s46, 68608
    s_add_u32 s3, s99, 10240
    buffer_load_dwordx4 v48, s[12:15], s3 offen lds
    s_add_u32 s94, s94, 8
    s_cmp_ge_u32 s94, 48
    s_cselect_b32 s3, 48, 0
    s_sub_u32 s94, s94, s3
    s_add_u32 m0, s46, 81920
    s_mul_i32 s99, s94, 171
    s_lshr_b32 s99, s99, 9
    s_mul_i32 s99, s99, -10240
    s_mul_i32 s3, s94, 20480
    s_add_u32 s99, s99, s3
    s_mov_b32 s3, s99
    buffer_load_dwordx4 v48, s[12:15], s3 offen lds
    s_add_u32 m0, s46, 82944
    s_add_u32 s3, s99, 10240
    buffer_load_dwordx4 v48, s[12:15], s3 offen lds
    s_add_u32 m0, s46, 83968
    s_add_u32 s101, s94, 1
    s_cmp_eq_u32 s101, 48
    s_cselect_b32 s101, 0, s101
    s_mul_i32 s99, s101, 171
    s_lshr_b32 s99, s99, 9
    s_mul_i32 s99, s99, -10240
    s_mul_i32 s3, s101, 20480
    s_add_u32 s99, s99, s3
    s_mov_b32 s3, s99
    buffer_load_dwordx4 v48, s[12:15], s3 offen lds
    s_add_u32 m0, s46, 84992
    s_add_u32 s3, s99, 10240
    buffer_load_dwordx4 v48, s[12:15], s3 offen lds
    s_add_u32 s94, s94, 8
    s_cmp_ge_u32 s94, 48
    s_cselect_b32 s3, 48, 0
    s_sub_u32 s94, s94, s3
    s_branch L_ringD_29
L_ringM_27:
    s_branch L_ringD_29
L_ringI_28:
L_ringD_29:
    s_cmp_lt_u32 s45, 5
    s_cbranch_scc1 L_p2
    s_lshl_b32 s49, s41, 1
    s_lshr_b32 s50, s42, 3
    s_add_u32 s49, s49, s50
    s_sub_u32 s48, s45, 4
    s_lshl_b32 s48, s48, 5
    s_cmp_eq_u32 s45, 7
    s_cselect_b32 s48, 0, s48
    s_add_u32 s48, s48, s49
    s_cmp_ge_u32 s48, 54
    s_cbranch_scc1 L_wd_30
    s_cmp_ge_u32 s48, 27
    s_cselect_b32 s52, s20, s16
    s_cselect_b32 s53, s21, s17
    s_cselect_b32 s49, 27, 0
    s_mov_b32 s54, 2211840
    s_mov_b32 s55, 0x20000
    s_sub_u32 s49, s48, s49
    v_lshrrev_b32 v4, 3, v1
    s_mul_i32 s50, s40, 160
    v_add_u32 v4, s50, v4
    v_mul_u32_u24 v4, 3456, v4
    v_and_b32 v5, 7, v1
    v_lshlrev_b32 v5, 4, v5
    v_add_u32 v4, v4, v5
    s_lshl_b32 s50, s49, 7
    v_add_u32 v4, s50, v4
    s_mov_b32 s50, 0
    buffer_load_dwordx4 v[64:67], v4, s[52:55], s50 offen
    s_mov_b32 s50, 27648
    buffer_load_dwordx4 v[68:71], v4, s[52:55], s50 offen
    s_mov_b32 s50, 55296
    buffer_load_dwordx4 v[72:75], v4, s[52:55], s50 offen
    s_mov_b32 s50, 82944
    buffer_load_dwordx4 v[76:79], v4, s[52:55], s50 offen
    s_mov_b32 s50, 110592
    buffer_load_dwordx4 v[80:83], v4, s[52:55], s50 offen
    s_mov_b32 s50, 138240
    buffer_load_dwordx4 v[84:87], v4, s[52:55], s50 offen
    s_mov_b32 s50, 165888
    buffer_load_dwordx4 v[88:91], v4, s[52:55], s50 offen
    s_mov_b32 s50, 193536
    buffer_load_dwordx4 v[92:95], v4, s[52:55], s50 offen
    s_mov_b32 s50, 221184
    buffer_load_dwordx4 v[96:99], v4, s[52:55], s50 offen
    s_mov_b32 s50, 248832
    buffer_load_dwordx4 v[100:103], v4, s[52:55], s50 offen
    s_mov_b32 s50, 276480
    buffer_load_dwordx4 v[104:107], v4, s[52:55], s50 offen
    s_mov_b32 s50, 304128
    buffer_load_dwordx4 v[108:111], v4, s[52:55], s50 offen
    s_mov_b32 s50, 331776
    buffer_load_dwordx4 v[112:115], v4, s[52:55], s50 offen
    s_mov_b32 s50, 359424
    buffer_load_dwordx4 v[116:119], v4, s[52:55], s50 offen
    s_mov_b32 s50, 387072
    buffer_load_dwordx4 v[120:123], v4, s[52:55], s50 offen
    s_mov_b32 s50, 414720
    buffer_load_dwordx4 v[124:127], v4, s[52:55], s50 offen
    s_mov_b32 s50, 442368
    buffer_load_dwordx4 v[128:131], v4, s[52:55], s50 offen
    s_mov_b32 s50, 470016
    buffer_load_dwordx4 v[132:135], v4, s[52:55], s50 offen
    s_mov_b32 s50, 497664
    buffer_load_dwordx4 v[136:139], v4, s[52:55], s50 offen
    s_mov_b32 s50, 525312
    buffer_load_dwordx4 v[140:143], v4, s[52:55], s50 offen
    v_mov_b32 v8, 0
    v_mov_b32 v9, 0
    v_mov_b32 v10, 0
    v_mov_b32 v11, 0
    v_mov_b32 v12, 0
    v_mov_b32 v13, 0
    v_mov_b32 v14, 0
    v_mov_b32 v15, 0
    s_waitcnt vmcnt(19)
    v_lshlrev_b32 v6, 16, v64
    v_and_b32 v7, 0xffff0000, v64
    v_pk_add_f32 v[8:9], v[8:9], v[6:7]
    v_lshlrev_b32 v6, 16, v65
    v_and_b32 v7, 0xffff0000, v65
    v_pk_add_f32 v[10:11], v[10:11], v[6:7]
    v_lshlrev_b32 v6, 16, v66
    v_and_b32 v7, 0xffff0000, v66
    v_pk_add_f32 v[12:13], v[12:13], v[6:7]
    v_lshlrev_b32 v6, 16, v67
    v_and_b32 v7, 0xffff0000, v67
    v_pk_add_f32 v[14:15], v[14:15], v[6:7]
    s_waitcnt vmcnt(18)
    v_lshlrev_b32 v6, 16, v68
    v_and_b32 v7, 0xffff0000, v68
    v_pk_add_f32 v[8:9], v[8:9], v[6:7]
    v_lshlrev_b32 v6, 16, v69
    v_and_b32 v7, 0xffff0000, v69
    v_pk_add_f32 v[10:11], v[10:11], v[6:7]
    v_lshlrev_b32 v6, 16, v70
    v_and_b32 v7, 0xffff0000, v70
    v_pk_add_f32 v[12:13], v[12:13], v[6:7]
    v_lshlrev_b32 v6, 16, v71
    v_and_b32 v7, 0xffff0000, v71
    v_pk_add_f32 v[14:15], v[14:15], v[6:7]
    s_waitcnt vmcnt(17)
    v_lshlrev_b32 v6, 16, v72
    v_and_b32 v7, 0xffff0000, v72
    v_pk_add_f32 v[8:9], v[8:9], v[6:7]
    v_lshlrev_b32 v6, 16, v73
    v_and_b32 v7, 0xffff0000, v73
    v_pk_add_f32 v[10:11], v[10:11], v[6:7]
    v_lshlrev_b32 v6, 16, v74
    v_and_b32 v7, 0xffff0000, v74
    v_pk_add_f32 v[12:13], v[12:13], v[6:7]
    v_lshlrev_b32 v6, 16, v75
    v_and_b32 v7, 0xffff0000, v75
    v_pk_add_f32 v[14:15], v[14:15], v[6:7]
    s_waitcnt vmcnt(16)
    v_lshlrev_b32 v6, 16, v76
    v_and_b32 v7, 0xffff0000, v76
    v_pk_add_f32 v[8:9], v[8:9], v[6:7]
    v_lshlrev_b32 v6, 16, v77
    v_and_b32 v7, 0xffff0000, v77
    v_pk_add_f32 v[10:11], v[10:11], v[6:7]
    v_lshlrev_b32 v6, 16, v78
    v_and_b32 v7, 0xffff0000, v78
    v_pk_add_f32 v[12:13], v[12:13], v[6:7]
    v_lshlrev_b32 v6, 16, v79
    v_and_b32 v7, 0xffff0000, v79
    v_pk_add_f32 v[14:15], v[14:15], v[6:7]
    s_waitcnt vmcnt(15)
    v_lshlrev_b32 v6, 16, v80
    v_and_b32 v7, 0xffff0000, v80
    v_pk_add_f32 v[8:9], v[8:9], v[6:7]
    v_lshlrev_b32 v6, 16, v81
    v_and_b32 v7, 0xffff0000, v81
    v_pk_add_f32 v[10:11], v[10:11], v[6:7]
    v_lshlrev_b32 v6, 16, v82
    v_and_b32 v7, 0xffff0000, v82
    v_pk_add_f32 v[12:13], v[12:13], v[6:7]
    v_lshlrev_b32 v6, 16, v83
    v_and_b32 v7, 0xffff0000, v83
    v_pk_add_f32 v[14:15], v[14:15], v[6:7]
    s_waitcnt vmcnt(14)
    v_lshlrev_b32 v6, 16, v84
    v_and_b32 v7, 0xffff0000, v84
    v_pk_add_f32 v[8:9], v[8:9], v[6:7]
    v_lshlrev_b32 v6, 16, v85
    v_and_b32 v7, 0xffff0000, v85
    v_pk_add_f32 v[10:11], v[10:11], v[6:7]
    v_lshlrev_b32 v6, 16, v86
    v_and_b32 v7, 0xffff0000, v86
    v_pk_add_f32 v[12:13], v[12:13], v[6:7]
    v_lshlrev_b32 v6, 16, v87
    v_and_b32 v7, 0xffff0000, v87
    v_pk_add_f32 v[14:15], v[14:15], v[6:7]
    s_waitcnt vmcnt(13)
    v_lshlrev_b32 v6, 16, v88
    v_and_b32 v7, 0xffff0000, v88
    v_pk_add_f32 v[8:9], v[8:9], v[6:7]
    v_lshlrev_b32 v6, 16, v89
    v_and_b32 v7, 0xffff0000, v89
    v_pk_add_f32 v[10:11], v[10:11], v[6:7]
    v_lshlrev_b32 v6, 16, v90
    v_and_b32 v7, 0xffff0000, v90
    v_pk_add_f32 v[12:13], v[12:13], v[6:7]
    v_lshlrev_b32 v6, 16, v91
    v_and_b32 v7, 0xffff0000, v91
    v_pk_add_f32 v[14:15], v[14:15], v[6:7]
    s_waitcnt vmcnt(12)
    v_lshlrev_b32 v6, 16, v92
    v_and_b32 v7, 0xffff0000, v92
    v_pk_add_f32 v[8:9], v[8:9], v[6:7]
    v_lshlrev_b32 v6, 16, v93
    v_and_b32 v7, 0xffff0000, v93
    v_pk_add_f32 v[10:11], v[10:11], v[6:7]
    v_lshlrev_b32 v6, 16, v94
    v_and_b32 v7, 0xffff0000, v94
    v_pk_add_f32 v[12:13], v[12:13], v[6:7]
    v_lshlrev_b32 v6, 16, v95
    v_and_b32 v7, 0xffff0000, v95
    v_pk_add_f32 v[14:15], v[14:15], v[6:7]
    s_waitcnt vmcnt(11)
    v_lshlrev_b32 v6, 16, v96
    v_and_b32 v7, 0xffff0000, v96
    v_pk_add_f32 v[8:9], v[8:9], v[6:7]
    v_lshlrev_b32 v6, 16, v97
    v_and_b32 v7, 0xffff0000, v97
    v_pk_add_f32 v[10:11], v[10:11], v[6:7]
    v_lshlrev_b32 v6, 16, v98
    v_and_b32 v7, 0xffff0000, v98
    v_pk_add_f32 v[12:13], v[12:13], v[6:7]
    v_lshlrev_b32 v6, 16, v99
    v_and_b32 v7, 0xffff0000, v99
    v_pk_add_f32 v[14:15], v[14:15], v[6:7]
    s_waitcnt vmcnt(10)
    v_lshlrev_b32 v6, 16, v100
    v_and_b32 v7, 0xffff0000, v100
    v_pk_add_f32 v[8:9], v[8:9], v[6:7]
    v_lshlrev_b32 v6, 16, v101
    v_and_b32 v7, 0xffff0000, v101
    v_pk_add_f32 v[10:11], v[10:11], v[6:7]
    v_lshlrev_b32 v6, 16, v102
    v_and_b32 v7, 0xffff0000, v102
    v_pk_add_f32 v[12:13], v[12:13], v[6:7]
    v_lshlrev_b32 v6, 16, v103
    v_and_b32 v7, 0xffff0000, v103
    v_pk_add_f32 v[14:15], v[14:15], v[6:7]
    s_waitcnt vmcnt(9)
    v_lshlrev_b32 v6, 16, v104
    v_and_b32 v7, 0xffff0000, v104
    v_pk_add_f32 v[8:9], v[8:9], v[6:7]
    v_lshlrev_b32 v6, 16, v105
    v_and_b32 v7, 0xffff0000, v105
    v_pk_add_f32 v[10:11], v[10:11], v[6:7]
    v_lshlrev_b32 v6, 16, v106
    v_and_b32 v7, 0xffff0000, v106
    v_pk_add_f32 v[12:13], v[12:13], v[6:7]
    v_lshlrev_b32 v6, 16, v107
    v_and_b32 v7, 0xffff0000, v107
    v_pk_add_f32 v[14:15], v[14:15], v[6:7]
    s_waitcnt vmcnt(8)
    v_lshlrev_b32 v6, 16, v108
    v_and_b32 v7, 0xffff0000, v108
    v_pk_add_f32 v[8:9], v[8:9], v[6:7]
    v_lshlrev_b32 v6, 16, v109
    v_and_b32 v7, 0xffff0000, v109
    v_pk_add_f32 v[10:11], v[10:11], v[6:7]
    v_lshlrev_b32 v6, 16, v110
    v_and_b32 v7, 0xffff0000, v110
    v_pk_add_f32 v[12:13], v[12:13], v[6:7]
    v_lshlrev_b32 v6, 16, v111
    v_and_b32 v7, 0xffff0000, v111
    v_pk_add_f32 v[14:15], v[14:15], v[6:7]
    s_waitcnt vmcnt(7)
    v_lshlrev_b32 v6, 16, v112
    v_and_b32 v7, 0xffff0000, v112
    v_pk_add_f32 v[8:9], v[8:9], v[6:7]
    v_lshlrev_b32 v6, 16, v113
    v_and_b32 v7, 0xffff0000, v113
    v_pk_add_f32 v[10:11], v[10:11], v[6:7]
    v_lshlrev_b32 v6, 16, v114
    v_and_b32 v7, 0xffff0000, v114
    v_pk_add_f32 v[12:13], v[12:13], v[6:7]
    v_lshlrev_b32 v6, 16, v115
    v_and_b32 v7, 0xffff0000, v115
    v_pk_add_f32 v[14:15], v[14:15], v[6:7]
    s_waitcnt vmcnt(6)
    v_lshlrev_b32 v6, 16, v116
    v_and_b32 v7, 0xffff0000, v116
    v_pk_add_f32 v[8:9], v[8:9], v[6:7]
    v_lshlrev_b32 v6, 16, v117
    v_and_b32 v7, 0xffff0000, v117
    v_pk_add_f32 v[10:11], v[10:11], v[6:7]
    v_lshlrev_b32 v6, 16, v118
    v_and_b32 v7, 0xffff0000, v118
    v_pk_add_f32 v[12:13], v[12:13], v[6:7]
    v_lshlrev_b32 v6, 16, v119
    v_and_b32 v7, 0xffff0000, v119
    v_pk_add_f32 v[14:15], v[14:15], v[6:7]
    s_waitcnt vmcnt(5)
    v_lshlrev_b32 v6, 16, v120
    v_and_b32 v7, 0xffff0000, v120
    v_pk_add_f32 v[8:9], v[8:9], v[6:7]
    v_lshlrev_b32 v6, 16, v121
    v_and_b32 v7, 0xffff0000, v121
    v_pk_add_f32 v[10:11], v[10:11], v[6:7]
    v_lshlrev_b32 v6, 16, v122
    v_and_b32 v7, 0xffff0000, v122
    v_pk_add_f32 v[12:13], v[12:13], v[6:7]
    v_lshlrev_b32 v6, 16, v123
    v_and_b32 v7, 0xffff0000, v123
    v_pk_add_f32 v[14:15], v[14:15], v[6:7]
    s_waitcnt vmcnt(4)
    v_lshlrev_b32 v6, 16, v124
    v_and_b32 v7, 0xffff0000, v124
    v_pk_add_f32 v[8:9], v[8:9], v[6:7]
    v_lshlrev_b32 v6, 16, v125
    v_and_b32 v7, 0xffff0000, v125
    v_pk_add_f32 v[10:11], v[10:11], v[6:7]
    v_lshlrev_b32 v6, 16, v126
    v_and_b32 v7, 0xffff0000, v126
    v_pk_add_f32 v[12:13], v[12:13], v[6:7]
    v_lshlrev_b32 v6, 16, v127
    v_and_b32 v7, 0xffff0000, v127
    v_pk_add_f32 v[14:15], v[14:15], v[6:7]
    s_waitcnt vmcnt(3)
    v_lshlrev_b32 v6, 16, v128
    v_and_b32 v7, 0xffff0000, v128
    v_pk_add_f32 v[8:9], v[8:9], v[6:7]
    v_lshlrev_b32 v6, 16, v129
    v_and_b32 v7, 0xffff0000, v129
    v_pk_add_f32 v[10:11], v[10:11], v[6:7]
    v_lshlrev_b32 v6, 16, v130
    v_and_b32 v7, 0xffff0000, v130
    v_pk_add_f32 v[12:13], v[12:13], v[6:7]
    v_lshlrev_b32 v6, 16, v131
    v_and_b32 v7, 0xffff0000, v131
    v_pk_add_f32 v[14:15], v[14:15], v[6:7]
    s_waitcnt vmcnt(2)
    v_lshlrev_b32 v6, 16, v132
    v_and_b32 v7, 0xffff0000, v132
    v_pk_add_f32 v[8:9], v[8:9], v[6:7]
    v_lshlrev_b32 v6, 16, v133
    v_and_b32 v7, 0xffff0000, v133
    v_pk_add_f32 v[10:11], v[10:11], v[6:7]
    v_lshlrev_b32 v6, 16, v134
    v_and_b32 v7, 0xffff0000, v134
    v_pk_add_f32 v[12:13], v[12:13], v[6:7]
    v_lshlrev_b32 v6, 16, v135
    v_and_b32 v7, 0xffff0000, v135
    v_pk_add_f32 v[14:15], v[14:15], v[6:7]
    s_waitcnt vmcnt(1)
    v_lshlrev_b32 v6, 16, v136
    v_and_b32 v7, 0xffff0000, v136
    v_pk_add_f32 v[8:9], v[8:9], v[6:7]
    v_lshlrev_b32 v6, 16, v137
    v_and_b32 v7, 0xffff0000, v137
    v_pk_add_f32 v[10:11], v[10:11], v[6:7]
    v_lshlrev_b32 v6, 16, v138
    v_and_b32 v7, 0xffff0000, v138
    v_pk_add_f32 v[12:13], v[12:13], v[6:7]
    v_lshlrev_b32 v6, 16, v139
    v_and_b32 v7, 0xffff0000, v139
    v_pk_add_f32 v[14:15], v[14:15], v[6:7]
    s_waitcnt vmcnt(0)
    v_lshlrev_b32 v6, 16, v140
    v_and_b32 v7, 0xffff0000, v140
    v_pk_add_f32 v[8:9], v[8:9], v[6:7]
    v_lshlrev_b32 v6, 16, v141
    v_and_b32 v7, 0xffff0000, v141
    v_pk_add_f32 v[10:11], v[10:11], v[6:7]
    v_lshlrev_b32 v6, 16, v142
    v_and_b32 v7, 0xffff0000, v142
    v_pk_add_f32 v[12:13], v[12:13], v[6:7]
    v_lshlrev_b32 v6, 16, v143
    v_and_b32 v7, 0xffff0000, v143
    v_pk_add_f32 v[14:15], v[14:15], v[6:7]
    v_lshlrev_b32 v4, 5, v0
    v_add_u32 v4, 131072, v4
    ds_write_b128 v4, v[8:11]
    ds_write_b128 v4, v[12:15] offset:16
    s_waitcnt lgkmcnt(0)
    s_barrier
    v_lshrrev_b32 v4, 3, v1
    v_lshlrev_b32 v4, 5, v4
    v_and_b32 v5, 7, v1
    v_lshlrev_b32 v5, 2, v5
    v_add_u32 v4, v4, v5
    v_add_u32 v4, 131072, v4
    ds_read_b32 v64, v4 offset:0
    ds_read_b32 v65, v4 offset:256
    ds_read_b32 v66, v4 offset:512
    ds_read_b32 v67, v4 offset:768
    ds_read_b32 v68, v4 offset:1024
    ds_read_b32 v69, v4 offset:1280
    ds_read_b32 v70, v4 offset:1536
    ds_read_b32 v71, v4 offset:1792
    ds_read_b32 v72, v4 offset:2048
    ds_read_b32 v73, v4 offset:2304
    ds_read_b32 v74, v4 offset:2560
    ds_read_b32 v75, v4 offset:2816
    ds_read_b32 v76, v4 offset:3072
    ds_read_b32 v77, v4 offset:3328
    ds_read_b32 v78, v4 offset:3584
    ds_read_b32 v79, v4 offset:3840
    ds_read_b32 v80, v4 offset:4096
    ds_read_b32 v81, v4 offset:4352
    ds_read_b32 v82, v4 offset:4608
    ds_read_b32 v83, v4 offset:4864
    ds_read_b32 v84, v4 offset:5120
    ds_read_b32 v85, v4 offset:5376
    ds_read_b32 v86, v4 offset:5632
    ds_read_b32 v87, v4 offset:5888
    ds_read_b32 v88, v4 offset:6144
    ds_read_b32 v89, v4 offset:6400
    ds_read_b32 v90, v4 offset:6656
    ds_read_b32 v91, v4 offset:6912
    ds_read_b32 v92, v4 offset:7168
    ds_read_b32 v93, v4 offset:7424
    ds_read_b32 v94, v4 offset:7680
    ds_read_b32 v95, v4 offset:7936
    s_waitcnt lgkmcnt(0)
    v_add_f32 v64, v64, v65
    v_add_f32 v64, v64, v66
    v_add_f32 v64, v64, v67
    v_add_f32 v64, v64, v68
    v_add_f32 v64, v64, v69
    v_add_f32 v64, v64, v70
    v_add_f32 v64, v64, v71
    v_add_f32 v64, v64, v72
    v_add_f32 v64, v64, v73
    v_add_f32 v64, v64, v74
    v_add_f32 v64, v64, v75
    v_add_f32 v64, v64, v76
    v_add_f32 v64, v64, v77
    v_add_f32 v64, v64, v78
    v_add_f32 v64, v64, v79
    v_add_f32 v64, v64, v80
    v_add_f32 v64, v64, v81
    v_add_f32 v64, v64, v82
    v_add_f32 v64, v64, v83
    v_add_f32 v64, v64, v84
    v_add_f32 v64, v64, v85
    v_add_f32 v64, v64, v86
    v_add_f32 v64, v64, v87
    v_add_f32 v64, v64, v88
    v_add_f32 v64, v64, v89
    v_add_f32 v64, v64, v90
    v_add_f32 v64, v64, v91
    v_add_f32 v64, v64, v92
    v_add_f32 v64, v64, v93
    v_add_f32 v64, v64, v94
    v_add_f32 v64, v64, v95
    s_cmp_lg_u32 s40, 0
    s_cbranch_scc1 L_nocs_32
    v_lshlrev_b32 v4, 2, v1
    s_lshl_b32 s50, s48, 8
    s_add_u32 s50, s50, 7602176
    buffer_store_dword v64, v4, s[32:35], s50 offen sc1
    s_waitcnt vmcnt(0)
    v_mov_b32 v4, 131072
    v_mov_b32 v5, 1
    s_mov_b64 exec, 1
    buffer_atomic_add v5, v4, s[32:35], 0 offen
    s_mov_b64 exec, -1
L_nocs_32:
    s_branch L_wdone_31
L_wd_30:
    s_sub_u32 s48, s48, 54
    s_lshl_b32 s48, s48, 2
    s_add_u32 s48, s48, s40
    s_mul_i32 s48, s48, 103
    v_lshrrev_b32 v5, 1, v1
    v_add_u32 v4, s48, v5
    v_lshlrev_b32 v4, 7, v4
    v_and_b32 v5, 1, v1
    v_lshlrev_b32 v5, 6, v5
    v_add_u32 v4, v4, v5
    s_mov_b32 exec_lo, -1
    s_mov_b32 exec_hi, 0xfffff
    buffer_load_dword v43, v4, s[24:27], 0 offen
    v_add_u32 v4, 3328, v4
    s_waitcnt vmcnt(0)
    buffer_load_dword v43, v4, s[24:27], 0 offen
    v_add_u32 v4, 3328, v4
    s_waitcnt vmcnt(0)
    buffer_load_dword v43, v4, s[24:27], 0 offen
    v_add_u32 v4, 3328, v4
    s_waitcnt vmcnt(0)
    buffer_load_dword v43, v4, s[24:27], 0 offen
    v_add_u32 v4, 3328, v4
    s_waitcnt vmcnt(0)
    s_mov_b64 exec, -1
L_wdone_31:
    s_waitcnt vmcnt(0) lgkmcnt(0)
    s_barrier
    s_cmp_lt_u32 s45, 7
    s_cbranch_scc1 L_p3
    s_branch L_fin
L_p2:
    s_lshl_b32 s48, s41, 7
    s_lshl_b32 s49, s40, 5
    s_add_u32 s48, s48, s49
    v_add_u32 v4, s48, v2
    v_mul_u32_u24 v4, 1280, v4
    v_lshlrev_b32 v5, 3, v3
    v_add_u32 v4, v4, v5
    s_lshl_b32 s48, s43, 7
    v_add_u32 v11, s48, v4
    v_accvgpr_read_b32 v4, a192
    v_lshlrev_b32 v64, 16, v4
    v_and_b32 v65, 0xffff0000, v4
    v_accvgpr_read_b32 v4, a193
    v_lshlrev_b32 v66, 16, v4
    v_and_b32 v67, 0xffff0000, v4
    v_accvgpr_read_b32 v4, a194
    v_lshlrev_b32 v68, 16, v4
    v_and_b32 v69, 0xffff0000, v4
    v_accvgpr_read_b32 v4, a195
    v_lshlrev_b32 v70, 16, v4
    v_and_b32 v71, 0xffff0000, v4
    v_accvgpr_read_b32 v4, a196
    v_lshlrev_b32 v72, 16, v4
    v_and_b32 v73, 0xffff0000, v4
    v_accvgpr_read_b32 v4, a197
    v_lshlrev_b32 v74, 16, v4
    v_and_b32 v75, 0xffff0000, v4
    v_accvgpr_read_b32 v4, a198
    v_lshlrev_b32 v76, 16, v4
    v_and_b32 v77, 0xffff0000, v4
    v_accvgpr_read_b32 v4, a199
    v_lshlrev_b32 v78, 16, v4
    v_and_b32 v79, 0xffff0000, v4
    v_accvgpr_read_b32 v4, a200
    v_lshlrev_b32 v80, 16, v4
    v_and_b32 v81, 0xffff0000, v4
    v_accvgpr_read_b32 v4, a201
    v_lshlrev_b32 v82, 16, v4
    v_and_b32 v83, 0xffff0000, v4
    v_accvgpr_read_b32 v4, a202
    v_lshlrev_b32 v84, 16, v4
    v_and_b32 v85, 0xffff0000, v4
    v_accvgpr_read_b32 v4, a203
    v_lshlrev_b32 v86, 16, v4
    v_and_b32 v87, 0xffff0000, v4
    v_accvgpr_read_b32 v4, a204
    v_lshlrev_b32 v88, 16, v4
    v_and_b32 v89, 0xffff0000, v4
    v_accvgpr_read_b32 v4, a205
    v_lshlrev_b32 v90, 16, v4
    v_and_b32 v91, 0xffff0000, v4
    v_accvgpr_read_b32 v4, a206
    v_lshlrev_b32 v92, 16, v4
    v_and_b32 v93, 0xffff0000, v4
    v_accvgpr_read_b32 v4, a207
    v_lshlrev_b32 v94, 16, v4
    v_and_b32 v95, 0xffff0000, v4
    s_lshl_b32 s50, s41, 2
    s_add_u32 s50, s50, s40
    s_mul_i32 s50, s50, 49152
    s_add_u32 s50, s50, 1310720
    s_and_b32 s51, s41, 3
    s_add_u32 s51, s51, s45
    s_cmp_ge_u32 s51, 6
    s_cselect_b32 s63, 6, 0
    s_sub_u32 s51, s51, s63
    s_mul_i32 s51, s51, 0
    s_mov_b32 s97, s50
    s_add_u32 s98, s50, 49152
    s_lshl_b32 s63, s51, 10
    s_add_u32 s96, s50, s63
    v_lshlrev_b32 v10, 4, v1
    s_lshl_b32 s63, s41, 11
    s_add_u32 s63, s63, 32768
    s_lshl_b32 s62, s42, 7
    s_add_u32 s63, s63, s62
    s_cmp_lg_u32 s40, 0
    s_cbranch_scc1 L_polld_34
    v_mov_b32 v4, 0
    s_mov_b32 s100, 0
    s_mov_b64 exec, 1
L_poll_33:
    buffer_load_dword v5, v4, s[32:35], s63 offen sc1
    s_add_u32 s100, s100, 1
    s_waitcnt vmcnt(0)
    v_readfirstlane_b32 s62, v5
    s_cmp_ge_u32 s100, 400000
    s_cbranch_scc1 L_polld_34x
    s_cmp_ge_u32 s62, 16
    s_cbranch_scc1 L_polld_34x
    s_branch L_poll_33
L_polld_34x:
    s_waitcnt vmcnt(0)
    s_mov_b64 exec, -1
L_polld_34:
    s_waitcnt vmcnt(0)
    s_barrier
    buffer_load_dwordx4 a[0:3], v10, s[32:35], s96 offen offset:0 sc1
    buffer_load_dwordx4 a[4:7], v10, s[32:35], s96 offen offset:1024 sc1
    buffer_load_dwordx4 a[8:11], v10, s[32:35], s96 offen offset:2048 sc1
    buffer_load_dwordx4 a[12:15], v10, s[32:35], s96 offen offset:3072 sc1
    s_add_u32 s96, s96, 4096
    s_cmp_eq_u32 s96, s98
    s_cselect_b32 s96, s97, s96
    buffer_load_dwordx4 a[16:19], v10, s[32:35], s96 offen offset:0 sc1
    buffer_load_dwordx4 a[20:23], v10, s[32:35], s96 offen offset:1024 sc1
    buffer_load_dwordx4 a[24:27], v10, s[32:35], s96 offen offset:2048 sc1
    buffer_load_dwordx4 a[28:31], v10, s[32:35], s96 offen offset:3072 sc1
    s_add_u32 s96, s96, 4096
    s_cmp_eq_u32 s96, s98
    s_cselect_b32 s96, s97, s96
    buffer_load_dwordx4 a[32:35], v10, s[32:35], s96 offen offset:0 sc1
    buffer_load_dwordx4 a[36:39], v10, s[32:35], s96 offen offset:1024 sc1
    buffer_load_dwordx4 a[40:43], v10, s[32:35], s96 offen offset:2048 sc1
    buffer_load_dwordx4 a[44:47], v10, s[32:35], s96 offen offset:3072 sc1
    s_add_u32 s96, s96, 4096
    s_cmp_eq_u32 s96, s98
    s_cselect_b32 s96, s97, s96
    ds_read_b64_tr_b16 a[160:161], v50 offset:0
    ds_read_b64_tr_b16 a[162:163], v50 offset:1024
    ds_read_b64_tr_b16 a[164:165], v51 offset:0
    ds_read_b64_tr_b16 a[166:167], v51 offset:1024
    ds_read_b64_tr_b16 a[168:169], v50 offset:2048
    ds_read_b64_tr_b16 a[170:171], v50 offset:3072
    ds_read_b64_tr_b16 a[172:173], v51 offset:2048
    ds_read_b64_tr_b16 a[174:175], v51 offset:3072
    ds_read_b64_tr_b16 a[176:177], v50 offset:4096
    ds_read_b64_tr_b16 a[178:179], v50 offset:5120
    ds_read_b64_tr_b16 a[180:181], v51 offset:4096
    ds_read_b64_tr_b16 a[182:183], v51 offset:5120
    s_waitcnt vmcnt(11) lgkmcnt(8)
    v_mfma_f32_32x32x16_bf16 v[64:79], a[160:163], a[0:3], v[64:79]
    ds_read_b64_tr_b16 a[184:185], v50 offset:6144
    ds_read_b64_tr_b16 a[186:187], v50 offset:7168
    v_mfma_f32_32x32x16_bf16 v[80:95], a[164:167], a[0:3], v[80:95]
    ds_read_b64_tr_b16 a[188:189], v51 offset:6144
    ds_read_b64_tr_b16 a[190:191], v51 offset:7168
    buffer_load_dwordx4 a[0:3], v10, s[32:35], s96 offen offset:0 sc1
    s_waitcnt vmcnt(11) lgkmcnt(8)
    v_mfma_f32_32x32x16_bf16 v[64:79], a[168:171], a[4:7], v[64:79]
    ds_read_b64_tr_b16 a[160:161], v50 offset:8192
    ds_read_b64_tr_b16 a[162:163], v50 offset:9216
    v_mfma_f32_32x32x16_bf16 v[80:95], a[172:175], a[4:7], v[80:95]
    ds_read_b64_tr_b16 a[164:165], v51 offset:8192
    ds_read_b64_tr_b16 a[166:167], v51 offset:9216
    buffer_load_dwordx4 a[4:7], v10, s[32:35], s96 offen offset:1024 sc1
    s_waitcnt vmcnt(11) lgkmcnt(8)
    v_mfma_f32_32x32x16_bf16 v[64:79], a[176:179], a[8:11], v[64:79]
    ds_read_b64_tr_b16 a[168:169], v50 offset:10240
    ds_read_b64_tr_b16 a[170:171], v50 offset:11264
    v_mfma_f32_32x32x16_bf16 v[80:95], a[180:183], a[8:11], v[80:95]
    ds_read_b64_tr_b16 a[172:173], v51 offset:10240
    ds_read_b64_tr_b16 a[174:175], v51 offset:11264
    buffer_load_dwordx4 a[8:11], v10, s[32:35], s96 offen offset:2048 sc1
    s_waitcnt vmcnt(11) lgkmcnt(8)
    v_mfma_f32_32x32x16_bf16 v[64:79], a[184:187], a[12:15], v[64:79]
    ds_read_b64_tr_b16 a[176:177], v50 offset:12288
    ds_read_b64_tr_b16 a[178:179], v50 offset:13312
    v_mfma_f32_32x32x16_bf16 v[80:95], a[188:191], a[12:15], v[80:95]
    ds_read_b64_tr_b16 a[180:181], v51 offset:12288
    ds_read_b64_tr_b16 a[182:183], v51 offset:13312
    buffer_load_dwordx4 a[12:15], v10, s[32:35], s96 offen offset:3072 sc1
    s_add_u32 s96, s96, 4096
    s_cmp_eq_u32 s96, s98
    s_cselect_b32 s96, s97, s96
    s_waitcnt vmcnt(11) lgkmcnt(8)
    v_mfma_f32_32x32x16_bf16 v[64:79], a[160:163], a[16:19], v[64:79]
    ds_read_b64_tr_b16 a[184:185], v50 offset:14336
    ds_read_b64_tr_b16 a[186:187], v50 offset:15360
    v_mfma_f32_32x32x16_bf16 v[80:95], a[164:167], a[16:19], v[80:95]
    ds_read_b64_tr_b16 a[188:189], v51 offset:14336
    ds_read_b64_tr_b16 a[190:191], v51 offset:15360
    buffer_load_dwordx4 a[16:19], v10, s[32:35], s96 offen offset:0 sc1
    s_waitcnt vmcnt(11) lgkmcnt(8)
    v_mfma_f32_32x32x16_bf16 v[64:79], a[168:171], a[20:23], v[64:79]
    ds_read_b64_tr_b16 a[160:161], v50 offset:16384
    ds_read_b64_tr_b16 a[162:163], v50 offset:17408
    v_mfma_f32_32x32x16_bf16 v[80:95], a[172:175], a[20:23], v[80:95]
    ds_read_b64_tr_b16 a[164:165], v51 offset:16384
    ds_read_b64_tr_b16 a[166:167], v51 offset:17408
    buffer_load_dwordx4 a[20:23], v10, s[32:35], s96 offen offset:1024 sc1
    s_waitcnt vmcnt(11) lgkmcnt(8)
    v_mfma_f32_32x32x16_bf16 v[64:79], a[176:179], a[24:27], v[64:79]
    ds_read_b64_tr_b16 a[168:169], v50 offset:18432
    ds_read_b64_tr_b16 a[170:171], v50 offset:19456
    v_mfma_f32_32x32x16_bf16 v[80:95], a[180:183], a[24:27], v[80:95]
    ds_read_b64_tr_b16 a[172:173], v51 offset:18432
    ds_read_b64_tr_b16 a[174:175], v51 offset:19456
    buffer_load_dwordx4 a[24:27], v10, s[32:35], s96 offen offset:2048 sc1
    s_waitcnt vmcnt(11) lgkmcnt(8)
    v_mfma_f32_32x32x16_bf16 v[64:79], a[184:187], a[28:31], v[64:79]
    ds_read_b64_tr_b16 a[176:177], v50 offset:20480
    ds_read_b64_tr_b16 a[178:179], v50 offset:21504
    v_mfma_f32_32x32x16_bf16 v[80:95], a[188:191], a[28:31], v[80:95]
    ds_read_b64_tr_b16 a[180:181], v51 offset:20480
    ds_read_b64_tr_b16 a[182:183], v51 offset:21504
    buffer_load_dwordx4 a[28:31], v10, s[32:35], s96 offen offset:3072 sc1
    s_add_u32 s96, s96, 4096
    s_cmp_eq_u32 s96, s98
    s_cselect_b32 s96, s97, s96
    s_waitcnt vmcnt(11) lgkmcnt(8)
    v_mfma_f32_32x32x16_bf16 v[64:79], a[160:163], a[32:35], v[64:79]
    ds_read_b64_tr_b16 a[184:185], v50 offset:22528
    ds_read_b64_tr_b16 a[186:187], v50 offset:23552
    v_mfma_f32_32x32x16_bf16 v[80:95], a[164:167], a[32:35], v[80:95]
    ds_read_b64_tr_b16 a[188:189], v51 offset:22528
    ds_read_b64_tr_b16 a[190:191], v51 offset:23552
    buffer_load_dwordx4 a[32:35], v10, s[32:35], s96 offen offset:0 sc1
    s_waitcnt vmcnt(11) lgkmcnt(8)
    v_mfma_f32_32x32x16_bf16 v[64:79], a[168:171], a[36:39], v[64:79]
    ds_read_b64_tr_b16 a[160:161], v50 offset:24576
    ds_read_b64_tr_b16 a[162:163], v50 offset:25600
    v_mfma_f32_32x32x16_bf16 v[80:95], a[172:175], a[36:39], v[80:95]
    ds_read_b64_tr_b16 a[164:165], v51 offset:24576
    ds_read_b64_tr_b16 a[166:167], v51 offset:25600
    buffer_load_dwordx4 a[36:39], v10, s[32:35], s96 offen offset:1024 sc1
    s_waitcnt vmcnt(11) lgkmcnt(8)
    v_mfma_f32_32x32x16_bf16 v[64:79], a[176:179], a[40:43], v[64:79]
    ds_read_b64_tr_b16 a[168:169], v50 offset:26624
    ds_read_b64_tr_b16 a[170:171], v50 offset:27648
    v_mfma_f32_32x32x16_bf16 v[80:95], a[180:183], a[40:43], v[80:95]
    ds_read_b64_tr_b16 a[172:173], v51 offset:26624
    ds_read_b64_tr_b16 a[174:175], v51 offset:27648
    buffer_load_dwordx4 a[40:43], v10, s[32:35], s96 offen offset:2048 sc1
    s_waitcnt vmcnt(11) lgkmcnt(8)
    v_mfma_f32_32x32x16_bf16 v[64:79], a[184:187], a[44:47], v[64:79]
    ds_read_b64_tr_b16 a[176:177], v50 offset:28672
    ds_read_b64_tr_b16 a[178:179], v50 offset:29696
    v_mfma_f32_32x32x16_bf16 v[80:95], a[188:191], a[44:47], v[80:95]
    ds_read_b64_tr_b16 a[180:181], v51 offset:28672
    ds_read_b64_tr_b16 a[182:183], v51 offset:29696
    buffer_load_dwordx4 a[44:47], v10, s[32:35], s96 offen offset:3072 sc1
    s_add_u32 s96, s96, 4096
    s_cmp_eq_u32 s96, s98
    s_cselect_b32 s96, s97, s96
    s_waitcnt vmcnt(11) lgkmcnt(8)
    v_mfma_f32_32x32x16_bf16 v[64:79], a[160:163], a[0:3], v[64:79]
    ds_read_b64_tr_b16 a[184:185], v50 offset:30720
    ds_read_b64_tr_b16 a[186:187], v50 offset:31744
    v_mfma_f32_32x32x16_bf16 v[80:95], a[164:167], a[0:3], v[80:95]
    ds_read_b64_tr_b16 a[188:189], v51 offset:30720
    ds_read_b64_tr_b16 a[190:191], v51 offset:31744
    buffer_load_dwordx4 a[0:3], v10, s[32:35], s96 offen offset:0 sc1
    s_waitcnt vmcnt(11) lgkmcnt(8)
    v_mfma_f32_32x32x16_bf16 v[64:79], a[168:171], a[4:7], v[64:79]
    ds_read_b64_tr_b16 a[160:161], v50 offset:32768
    ds_read_b64_tr_b16 a[162:163], v50 offset:33792
    v_mfma_f32_32x32x16_bf16 v[80:95], a[172:175], a[4:7], v[80:95]
    ds_read_b64_tr_b16 a[164:165], v51 offset:32768
    ds_read_b64_tr_b16 a[166:167], v51 offset:33792
    buffer_load_dwordx4 a[4:7], v10, s[32:35], s96 offen offset:1024 sc1
    s_waitcnt vmcnt(11) lgkmcnt(8)
    v_mfma_f32_32x32x16_bf16 v[64:79], a[176:179], a[8:11], v[64:79]
    ds_read_b64_tr_b16 a[168:169], v50 offset:34816
    ds_read_b64_tr_b16 a[170:171], v50 offset:35840
    v_mfma_f32_32x32x16_bf16 v[80:95], a[180:183], a[8:11], v[80:95]
    ds_read_b64_tr_b16 a[172:173], v51 offset:34816
    ds_read_b64_tr_b16 a[174:175], v51 offset:35840
    buffer_load_dwordx4 a[8:11], v10, s[32:35], s96 offen offset:2048 sc1
    s_waitcnt vmcnt(11) lgkmcnt(8)
    v_mfma_f32_32x32x16_bf16 v[64:79], a[184:187], a[12:15], v[64:79]
    ds_read_b64_tr_b16 a[176:177], v50 offset:36864
    ds_read_b64_tr_b16 a[178:179], v50 offset:37888
    v_mfma_f32_32x32x16_bf16 v[80:95], a[188:191], a[12:15], v[80:95]
    ds_read_b64_tr_b16 a[180:181], v51 offset:36864
    ds_read_b64_tr_b16 a[182:183], v51 offset:37888
    buffer_load_dwordx4 a[12:15], v10, s[32:35], s96 offen offset:3072 sc1
    s_add_u32 s96, s96, 4096
    s_cmp_eq_u32 s96, s98
    s_cselect_b32 s96, s97, s96
    s_waitcnt vmcnt(11) lgkmcnt(8)
    v_mfma_f32_32x32x16_bf16 v[64:79], a[160:163], a[16:19], v[64:79]
    ds_read_b64_tr_b16 a[184:185], v50 offset:38912
    ds_read_b64_tr_b16 a[186:187], v50 offset:39936
    v_mfma_f32_32x32x16_bf16 v[80:95], a[164:167], a[16:19], v[80:95]
    ds_read_b64_tr_b16 a[188:189], v51 offset:38912
    ds_read_b64_tr_b16 a[190:191], v51 offset:39936
    buffer_load_dwordx4 a[16:19], v10, s[32:35], s96 offen offset:0 sc1
    s_waitcnt vmcnt(11) lgkmcnt(8)
    v_mfma_f32_32x32x16_bf16 v[64:79], a[168:171], a[20:23], v[64:79]
    ds_read_b64_tr_b16 a[160:161], v50 offset:40960
    ds_read_b64_tr_b16 a[162:163], v50 offset:41984
    v_mfma_f32_32x32x16_bf16 v[80:95], a[172:175], a[20:23], v[80:95]
    ds_read_b64_tr_b16 a[164:165], v51 offset:40960
    ds_read_b64_tr_b16 a[166:167], v51 offset:41984
    buffer_load_dwordx4 a[20:23], v10, s[32:35], s96 offen offset:1024 sc1
    s_waitcnt vmcnt(11) lgkmcnt(8)
    v_mfma_f32_32x32x16_bf16 v[64:79], a[176:179], a[24:27], v[64:79]
    ds_read_b64_tr_b16 a[168:169], v50 offset:43008
    ds_read_b64_tr_b16 a[170:171], v50 offset:44032
    v_mfma_f32_32x32x16_bf16 v[80:95], a[180:183], a[24:27], v[80:95]
    ds_read_b64_tr_b16 a[172:173], v51 offset:43008
    ds_read_b64_tr_b16 a[174:175], v51 offset:44032
    buffer_load_dwordx4 a[24:27], v10, s[32:35], s96 offen offset:2048 sc1
    s_waitcnt vmcnt(11) lgkmcnt(8)
    v_mfma_f32_32x32x16_bf16 v[64:79], a[184:187], a[28:31], v[64:79]
    ds_read_b64_tr_b16 a[176:177], v50 offset:45056
    ds_read_b64_tr_b16 a[178:179], v50 offset:46080
    v_mfma_f32_32x32x16_bf16 v[80:95], a[188:191], a[28:31], v[80:95]
    ds_read_b64_tr_b16 a[180:181], v51 offset:45056
    ds_read_b64_tr_b16 a[182:183], v51 offset:46080
    buffer_load_dwordx4 a[28:31], v10, s[32:35], s96 offen offset:3072 sc1
    s_add_u32 s96, s96, 4096
    s_cmp_eq_u32 s96, s98
    s_cselect_b32 s96, s97, s96
    s_waitcnt vmcnt(11) lgkmcnt(8)
    v_mfma_f32_32x32x16_bf16 v[64:79], a[160:163], a[32:35], v[64:79]
    ds_read_b64_tr_b16 a[184:185], v50 offset:47104
    ds_read_b64_tr_b16 a[186:187], v50 offset:48128
    v_mfma_f32_32x32x16_bf16 v[80:95], a[164:167], a[32:35], v[80:95]
    ds_read_b64_tr_b16 a[188:189], v51 offset:47104
    ds_read_b64_tr_b16 a[190:191], v51 offset:48128
    buffer_load_dwordx4 a[32:35], v10, s[32:35], s96 offen offset:0 sc1
    s_waitcnt vmcnt(11) lgkmcnt(8)
    v_mfma_f32_32x32x16_bf16 v[64:79], a[168:171], a[36:39], v[64:79]
    ds_read_b64_tr_b16 a[160:161], v50 offset:49152
    ds_read_b64_tr_b16 a[162:163], v50 offset:50176
    v_mfma_f32_32x32x16_bf16 v[80:95], a[172:175], a[36:39], v[80:95]
    ds_read_b64_tr_b16 a[164:165], v51 offset:49152
    ds_read_b64_tr_b16 a[166:167], v51 offset:50176
    buffer_load_dwordx4 a[36:39], v10, s[32:35], s96 offen offset:1024 sc1
    s_waitcnt vmcnt(11) lgkmcnt(8)
    v_mfma_f32_32x32x16_bf16 v[64:79], a[176:179], a[40:43], v[64:79]
    ds_read_b64_tr_b16 a[168:169], v50 offset:51200
    ds_read_b64_tr_b16 a[170:171], v50 offset:52224
    v_mfma_f32_32x32x16_bf16 v[80:95], a[180:183], a[40:43], v[80:95]
    ds_read_b64_tr_b16 a[172:173], v51 offset:51200
    ds_read_b64_tr_b16 a[174:175], v51 offset:52224
    buffer_load_dwordx4 a[40:43], v10, s[32:35], s96 offen offset:2048 sc1
    s_waitcnt vmcnt(11) lgkmcnt(8)
    v_mfma_f32_32x32x16_bf16 v[64:79], a[184:187], a[44:47], v[64:79]
    ds_read_b64_tr_b16 a[176:177], v50 offset:53248
    ds_read_b64_tr_b16 a[178:179], v50 offset:54272
    v_mfma_f32_32x32x16_bf16 v[80:95], a[188:191], a[44:47], v[80:95]
    ds_read_b64_tr_b16 a[180:181], v51 offset:53248
    ds_read_b64_tr_b16 a[182:183], v51 offset:54272
    buffer_load_dwordx4 a[44:47], v10, s[32:35], s96 offen offset:3072 sc1
    s_add_u32 s96, s96, 4096
    s_cmp_eq_u32 s96, s98
    s_cselect_b32 s96, s97, s96
    s_waitcnt vmcnt(11) lgkmcnt(8)
    v_mfma_f32_32x32x16_bf16 v[64:79], a[160:163], a[0:3], v[64:79]
    ds_read_b64_tr_b16 a[184:185], v50 offset:55296
    ds_read_b64_tr_b16 a[186:187], v50 offset:56320
    v_mfma_f32_32x32x16_bf16 v[80:95], a[164:167], a[0:3], v[80:95]
    ds_read_b64_tr_b16 a[188:189], v51 offset:55296
    ds_read_b64_tr_b16 a[190:191], v51 offset:56320
    buffer_load_dwordx4 a[0:3], v10, s[32:35], s96 offen offset:0 sc1
    s_waitcnt vmcnt(11) lgkmcnt(8)
    v_mfma_f32_32x32x16_bf16 v[64:79], a[168:171], a[4:7], v[64:79]
    ds_read_b64_tr_b16 a[160:161], v50 offset:57344
    ds_read_b64_tr_b16 a[162:163], v50 offset:58368
    v_mfma_f32_32x32x16_bf16 v[80:95], a[172:175], a[4:7], v[80:95]
    ds_read_b64_tr_b16 a[164:165], v51 offset:57344
    ds_read_b64_tr_b16 a[166:167], v51 offset:58368
    buffer_load_dwordx4 a[4:7], v10, s[32:35], s96 offen offset:1024 sc1
    s_waitcnt vmcnt(11) lgkmcnt(8)
    v_mfma_f32_32x32x16_bf16 v[64:79], a[176:179], a[8:11], v[64:79]
    ds_read_b64_tr_b16 a[168:169], v50 offset:59392
    ds_read_b64_tr_b16 a[170:171], v50 offset:60416
    v_mfma_f32_32x32x16_bf16 v[80:95], a[180:183], a[8:11], v[80:95]
    ds_read_b64_tr_b16 a[172:173], v51 offset:59392
    ds_read_b64_tr_b16 a[174:175], v51 offset:60416
    buffer_load_dwordx4 a[8:11], v10, s[32:35], s96 offen offset:2048 sc1
    s_waitcnt vmcnt(11) lgkmcnt(8)
    v_mfma_f32_32x32x16_bf16 v[64:79], a[184:187], a[12:15], v[64:79]
    ds_read_b64_tr_b16 a[176:177], v50 offset:61440
    ds_read_b64_tr_b16 a[178:179], v50 offset:62464
    v_mfma_f32_32x32x16_bf16 v[80:95], a[188:191], a[12:15], v[80:95]
    ds_read_b64_tr_b16 a[180:181], v51 offset:61440
    ds_read_b64_tr_b16 a[182:183], v51 offset:62464
    buffer_load_dwordx4 a[12:15], v10, s[32:35], s96 offen offset:3072 sc1
    s_add_u32 s96, s96, 4096
    s_cmp_eq_u32 s96, s98
    s_cselect_b32 s96, s97, s96
    s_waitcnt vmcnt(11) lgkmcnt(8)
    v_mfma_f32_32x32x16_bf16 v[64:79], a[160:163], a[16:19], v[64:79]
    ds_read_b64_tr_b16 a[184:185], v50 offset:63488
    ds_read_b64_tr_b16 a[186:187], v50 offset:64512
    v_mfma_f32_32x32x16_bf16 v[80:95], a[164:167], a[16:19], v[80:95]
    ds_read_b64_tr_b16 a[188:189], v51 offset:63488
    ds_read_b64_tr_b16 a[190:191], v51 offset:64512
    buffer_load_dwordx4 a[16:19], v10, s[32:35], s96 offen offset:0 sc1
    s_waitcnt vmcnt(11) lgkmcnt(8)
    v_mfma_f32_32x32x16_bf16 v[64:79], a[168:171], a[20:23], v[64:79]
    ds_read_b64_tr_b16 a[160:161], v52 offset:0
    ds_read_b64_tr_b16 a[162:163], v52 offset:1024
    v_mfma_f32_32x32x16_bf16 v[80:95], a[172:175], a[20:23], v[80:95]
    ds_read_b64_tr_b16 a[164:165], v53 offset:0
    ds_read_b64_tr_b16 a[166:167], v53 offset:1024
    buffer_load_dwordx4 a[20:23], v10, s[32:35], s96 offen offset:1024 sc1
    s_waitcnt vmcnt(11) lgkmcnt(8)
    v_mfma_f32_32x32x16_bf16 v[64:79], a[176:179], a[24:27], v[64:79]
    ds_read_b64_tr_b16 a[168:169], v52 offset:2048
    ds_read_b64_tr_b16 a[170:171], v52 offset:3072
    v_mfma_f32_32x32x16_bf16 v[80:95], a[180:183], a[24:27], v[80:95]
    ds_read_b64_tr_b16 a[172:173], v53 offset:2048
    ds_read_b64_tr_b16 a[174:175], v53 offset:3072
    buffer_load_dwordx4 a[24:27], v10, s[32:35], s96 offen offset:2048 sc1
    s_waitcnt vmcnt(11) lgkmcnt(8)
    v_mfma_f32_32x32x16_bf16 v[64:79], a[184:187], a[28:31], v[64:79]
    ds_read_b64_tr_b16 a[176:177], v52 offset:4096
    ds_read_b64_tr_b16 a[178:179], v52 offset:5120
    v_mfma_f32_32x32x16_bf16 v[80:95], a[188:191], a[28:31], v[80:95]
    ds_read_b64_tr_b16 a[180:181], v53 offset:4096
    ds_read_b64_tr_b16 a[182:183], v53 offset:5120
    buffer_load_dwordx4 a[28:31], v10, s[32:35], s96 offen offset:3072 sc1
    s_add_u32 s96, s96, 4096
    s_cmp_eq_u32 s96, s98
    s_cselect_b32 s96, s97, s96
    s_waitcnt vmcnt(11) lgkmcnt(8)
    v_mfma_f32_32x32x16_bf16 v[64:79], a[160:163], a[32:35], v[64:79]
    ds_read_b64_tr_b16 a[184:185], v52 offset:6144
    ds_read_b64_tr_b16 a[186:187], v52 offset:7168
    v_mfma_f32_32x32x16_bf16 v[80:95], a[164:167], a[32:35], v[80:95]
    ds_read_b64_tr_b16 a[188:189], v53 offset:6144
    ds_read_b64_tr_b16 a[190:191], v53 offset:7168
    buffer_load_dwordx4 a[32:35], v10, s[32:35], s96 offen offset:0 sc1
    s_waitcnt vmcnt(11) lgkmcnt(8)
    v_mfma_f32_32x32x16_bf16 v[64:79], a[168:171], a[36:39], v[64:79]
    ds_read_b64_tr_b16 a[160:161], v52 offset:8192
    ds_read_b64_tr_b16 a[162:163], v52 offset:9216
    v_mfma_f32_32x32x16_bf16 v[80:95], a[172:175], a[36:39], v[80:95]
    ds_read_b64_tr_b16 a[164:165], v53 offset:8192
    ds_read_b64_tr_b16 a[166:167], v53 offset:9216
    buffer_load_dwordx4 a[36:39], v10, s[32:35], s96 offen offset:1024 sc1
    s_waitcnt vmcnt(11) lgkmcnt(8)
    v_mfma_f32_32x32x16_bf16 v[64:79], a[176:179], a[40:43], v[64:79]
    ds_read_b64_tr_b16 a[168:169], v52 offset:10240
    ds_read_b64_tr_b16 a[170:171], v52 offset:11264
    v_mfma_f32_32x32x16_bf16 v[80:95], a[180:183], a[40:43], v[80:95]
    ds_read_b64_tr_b16 a[172:173], v53 offset:10240
    ds_read_b64_tr_b16 a[174:175], v53 offset:11264
    buffer_load_dwordx4 a[40:43], v10, s[32:35], s96 offen offset:2048 sc1
    s_waitcnt vmcnt(11) lgkmcnt(8)
    v_mfma_f32_32x32x16_bf16 v[64:79], a[184:187], a[44:47], v[64:79]
    ds_read_b64_tr_b16 a[176:177], v52 offset:12288
    ds_read_b64_tr_b16 a[178:179], v52 offset:13312
    v_mfma_f32_32x32x16_bf16 v[80:95], a[188:191], a[44:47], v[80:95]
    ds_read_b64_tr_b16 a[180:181], v53 offset:12288
    ds_read_b64_tr_b16 a[182:183], v53 offset:13312
    buffer_load_dwordx4 a[44:47], v10, s[32:35], s96 offen offset:3072 sc1
    s_add_u32 s96, s96, 4096
    s_cmp_eq_u32 s96, s98
    s_cselect_b32 s96, s97, s96
    s_waitcnt vmcnt(11) lgkmcnt(8)
    v_mfma_f32_32x32x16_bf16 v[64:79], a[160:163], a[0:3], v[64:79]
    ds_read_b64_tr_b16 a[184:185], v52 offset:14336
    ds_read_b64_tr_b16 a[186:187], v52 offset:15360
    v_mfma_f32_32x32x16_bf16 v[80:95], a[164:167], a[0:3], v[80:95]
    ds_read_b64_tr_b16 a[188:189], v53 offset:14336
    ds_read_b64_tr_b16 a[190:191], v53 offset:15360
    s_waitcnt vmcnt(10) lgkmcnt(8)
    v_mfma_f32_32x32x16_bf16 v[64:79], a[168:171], a[4:7], v[64:79]
    ds_read_b64_tr_b16 a[160:161], v52 offset:16384
    ds_read_b64_tr_b16 a[162:163], v52 offset:17408
    v_mfma_f32_32x32x16_bf16 v[80:95], a[172:175], a[4:7], v[80:95]
    ds_read_b64_tr_b16 a[164:165], v53 offset:16384
    ds_read_b64_tr_b16 a[166:167], v53 offset:17408
    s_waitcnt vmcnt(9) lgkmcnt(8)
    v_mfma_f32_32x32x16_bf16 v[64:79], a[176:179], a[8:11], v[64:79]
    ds_read_b64_tr_b16 a[168:169], v52 offset:18432
    ds_read_b64_tr_b16 a[170:171], v52 offset:19456
    v_mfma_f32_32x32x16_bf16 v[80:95], a[180:183], a[8:11], v[80:95]
    ds_read_b64_tr_b16 a[172:173], v53 offset:18432
    ds_read_b64_tr_b16 a[174:175], v53 offset:19456
    s_waitcnt vmcnt(8) lgkmcnt(8)
    v_mfma_f32_32x32x16_bf16 v[64:79], a[184:187], a[12:15], v[64:79]
    ds_read_b64_tr_b16 a[176:177], v52 offset:20480
    ds_read_b64_tr_b16 a[178:179], v52 offset:21504
    v_mfma_f32_32x32x16_bf16 v[80:95], a[188:191], a[12:15], v[80:95]
    ds_read_b64_tr_b16 a[180:181], v53 offset:20480
    ds_read_b64_tr_b16 a[182:183], v53 offset:21504
    s_waitcnt vmcnt(7) lgkmcnt(8)
    v_mfma_f32_32x32x16_bf16 v[64:79], a[160:163], a[16:19], v[64:79]
    ds_read_b64_tr_b16 a[184:185], v52 offset:22528
    ds_read_b64_tr_b16 a[186:187], v52 offset:23552
    v_mfma_f32_32x32x16_bf16 v[80:95], a[164:167], a[16:19], v[80:95]
    ds_read_b64_tr_b16 a[188:189], v53 offset:22528
    ds_read_b64_tr_b16 a[190:191], v53 offset:23552
    s_waitcnt vmcnt(6) lgkmcnt(8)
    v_mfma_f32_32x32x16_bf16 v[64:79], a[168:171], a[20:23], v[64:79]
    ds_read_b64_tr_b16 a[160:161], v52 offset:24576
    ds_read_b64_tr_b16 a[162:163], v52 offset:25600
    v_mfma_f32_32x32x16_bf16 v[80:95], a[172:175], a[20:23], v[80:95]
    ds_read_b64_tr_b16 a[164:165], v53 offset:24576
    ds_read_b64_tr_b16 a[166:167], v53 offset:25600
    s_waitcnt vmcnt(5) lgkmcnt(8)
    v_mfma_f32_32x32x16_bf16 v[64:79], a[176:179], a[24:27], v[64:79]
    ds_read_b64_tr_b16 a[168:169], v52 offset:26624
    ds_read_b64_tr_b16 a[170:171], v52 offset:27648
    v_mfma_f32_32x32x16_bf16 v[80:95], a[180:183], a[24:27], v[80:95]
    ds_read_b64_tr_b16 a[172:173], v53 offset:26624
    ds_read_b64_tr_b16 a[174:175], v53 offset:27648
    s_waitcnt vmcnt(4) lgkmcnt(8)
    v_mfma_f32_32x32x16_bf16 v[64:79], a[184:187], a[28:31], v[64:79]
    ds_read_b64_tr_b16 a[176:177], v52 offset:28672
    ds_read_b64_tr_b16 a[178:179], v52 offset:29696
    v_mfma_f32_32x32x16_bf16 v[80:95], a[188:191], a[28:31], v[80:95]
    ds_read_b64_tr_b16 a[180:181], v53 offset:28672
    ds_read_b64_tr_b16 a[182:183], v53 offset:29696
    s_waitcnt vmcnt(3) lgkmcnt(8)
    v_mfma_f32_32x32x16_bf16 v[64:79], a[160:163], a[32:35], v[64:79]
    ds_read_b64_tr_b16 a[184:185], v52 offset:30720
    ds_read_b64_tr_b16 a[186:187], v52 offset:31744
    v_mfma_f32_32x32x16_bf16 v[80:95], a[164:167], a[32:35], v[80:95]
    ds_read_b64_tr_b16 a[188:189], v53 offset:30720
    ds_read_b64_tr_b16 a[190:191], v53 offset:31744
    s_waitcnt vmcnt(2) lgkmcnt(8)
    v_mfma_f32_32x32x16_bf16 v[64:79], a[168:171], a[36:39], v[64:79]
    v_mfma_f32_32x32x16_bf16 v[80:95], a[172:175], a[36:39], v[80:95]
    s_waitcnt vmcnt(1) lgkmcnt(4)
    v_mfma_f32_32x32x16_bf16 v[64:79], a[176:179], a[40:43], v[64:79]
    v_mfma_f32_32x32x16_bf16 v[80:95], a[180:183], a[40:43], v[80:95]
    s_waitcnt vmcnt(0) lgkmcnt(0)
    v_mfma_f32_32x32x16_bf16 v[64:79], a[184:187], a[44:47], v[64:79]
    v_mfma_f32_32x32x16_bf16 v[80:95], a[188:191], a[44:47], v[80:95]
    s_add_u32 m0, s47, 98304
    s_mov_b32 s3, 0
    buffer_load_dwordx4 v49, s[16:19], s3 offen lds
    s_add_u32 m0, s47, 99328
    s_mov_b32 s3, 27648
    buffer_load_dwordx4 v49, s[16:19], s3 offen lds
    s_add_u32 m0, s47, 106496
    s_mov_b32 s3, 0
    buffer_load_dwordx4 v49, s[20:23], s3 offen lds
    s_add_u32 m0, s47, 107520
    s_mov_b32 s3, 27648
    buffer_load_dwordx4 v49, s[20:23], s3 offen lds
    s_add_u32 m0, s47, 114688
    s_mov_b32 s3, 221184
    buffer_load_dwordx4 v49, s[16:19], s3 offen lds
    s_add_u32 m0, s47, 115712
    s_mov_b32 s3, 248832
    buffer_load_dwordx4 v49, s[16:19], s3 offen lds
    s_add_u32 m0, s47, 122880
    s_mov_b32 s3, 221184
    buffer_load_dwordx4 v49, s[20:23], s3 offen lds
    s_add_u32 m0, s47, 123904
    s_mov_b32 s3, 248832
    buffer_load_dwordx4 v49, s[20:23], s3 offen lds
    v_cvt_pk_bf16_f32 v144, v64, v65
    v_cvt_pk_bf16_f32 v145, v66, v67
    v_cvt_pk_bf16_f32 v146, v68, v69
    v_cvt_pk_bf16_f32 v147, v70, v71
    v_cvt_pk_bf16_f32 v148, v72, v73
    v_cvt_pk_bf16_f32 v149, v74, v75
    v_cvt_pk_bf16_f32 v150, v76, v77
    v_cvt_pk_bf16_f32 v151, v78, v79
    v_cvt_pk_bf16_f32 v152, v80, v81
    v_cvt_pk_bf16_f32 v153, v82, v83
    v_cvt_pk_bf16_f32 v154, v84, v85
    v_cvt_pk_bf16_f32 v155, v86, v87
    v_cvt_pk_bf16_f32 v156, v88, v89
    v_cvt_pk_bf16_f32 v157, v90, v91
    v_cvt_pk_bf16_f32 v158, v92, v93
    v_cvt_pk_bf16_f32 v159, v94, v95
    s_lshl_b32 s50, s41, 2
    s_add_u32 s50, s50, s40
    s_mul_i32 s50, s50, 40960
    s_lshl_b32 s51, s43, 12
    s_add_u32 s50, s50, s51
    s_add_u32 s50, s50, 4718592
    s_add_u32 s51, s50, 0
    buffer_store_dwordx4 v[144:147], v10, s[32:35], s51 offen sc1
    s_add_u32 s51, s50, 1024
    buffer_store_dwordx4 v[148:151], v10, s[32:35], s51 offen sc1
    s_add_u32 s51, s50, 2048
    buffer_store_dwordx4 v[152:155], v10, s[32:35], s51 offen sc1
    s_add_u32 s51, s50, 3072
    buffer_store_dwordx4 v[156:159], v10, s[32:35], s51 offen sc1
    v_lshlrev_b32 v4, 16, v144
    v_and_b32 v5, 0xffff0000, v144
    v_pk_mul_f32 v[14:15], v[4:5], v[4:5]
    v_mov_b32 v12, v4
    v_mov_b32 v13, v5
    v_lshlrev_b32 v6, 16, v145
    v_and_b32 v7, 0xffff0000, v145
    v_pk_add_f32 v[12:13], v[12:13], v[6:7]
    v_pk_fma_f32 v[14:15], v[6:7], v[6:7], v[14:15]
    v_lshlrev_b32 v4, 16, v146
    v_and_b32 v5, 0xffff0000, v146
    v_pk_add_f32 v[12:13], v[12:13], v[4:5]
    v_pk_fma_f32 v[14:15], v[4:5], v[4:5], v[14:15]
    v_lshlrev_b32 v6, 16, v147
    v_and_b32 v7, 0xffff0000, v147
    v_pk_add_f32 v[12:13], v[12:13], v[6:7]
    v_pk_fma_f32 v[14:15], v[6:7], v[6:7], v[14:15]
    v_lshlrev_b32 v4, 16, v148
    v_and_b32 v5, 0xffff0000, v148
    v_pk_add_f32 v[12:13], v[12:13], v[4:5]
    v_pk_fma_f32 v[14:15], v[4:5], v[4:5], v[14:15]
    v_lshlrev_b32 v6, 16, v149
    v_and_b32 v7, 0xffff0000, v149
    v_pk_add_f32 v[12:13], v[12:13], v[6:7]
    v_pk_fma_f32 v[14:15], v[6:7], v[6:7], v[14:15]
    v_lshlrev_b32 v4, 16, v150
    v_and_b32 v5, 0xffff0000, v150
    v_pk_add_f32 v[12:13], v[12:13], v[4:5]
    v_pk_fma_f32 v[14:15], v[4:5], v[4:5], v[14:15]
    v_lshlrev_b32 v6, 16, v151
    v_and_b32 v7, 0xffff0000, v151
    v_pk_add_f32 v[12:13], v[12:13], v[6:7]
    v_pk_fma_f32 v[14:15], v[6:7], v[6:7], v[14:15]
    v_lshlrev_b32 v4, 16, v152
    v_and_b32 v5, 0xffff0000, v152
    v_pk_add_f32 v[12:13], v[12:13], v[4:5]
    v_pk_fma_f32 v[14:15], v[4:5], v[4:5], v[14:15]
    v_lshlrev_b32 v6, 16, v153
    v_and_b32 v7, 0xffff0000, v153
    v_pk_add_f32 v[12:13], v[12:13], v[6:7]
    v_pk_fma_f32 v[14:15], v[6:7], v[6:7], v[14:15]
    v_lshlrev_b32 v4, 16, v154
    v_and_b32 v5, 0xffff0000, v154
    v_pk_add_f32 v[12:13], v[12:13], v[4:5]
    v_pk_fma_f32 v[14:15], v[4:5], v[4:5], v[14:15]
    v_lshlrev_b32 v6, 16, v155
    v_and_b32 v7, 0xffff0000, v155
    v_pk_add_f32 v[12:13], v[12:13], v[6:7]
    v_pk_fma_f32 v[14:15], v[6:7], v[6:7], v[14:15]
    v_lshlrev_b32 v4, 16, v156
    v_and_b32 v5, 0xffff0000, v156
    v_pk_add_f32 v[12:13], v[12:13], v[4:5]
    v_pk_fma_f32 v[14:15], v[4:5], v[4:5], v[14:15]
    v_lshlrev_b32 v6, 16, v157
    v_and_b32 v7, 0xffff0000, v157
    v_pk_add_f32 v[12:13], v[12:13], v[6:7]
    v_pk_fma_f32 v[14:15], v[6:7], v[6:7], v[14:15]
    v_lshlrev_b32 v4, 16, v158
    v_and_b32 v5, 0xffff0000, v158
    v_pk_add_f32 v[12:13], v[12:13], v[4:5]
    v_pk_fma_f32 v[14:15], v[4:5], v[4:5], v[14:15]
    v_lshlrev_b32 v6, 16, v159
    v_and_b32 v7, 0xffff0000, v159
    v_pk_add_f32 v[12:13], v[12:13], v[6:7]
    v_pk_fma_f32 v[14:15], v[6:7], v[6:7], v[14:15]
    v_add_f32 v8, v12, v13
    v_add_f32 v9, v14, v15
    v_mov_b32 v4, v8
    v_mov_b32 v5, v9
    s_nop 1
    v_permlane32_swap_b32 v8, v4
    v_permlane32_swap_b32 v9, v5
    v_add_f32 v8, v8, v4
    v_add_f32 v9, v9, v5
    s_lshl_b32 s48, s41, 7
    s_lshl_b32 s49, s40, 5
    s_add_u32 s48, s48, s49
    v_add_u32 v4, s48, v2
    v_lshlrev_b32 v4, 3, v4
    s_lshl_b32 s48, s43, 14
    s_add_u32 s48, s48, 7340032
    v_mov_b32 v5, 2147483648
    v_cmp_eq_u32 vcc, 1, v3
    s_nop 1
    v_cndmask_b32 v4, v4, v5, vcc
    buffer_store_dwordx2 v[8:9], v4, s[32:35], s48 offen sc1
    v_accvgpr_write_b32 a224, v144
    v_accvgpr_write_b32 a225, v145
    v_accvgpr_write_b32 a226, v146
    v_accvgpr_write_b32 a227, v147
    v_accvgpr_write_b32 a228, v148
    v_accvgpr_write_b32 a229, v149
    v_accvgpr_write_b32 a230, v150
    v_accvgpr_write_b32 a231, v151
    v_accvgpr_write_b32 a232, v152
    v_accvgpr_write_b32 a233, v153
    v_accvgpr_write_b32 a234, v154
    v_accvgpr_write_b32 a235, v155
    v_accvgpr_write_b32 a236, v156
    v_accvgpr_write_b32 a237, v157
    v_accvgpr_write_b32 a238, v158
    v_accvgpr_write_b32 a239, v159
    v_accvgpr_write_b32 a223, v11
    s_lshl_b32 s63, s41, 11
    s_add_u32 s63, s63, 65536
    v_lshlrev_b32 v46, 7, v1
    v_add_u32 v46, s63, v46
    v_mov_b32 v47, 1
    s_waitcnt vmcnt(0)
    s_barrier
    s_cmp_lg_u32 s40, 0
    s_cbranch_scc1 L_arr_35
    s_mov_b64 exec, 0xffff
    buffer_atomic_add v47, v46, s[32:35], 0 offen
    s_mov_b64 exec, -1
L_arr_35:
    s_add_u32 m0, s47, 0
    s_mov_b32 s3, 442368
    buffer_load_dwordx4 v49, s[16:19], s3 offen lds
    s_add_u32 m0, s47, 1024
    s_mov_b32 s3, 470016
    buffer_load_dwordx4 v49, s[16:19], s3 offen lds
    s_add_u32 m0, s47, 8192
    s_mov_b32 s3, 442368
    buffer_load_dwordx4 v49, s[20:23], s3 offen lds
    s_add_u32 m0, s47, 9216
    s_mov_b32 s3, 470016
    buffer_load_dwordx4 v49, s[20:23], s3 offen lds
    s_add_u32 m0, s47, 16384
    s_mov_b32 s3, 663552
    buffer_load_dwordx4 v49, s[16:19], s3 offen lds
    s_add_u32 m0, s47, 17408
    s_mov_b32 s3, 691200
    buffer_load_dwordx4 v49, s[16:19], s3 offen lds
    s_add_u32 m0, s47, 24576
    s_mov_b32 s3, 663552
    buffer_load_dwordx4 v49, s[20:23], s3 offen lds
    s_add_u32 m0, s47, 25600
    s_mov_b32 s3, 691200
    buffer_load_dwordx4 v49, s[20:23], s3 offen lds
L_p3:
    s_waitcnt vmcnt(0)
    v_lshlrev_b32 v10, 4, v1
    s_lshl_b32 s50, s41, 2
    s_add_u32 s50, s50, s40
    s_mul_i32 s50, s50, 40960
    s_add_u32 s96, s50, 4718592
    s_lshl_b32 s63, s41, 11
    s_add_u32 s63, s63, 65536
    s_lshl_b32 s62, s42, 7
    s_add_u32 s63, s63, s62
    s_cmp_lg_u32 s40, 0
    s_cbranch_scc1 L_polld_37
    v_mov_b32 v4, 0
    s_mov_b32 s100, 0
    s_mov_b64 exec, 1
L_poll_36:
    buffer_load_dword v5, v4, s[32:35], s63 offen sc1
    s_add_u32 s100, s100, 1
    s_waitcnt vmcnt(0)
    v_readfirstlane_b32 s62, v5
    s_cmp_ge_u32 s100, 400000
    s_cbranch_scc1 L_polld_37x
    s_cmp_ge_u32 s62, 10
    s_cbranch_scc1 L_polld_37x
    s_branch L_poll_36
L_polld_37x:
    s_waitcnt vmcnt(0)
    s_mov_b64 exec, -1
L_polld_37:
    s_waitcnt vmcnt(0)
    s_barrier
    buffer_load_dwordx4 a[48:51], v10, s[32:35], s96 offen offset:0 sc1
    buffer_load_dwordx4 a[52:55], v10, s[32:35], s96 offen offset:1024 sc1
    buffer_load_dwordx4 a[56:59], v10, s[32:35], s96 offen offset:2048 sc1
    buffer_load_dwordx4 a[60:63], v10, s[32:35], s96 offen offset:3072 sc1
    s_add_u32 s96, s96, 4096
    s_and_b32 s51, s41, 3
    s_mul_i32 s51, s51, 0
    s_mul_i32 s63, s45, 0
    s_add_u32 s51, s51, s63
    s_cmp_ge_u32 s51, 108
    s_cselect_b32 s63, 108, 0
    s_sub_u32 s51, s51, s63
    s_lshl_b32 s63, s40, 1
    s_add_u32 s63, s63, s51
    s_cmp_ge_u32 s63, 108
    s_cselect_b32 s62, 108, 0
    s_sub_u32 s94, s63, s62
    s_cmp_ge_u32 s45, 5
    s_cselect_b32 s26, 0, s26
    ds_read_b64_tr_b16 a[0:1], v52 offset:32768
    ds_read_b64_tr_b16 a[2:3], v52 offset:33792
    ds_read_b64_tr_b16 a[4:5], v53 offset:32768
    ds_read_b64_tr_b16 a[6:7], v53 offset:33792
    ds_read_b64_tr_b16 a[8:9], v52 offset:40960
    ds_read_b64_tr_b16 a[10:11], v52 offset:41984
    ds_read_b64_tr_b16 a[12:13], v53 offset:40960
    ds_read_b64_tr_b16 a[14:15], v53 offset:41984
    ds_read_b64_tr_b16 a[16:17], v52 offset:34816
    ds_read_b64_tr_b16 a[18:19], v52 offset:35840
    ds_read_b64_tr_b16 a[20:21], v53 offset:34816
    ds_read_b64_tr_b16 a[22:23], v53 offset:35840
    ds_read_b64_tr_b16 a[24:25], v52 offset:43008
    ds_read_b64_tr_b16 a[26:27], v52 offset:44032
    ds_read_b64_tr_b16 a[28:29], v53 offset:43008
    ds_read_b64_tr_b16 a[30:31], v53 offset:44032
    s_add_u32 m0, s47, 32768
    s_mov_b32 s3, 884736
    buffer_load_dwordx4 v49, s[16:19], s3 offen lds
    s_add_u32 m0, s47, 33792
    s_mov_b32 s3, 912384
    buffer_load_dwordx4 v49, s[16:19], s3 offen lds
    s_add_u32 m0, s47, 40960
    s_mov_b32 s3, 884736
    buffer_load_dwordx4 v49, s[20:23], s3 offen lds
    s_add_u32 m0, s47, 41984
    s_mov_b32 s3, 912384
    buffer_load_dwordx4 v49, s[20:23], s3 offen lds
    buffer_load_dwordx4 a[64:67], v10, s[32:35], s96 offen offset:0 sc1
    buffer_load_dwordx4 a[68:71], v10, s[32:35], s96 offen offset:1024 sc1
    buffer_load_dwordx4 a[72:75], v10, s[32:35], s96 offen offset:2048 sc1
    buffer_load_dwordx4 a[76:79], v10, s[32:35], s96 offen offset:3072 sc1
    s_add_u32 s96, s96, 4096
    s_waitcnt vmcnt(11) lgkmcnt(12)
    v_mfma_f32_32x32x16_bf16 v[64:79], a[0:3], a[48:51], 0
    ds_read_b64_tr_b16 a[32:33], v52 offset:36864
    ds_read_b64_tr_b16 a[34:35], v52 offset:37888
    buffer_load_dwordx4 a[80:83], v10, s[32:35], s96 offen offset:0 sc1
    v_mfma_f32_32x32x16_bf16 v[80:95], a[4:7], a[48:51], 0
    ds_read_b64_tr_b16 a[36:37], v53 offset:36864
    ds_read_b64_tr_b16 a[38:39], v53 offset:37888
    s_add_u32 m0, s47, 49152
    s_mov_b32 s3, 1105920
    buffer_load_dwordx4 v49, s[16:19], s3 offen lds
    s_waitcnt lgkmcnt(12)
    v_mfma_f32_32x32x16_bf16 v[96:111], a[8:11], a[48:51], 0
    ds_read_b64_tr_b16 a[40:41], v52 offset:45056
    ds_read_b64_tr_b16 a[42:43], v52 offset:46080
    buffer_load_dwordx4 a[84:87], v10, s[32:35], s96 offen offset:1024 sc1
    v_mfma_f32_32x32x16_bf16 v[112:127], a[12:15], a[48:51], 0
    ds_read_b64_tr_b16 a[44:45], v53 offset:45056
    ds_read_b64_tr_b16 a[46:47], v53 offset:46080
    s_waitcnt vmcnt(13) lgkmcnt(12)
    v_mfma_f32_32x32x16_bf16 v[64:79], a[16:19], a[52:55], v[64:79]
    ds_read_b64_tr_b16 a[0:1], v52 offset:38912
    ds_read_b64_tr_b16 a[2:3], v52 offset:39936
    buffer_load_dwordx4 a[88:91], v10, s[32:35], s96 offen offset:2048 sc1
    v_mfma_f32_32x32x16_bf16 v[80:95], a[20:23], a[52:55], v[80:95]
    ds_read_b64_tr_b16 a[4:5], v53 offset:38912
    ds_read_b64_tr_b16 a[6:7], v53 offset:39936
    s_add_u32 m0, s47, 50176
    s_mov_b32 s3, 1133568
    buffer_load_dwordx4 v49, s[16:19], s3 offen lds
    s_waitcnt lgkmcnt(12)
    v_mfma_f32_32x32x16_bf16 v[96:111], a[24:27], a[52:55], v[96:111]
    ds_read_b64_tr_b16 a[8:9], v52 offset:47104
    ds_read_b64_tr_b16 a[10:11], v52 offset:48128
    buffer_load_dwordx4 a[92:95], v10, s[32:35], s96 offen offset:3072 sc1
    s_add_u32 s96, s96, 4096
    v_mfma_f32_32x32x16_bf16 v[112:127], a[28:31], a[52:55], v[112:127]
    ds_read_b64_tr_b16 a[12:13], v53 offset:47104
    ds_read_b64_tr_b16 a[14:15], v53 offset:48128
    s_waitcnt vmcnt(15) lgkmcnt(12)
    v_mfma_f32_32x32x16_bf16 v[64:79], a[32:35], a[56:59], v[64:79]
    ds_read_b64_tr_b16 a[16:17], v52 offset:49152
    ds_read_b64_tr_b16 a[18:19], v52 offset:50176
    v_mfma_f32_32x32x16_bf16 v[80:95], a[36:39], a[56:59], v[80:95]
    ds_read_b64_tr_b16 a[20:21], v53 offset:49152
    ds_read_b64_tr_b16 a[22:23], v53 offset:50176
    s_add_u32 m0, s47, 57344
    s_mov_b32 s3, 1105920
    buffer_load_dwordx4 v49, s[20:23], s3 offen lds
    s_waitcnt lgkmcnt(12)
    v_mfma_f32_32x32x16_bf16 v[96:111], a[40:43], a[56:59], v[96:111]
    ds_read_b64_tr_b16 a[24:25], v52 offset:57344
    ds_read_b64_tr_b16 a[26:27], v52 offset:58368
    buffer_load_dwordx4 a[96:99], v10, s[32:35], s96 offen offset:0 sc1
    v_mfma_f32_32x32x16_bf16 v[112:127], a[44:47], a[56:59], v[112:127]
    ds_read_b64_tr_b16 a[28:29], v53 offset:57344
    ds_read_b64_tr_b16 a[30:31], v53 offset:58368
    s_waitcnt vmcnt(16) lgkmcnt(12)
    v_mfma_f32_32x32x16_bf16 v[64:79], a[0:3], a[60:63], v[64:79]
    ds_read_b64_tr_b16 a[32:33], v52 offset:51200
    ds_read_b64_tr_b16 a[34:35], v52 offset:52224
    v_mfma_f32_32x32x16_bf16 v[80:95], a[4:7], a[60:63], v[80:95]
    ds_read_b64_tr_b16 a[36:37], v53 offset:51200
    ds_read_b64_tr_b16 a[38:39], v53 offset:52224
    s_add_u32 m0, s47, 58368
    s_mov_b32 s3, 1133568
    buffer_load_dwordx4 v49, s[20:23], s3 offen lds
    s_waitcnt lgkmcnt(12)
    v_mfma_f32_32x32x16_bf16 v[96:111], a[8:11], a[60:63], v[96:111]
    ds_read_b64_tr_b16 a[40:41], v52 offset:59392
    ds_read_b64_tr_b16 a[42:43], v52 offset:60416
    buffer_load_dwordx4 a[100:103], v10, s[32:35], s96 offen offset:1024 sc1
    v_mfma_f32_32x32x16_bf16 v[112:127], a[12:15], a[60:63], v[112:127]
    ds_read_b64_tr_b16 a[44:45], v53 offset:59392
    ds_read_b64_tr_b16 a[46:47], v53 offset:60416
    v_mov_b32 v46, 131072
    buffer_load_dword v47, v46, s[32:35], 0 offen sc1
    s_waitcnt vmcnt(14) lgkmcnt(12)
    v_mfma_f32_32x32x16_bf16 v[64:79], a[16:19], a[64:67], v[64:79]
    ds_read_b64_tr_b16 a[0:1], v52 offset:53248
    ds_read_b64_tr_b16 a[2:3], v52 offset:54272
    v_mfma_f32_32x32x16_bf16 v[80:95], a[20:23], a[64:67], v[80:95]
    ds_read_b64_tr_b16 a[4:5], v53 offset:53248
    ds_read_b64_tr_b16 a[6:7], v53 offset:54272
    s_waitcnt lgkmcnt(12)
    v_mfma_f32_32x32x16_bf16 v[96:111], a[24:27], a[64:67], v[96:111]
    ds_read_b64_tr_b16 a[8:9], v52 offset:61440
    ds_read_b64_tr_b16 a[10:11], v52 offset:62464
    buffer_load_dwordx4 a[104:107], v10, s[32:35], s96 offen offset:2048 sc1
    v_mfma_f32_32x32x16_bf16 v[112:127], a[28:31], a[64:67], v[112:127]
    ds_read_b64_tr_b16 a[12:13], v53 offset:61440
    ds_read_b64_tr_b16 a[14:15], v53 offset:62464
    s_waitcnt vmcnt(14) lgkmcnt(12)
    v_mfma_f32_32x32x16_bf16 v[64:79], a[32:35], a[68:71], v[64:79]
    ds_read_b64_tr_b16 a[16:17], v52 offset:55296
    ds_read_b64_tr_b16 a[18:19], v52 offset:56320
    v_mfma_f32_32x32x16_bf16 v[80:95], a[36:39], a[68:71], v[80:95]
    ds_read_b64_tr_b16 a[20:21], v53 offset:55296
    ds_read_b64_tr_b16 a[22:23], v53 offset:56320
    s_waitcnt lgkmcnt(12)
    v_mfma_f32_32x32x16_bf16 v[96:111], a[40:43], a[68:71], v[96:111]
    ds_read_b64_tr_b16 a[24:25], v52 offset:63488
    ds_read_b64_tr_b16 a[26:27], v52 offset:64512
    buffer_load_dwordx4 a[108:111], v10, s[32:35], s96 offen offset:3072 sc1
    s_add_u32 s96, s96, 4096
    v_mfma_f32_32x32x16_bf16 v[112:127], a[44:47], a[68:71], v[112:127]
    ds_read_b64_tr_b16 a[28:29], v53 offset:63488
    ds_read_b64_tr_b16 a[30:31], v53 offset:64512
    s_barrier
    s_waitcnt vmcnt(14) lgkmcnt(12)
    v_mfma_f32_32x32x16_bf16 v[64:79], a[0:3], a[72:75], v[64:79]
    ds_read_b64_tr_b16 a[32:33], v50 offset:0
    ds_read_b64_tr_b16 a[34:35], v50 offset:1024
    v_mfma_f32_32x32x16_bf16 v[80:95], a[4:7], a[72:75], v[80:95]
    ds_read_b64_tr_b16 a[36:37], v51 offset:0
    ds_read_b64_tr_b16 a[38:39], v51 offset:1024
    s_add_u32 m0, s47, 65536
    s_mov_b32 s3, 1327104
    buffer_load_dwordx4 v49, s[16:19], s3 offen lds
    s_waitcnt lgkmcnt(12)
    v_mfma_f32_32x32x16_bf16 v[96:111], a[8:11], a[72:75], v[96:111]
    ds_read_b64_tr_b16 a[40:41], v50 offset:8192
    ds_read_b64_tr_b16 a[42:43], v50 offset:9216
    buffer_load_dwordx4 a[112:115], v10, s[32:35], s96 offen offset:0 sc1
    v_mfma_f32_32x32x16_bf16 v[112:127], a[12:15], a[72:75], v[112:127]
    ds_read_b64_tr_b16 a[44:45], v51 offset:8192
    ds_read_b64_tr_b16 a[46:47], v51 offset:9216
    s_waitcnt vmcnt(15) lgkmcnt(12)
    v_mfma_f32_32x32x16_bf16 v[64:79], a[16:19], a[76:79], v[64:79]
    ds_read_b64_tr_b16 a[0:1], v50 offset:2048
    ds_read_b64_tr_b16 a[2:3], v50 offset:3072
    v_mfma_f32_32x32x16_bf16 v[80:95], a[20:23], a[76:79], v[80:95]
    ds_read_b64_tr_b16 a[4:5], v51 offset:2048
    ds_read_b64_tr_b16 a[6:7], v51 offset:3072
    s_add_u32 m0, s47, 66560
    s_mov_b32 s3, 1354752
    buffer_load_dwordx4 v49, s[16:19], s3 offen lds
    s_waitcnt lgkmcnt(12)
    v_mfma_f32_32x32x16_bf16 v[96:111], a[24:27], a[76:79], v[96:111]
    ds_read_b64_tr_b16 a[8:9], v50 offset:10240
    ds_read_b64_tr_b16 a[10:11], v50 offset:11264
    buffer_load_dwordx4 a[116:119], v10, s[32:35], s96 offen offset:1024 sc1
    v_mfma_f32_32x32x16_bf16 v[112:127], a[28:31], a[76:79], v[112:127]
    ds_read_b64_tr_b16 a[12:13], v51 offset:10240
    ds_read_b64_tr_b16 a[14:15], v51 offset:11264
    s_waitcnt vmcnt(16) lgkmcnt(12)
    v_mfma_f32_32x32x16_bf16 v[64:79], a[32:35], a[80:83], v[64:79]
    ds_read_b64_tr_b16 a[16:17], v50 offset:4096
    ds_read_b64_tr_b16 a[18:19], v50 offset:5120
    v_mfma_f32_32x32x16_bf16 v[80:95], a[36:39], a[80:83], v[80:95]
    ds_read_b64_tr_b16 a[20:21], v51 offset:4096
    ds_read_b64_tr_b16 a[22:23], v51 offset:5120
    s_add_u32 m0, s47, 73728
    s_mov_b32 s3, 1327104
    buffer_load_dwordx4 v49, s[20:23], s3 offen lds
    s_waitcnt lgkmcnt(12)
    v_mfma_f32_32x32x16_bf16 v[96:111], a[40:43], a[80:83], v[96:111]
    ds_read_b64_tr_b16 a[24:25], v50 offset:12288
    ds_read_b64_tr_b16 a[26:27], v50 offset:13312
    buffer_load_dwordx4 a[120:123], v10, s[32:35], s96 offen offset:2048 sc1
    v_mfma_f32_32x32x16_bf16 v[112:127], a[44:47], a[80:83], v[112:127]
    ds_read_b64_tr_b16 a[28:29], v51 offset:12288
    ds_read_b64_tr_b16 a[30:31], v51 offset:13312
    s_waitcnt vmcnt(16) lgkmcnt(12)
    v_mfma_f32_32x32x16_bf16 v[64:79], a[0:3], a[84:87], v[64:79]
    ds_read_b64_tr_b16 a[32:33], v50 offset:6144
    ds_read_b64_tr_b16 a[34:35], v50 offset:7168
    v_mfma_f32_32x32x16_bf16 v[80:95], a[4:7], a[84:87], v[80:95]
    ds_read_b64_tr_b16 a[36:37], v51 offset:6144
    ds_read_b64_tr_b16 a[38:39], v51 offset:7168
    s_add_u32 m0, s47, 74752
    s_mov_b32 s3, 1354752
    buffer_load_dwordx4 v49, s[20:23], s3 offen lds
    s_waitcnt lgkmcnt(12)
    v_mfma_f32_32x32x16_bf16 v[96:111], a[8:11], a[84:87], v[96:111]
    ds_read_b64_tr_b16 a[40:41], v50 offset:14336
    ds_read_b64_tr_b16 a[42:43], v50 offset:15360
    buffer_load_dwordx4 a[124:127], v10, s[32:35], s96 offen offset:3072 sc1
    s_add_u32 s96, s96, 4096
    v_mfma_f32_32x32x16_bf16 v[112:127], a[12:15], a[84:87], v[112:127]
    ds_read_b64_tr_b16 a[44:45], v51 offset:14336
    ds_read_b64_tr_b16 a[46:47], v51 offset:15360
    s_waitcnt vmcnt(17) lgkmcnt(12)
    v_mfma_f32_32x32x16_bf16 v[64:79], a[16:19], a[88:91], v[64:79]
    ds_read_b64_tr_b16 a[0:1], v50 offset:16384
    ds_read_b64_tr_b16 a[2:3], v50 offset:17408
    v_mfma_f32_32x32x16_bf16 v[80:95], a[20:23], a[88:91], v[80:95]
    ds_read_b64_tr_b16 a[4:5], v51 offset:16384
    ds_read_b64_tr_b16 a[6:7], v51 offset:17408
    s_add_u32 m0, s47, 81920
    s_mov_b32 s3, 1548288
    buffer_load_dwordx4 v49, s[16:19], s3 offen lds
    s_waitcnt lgkmcnt(12)
    v_mfma_f32_32x32x16_bf16 v[96:111], a[24:27], a[88:91], v[96:111]
    ds_read_b64_tr_b16 a[8:9], v50 offset:24576
    ds_read_b64_tr_b16 a[10:11], v50 offset:25600
    buffer_load_dwordx4 a[128:131], v10, s[32:35], s96 offen offset:0 sc1
    v_mfma_f32_32x32x16_bf16 v[112:127], a[28:31], a[88:91], v[112:127]
    ds_read_b64_tr_b16 a[12:13], v51 offset:24576
    ds_read_b64_tr_b16 a[14:15], v51 offset:25600
    s_waitcnt vmcnt(17) lgkmcnt(12)
    v_mfma_f32_32x32x16_bf16 v[64:79], a[32:35], a[92:95], v[64:79]
    ds_read_b64_tr_b16 a[16:17], v50 offset:18432
    ds_read_b64_tr_b16 a[18:19], v50 offset:19456
    v_mfma_f32_32x32x16_bf16 v[80:95], a[36:39], a[92:95], v[80:95]
    ds_read_b64_tr_b16 a[20:21], v51 offset:18432
    ds_read_b64_tr_b16 a[22:23], v51 offset:19456
    s_add_u32 m0, s47, 82944
    s_mov_b32 s3, 1575936
    buffer_load_dwordx4 v49, s[16:19], s3 offen lds
    s_waitcnt lgkmcnt(12)
    v_mfma_f32_32x32x16_bf16 v[96:111], a[40:43], a[92:95], v[96:111]
    ds_read_b64_tr_b16 a[24:25], v50 offset:26624
    ds_read_b64_tr_b16 a[26:27], v50 offset:27648
    buffer_load_dwordx4 a[132:135], v10, s[32:35], s96 offen offset:1024 sc1
    v_mfma_f32_32x32x16_bf16 v[112:127], a[44:47], a[92:95], v[112:127]
    ds_read_b64_tr_b16 a[28:29], v51 offset:26624
    ds_read_b64_tr_b16 a[30:31], v51 offset:27648
    s_waitcnt vmcnt(17) lgkmcnt(12)
    v_mfma_f32_32x32x16_bf16 v[64:79], a[0:3], a[96:99], v[64:79]
    ds_read_b64_tr_b16 a[32:33], v50 offset:20480
    ds_read_b64_tr_b16 a[34:35], v50 offset:21504
    v_mfma_f32_32x32x16_bf16 v[80:95], a[4:7], a[96:99], v[80:95]
    ds_read_b64_tr_b16 a[36:37], v51 offset:20480
    ds_read_b64_tr_b16 a[38:39], v51 offset:21504
    s_add_u32 m0, s47, 90112
    s_mov_b32 s3, 1548288
    buffer_load_dwordx4 v49, s[20:23], s3 offen lds
    s_waitcnt lgkmcnt(12)
    v_mfma_f32_32x32x16_bf16 v[96:111], a[8:11], a[96:99], v[96:111]
    ds_read_b64_tr_b16 a[40:41], v50 offset:28672
    ds_read_b64_tr_b16 a[42:43], v50 offset:29696
    buffer_load_dwordx4 a[136:139], v10, s[32:35], s96 offen offset:2048 sc1
    v_mfma_f32_32x32x16_bf16 v[112:127], a[12:15], a[96:99], v[112:127]
    ds_read_b64_tr_b16 a[44:45], v51 offset:28672
    ds_read_b64_tr_b16 a[46:47], v51 offset:29696
    s_waitcnt vmcnt(17) lgkmcnt(12)
    v_mfma_f32_32x32x16_bf16 v[64:79], a[16:19], a[100:103], v[64:79]
    ds_read_b64_tr_b16 a[0:1], v50 offset:22528
    ds_read_b64_tr_b16 a[2:3], v50 offset:23552
    v_mfma_f32_32x32x16_bf16 v[80:95], a[20:23], a[100:103], v[80:95]
    ds_read_b64_tr_b16 a[4:5], v51 offset:22528
    ds_read_b64_tr_b16 a[6:7], v51 offset:23552
    s_add_u32 m0, s47, 91136
    s_mov_b32 s3, 1575936
    buffer_load_dwordx4 v49, s[20:23], s3 offen lds
    s_waitcnt lgkmcnt(12)
    v_mfma_f32_32x32x16_bf16 v[96:111], a[24:27], a[100:103], v[96:111]
    ds_read_b64_tr_b16 a[8:9], v50 offset:30720
    ds_read_b64_tr_b16 a[10:11], v50 offset:31744
    buffer_load_dwordx4 a[140:143], v10, s[32:35], s96 offen offset:3072 sc1
    s_add_u32 s96, s96, 4096
    v_mfma_f32_32x32x16_bf16 v[112:127], a[28:31], a[100:103], v[112:127]
    ds_read_b64_tr_b16 a[12:13], v51 offset:30720
    ds_read_b64_tr_b16 a[14:15], v51 offset:31744
    s_barrier
    s_waitcnt vmcnt(17) lgkmcnt(12)
    v_mfma_f32_32x32x16_bf16 v[64:79], a[32:35], a[104:107], v[64:79]
    ds_read_b64_tr_b16 a[16:17], v50 offset:32768
    ds_read_b64_tr_b16 a[18:19], v50 offset:33792
    v_mfma_f32_32x32x16_bf16 v[80:95], a[36:39], a[104:107], v[80:95]
    ds_read_b64_tr_b16 a[20:21], v51 offset:32768
    ds_read_b64_tr_b16 a[22:23], v51 offset:33792
    s_add_u32 m0, s47, 98304
    s_mov_b32 s3, 1769472
    buffer_load_dwordx4 v49, s[16:19], s3 offen lds
    s_waitcnt lgkmcnt(12)
    v_mfma_f32_32x32x16_bf16 v[96:111], a[40:43], a[104:107], v[96:111]
    ds_read_b64_tr_b16 a[24:25], v50 offset:40960
    ds_read_b64_tr_b16 a[26:27], v50 offset:41984
    buffer_load_dwordx4 a[144:147], v10, s[32:35], s96 offen offset:0 sc1
    v_mfma_f32_32x32x16_bf16 v[112:127], a[44:47], a[104:107], v[112:127]
    ds_read_b64_tr_b16 a[28:29], v51 offset:40960
    ds_read_b64_tr_b16 a[30:31], v51 offset:41984
    s_waitcnt vmcnt(18) lgkmcnt(12)
    v_mfma_f32_32x32x16_bf16 v[64:79], a[0:3], a[108:111], v[64:79]
    ds_read_b64_tr_b16 a[32:33], v50 offset:34816
    ds_read_b64_tr_b16 a[34:35], v50 offset:35840
    v_mfma_f32_32x32x16_bf16 v[80:95], a[4:7], a[108:111], v[80:95]
    ds_read_b64_tr_b16 a[36:37], v51 offset:34816
    ds_read_b64_tr_b16 a[38:39], v51 offset:35840
    s_add_u32 m0, s47, 99328
    s_mov_b32 s3, 1797120
    buffer_load_dwordx4 v49, s[16:19], s3 offen lds
    s_waitcnt lgkmcnt(12)
    v_mfma_f32_32x32x16_bf16 v[96:111], a[8:11], a[108:111], v[96:111]
    ds_read_b64_tr_b16 a[40:41], v50 offset:43008
    ds_read_b64_tr_b16 a[42:43], v50 offset:44032
    buffer_load_dwordx4 a[148:151], v10, s[32:35], s96 offen offset:1024 sc1
    v_mfma_f32_32x32x16_bf16 v[112:127], a[12:15], a[108:111], v[112:127]
    ds_read_b64_tr_b16 a[44:45], v51 offset:43008
    ds_read_b64_tr_b16 a[46:47], v51 offset:44032
    s_waitcnt vmcnt(18) lgkmcnt(12)
    v_mfma_f32_32x32x16_bf16 v[64:79], a[16:19], a[112:115], v[64:79]
    ds_read_b64_tr_b16 a[0:1], v50 offset:36864
    ds_read_b64_tr_b16 a[2:3], v50 offset:37888
    v_mfma_f32_32x32x16_bf16 v[80:95], a[20:23], a[112:115], v[80:95]
    ds_read_b64_tr_b16 a[4:5], v51 offset:36864
    ds_read_b64_tr_b16 a[6:7], v51 offset:37888
    s_add_u32 m0, s47, 106496
    s_mov_b32 s3, 1769472
    buffer_load_dwordx4 v49, s[20:23], s3 offen lds
    s_waitcnt lgkmcnt(12)
    v_mfma_f32_32x32x16_bf16 v[96:111], a[24:27], a[112:115], v[96:111]
    ds_read_b64_tr_b16 a[8:9], v50 offset:45056
    ds_read_b64_tr_b16 a[10:11], v50 offset:46080
    buffer_load_dwordx4 a[152:155], v10, s[32:35], s96 offen offset:2048 sc1
    v_mfma_f32_32x32x16_bf16 v[112:127], a[28:31], a[112:115], v[112:127]
    ds_read_b64_tr_b16 a[12:13], v51 offset:45056
    ds_read_b64_tr_b16 a[14:15], v51 offset:46080
    s_waitcnt vmcnt(18) lgkmcnt(12)
    v_mfma_f32_32x32x16_bf16 v[64:79], a[32:35], a[116:119], v[64:79]
    ds_read_b64_tr_b16 a[16:17], v50 offset:38912
    ds_read_b64_tr_b16 a[18:19], v50 offset:39936
    v_mfma_f32_32x32x16_bf16 v[80:95], a[36:39], a[116:119], v[80:95]
    ds_read_b64_tr_b16 a[20:21], v51 offset:38912
    ds_read_b64_tr_b16 a[22:23], v51 offset:39936
    s_add_u32 m0, s47, 107520
    s_mov_b32 s3, 1797120
    buffer_load_dwordx4 v49, s[20:23], s3 offen lds
    s_waitcnt lgkmcnt(12)
    v_mfma_f32_32x32x16_bf16 v[96:111], a[40:43], a[116:119], v[96:111]
    ds_read_b64_tr_b16 a[24:25], v50 offset:47104
    ds_read_b64_tr_b16 a[26:27], v50 offset:48128
    buffer_load_dwordx4 a[156:159], v10, s[32:35], s96 offen offset:3072 sc1
    s_add_u32 s96, s96, 4096
    v_mfma_f32_32x32x16_bf16 v[112:127], a[44:47], a[116:119], v[112:127]
    ds_read_b64_tr_b16 a[28:29], v51 offset:47104
    ds_read_b64_tr_b16 a[30:31], v51 offset:48128
    s_waitcnt vmcnt(18) lgkmcnt(12)
    v_mfma_f32_32x32x16_bf16 v[64:79], a[0:3], a[120:123], v[64:79]
    ds_read_b64_tr_b16 a[32:33], v50 offset:49152
    ds_read_b64_tr_b16 a[34:35], v50 offset:50176
    v_mfma_f32_32x32x16_bf16 v[80:95], a[4:7], a[120:123], v[80:95]
    ds_read_b64_tr_b16 a[36:37], v51 offset:49152
    ds_read_b64_tr_b16 a[38:39], v51 offset:50176
    s_add_u32 m0, s47, 114688
    s_mov_b32 s3, 1990656
    buffer_load_dwordx4 v49, s[16:19], s3 offen lds
    s_waitcnt lgkmcnt(12)
    v_mfma_f32_32x32x16_bf16 v[96:111], a[8:11], a[120:123], v[96:111]
    ds_read_b64_tr_b16 a[40:41], v50 offset:57344
    ds_read_b64_tr_b16 a[42:43], v50 offset:58368
    buffer_load_dwordx4 a[160:163], v10, s[32:35], s96 offen offset:0 sc1
    v_mfma_f32_32x32x16_bf16 v[112:127], a[12:15], a[120:123], v[112:127]
    ds_read_b64_tr_b16 a[44:45], v51 offset:57344
    ds_read_b64_tr_b16 a[46:47], v51 offset:58368
    s_waitcnt vmcnt(18) lgkmcnt(12)
    v_mfma_f32_32x32x16_bf16 v[64:79], a[16:19], a[124:127], v[64:79]
    ds_read_b64_tr_b16 a[0:1], v50 offset:51200
    ds_read_b64_tr_b16 a[2:3], v50 offset:52224
    v_mfma_f32_32x32x16_bf16 v[80:95], a[20:23], a[124:127], v[80:95]
    ds_read_b64_tr_b16 a[4:5], v51 offset:51200
    ds_read_b64_tr_b16 a[6:7], v51 offset:52224
    s_add_u32 m0, s47, 115712
    s_mov_b32 s3, 2018304
    buffer_load_dwordx4 v49, s[16:19], s3 offen lds
    s_waitcnt lgkmcnt(12)
    v_mfma_f32_32x32x16_bf16 v[96:111], a[24:27], a[124:127], v[96:111]
    ds_read_b64_tr_b16 a[8:9], v50 offset:59392
    ds_read_b64_tr_b16 a[10:11], v50 offset:60416
    buffer_load_dwordx4 a[164:167], v10, s[32:35], s96 offen offset:1024 sc1
    v_mfma_f32_32x32x16_bf16 v[112:127], a[28:31], a[124:127], v[112:127]
    ds_read_b64_tr_b16 a[12:13], v51 offset:59392
    ds_read_b64_tr_b16 a[14:15], v51 offset:60416
    v_readfirstlane_b32 s62, v47
    s_mov_b32 s100, 0
    s_nop 2
    s_cmp_ge_u32 s62, 54
    s_cbranch_scc1 L_csok_38
L_csspin_39:
    buffer_load_dword v47, v46, s[32:35], 0 offen sc1
    s_add_u32 s100, s100, 1
    s_waitcnt vmcnt(0)
    v_readfirstlane_b32 s62, v47
    s_cmp_ge_u32 s100, 400000
    s_cbranch_scc1 L_csok_38
    s_cmp_lt_u32 s62, 54
    s_cbranch_scc1 L_csspin_39
L_csok_38:
    s_lshl_b32 s48, s41, 7
    s_lshl_b32 s49, s40, 5
    s_add_u32 s48, s48, s49
    v_add_u32 v4, s48, v2
    v_lshlrev_b32 v4, 3, v4
    v_mul_u32_u24 v5, 81920, v3
    v_add_u32 v4, v4, v5
    s_mov_b32 s48, 7340032
    buffer_load_dwordx2 v[232:233], v4, s[32:35], s48 offen sc1
    s_mov_b32 s48, 7356416
    buffer_load_dwordx2 v[234:235], v4, s[32:35], s48 offen sc1
    s_mov_b32 s48, 7372800
    buffer_load_dwordx2 v[236:237], v4, s[32:35], s48 offen sc1
    s_mov_b32 s48, 7389184
    buffer_load_dwordx2 v[238:239], v4, s[32:35], s48 offen sc1
    s_mov_b32 s48, 7405568
    buffer_load_dwordx2 v[240:241], v4, s[32:35], s48 offen sc1
    s_lshl_b32 s48, s44, 9
    v_lshlrev_b32 v4, 4, v2
    v_mul_u32_u24 v5, 6912, v3
    v_add_u32 v4, v4, v5
    v_add_u32 v4, s48, v4
    s_mov_b32 m0, 139264
    s_mov_b32 s48, 7602176
    buffer_load_dwordx4 v4, s[32:35], s48 offen sc1 lds
    s_waitcnt vmcnt(24) lgkmcnt(12)
    v_mfma_f32_32x32x16_bf16 v[64:79], a[32:35], a[128:131], v[64:79]
    ds_read_b64_tr_b16 a[16:17], v50 offset:53248
    ds_read_b64_tr_b16 a[18:19], v50 offset:54272
    v_mfma_f32_32x32x16_bf16 v[80:95], a[36:39], a[128:131], v[80:95]
    ds_read_b64_tr_b16 a[20:21], v51 offset:53248
    ds_read_b64_tr_b16 a[22:23], v51 offset:54272
    s_add_u32 m0, s47, 122880
    s_mov_b32 s3, 1990656
    buffer_load_dwordx4 v49, s[20:23], s3 offen lds
    s_waitcnt lgkmcnt(12)
    v_mfma_f32_32x32x16_bf16 v[96:111], a[40:43], a[128:131], v[96:111]
    ds_read_b64_tr_b16 a[24:25], v50 offset:61440
    ds_read_b64_tr_b16 a[26:27], v50 offset:62464
    buffer_load_dwordx4 a[168:171], v10, s[32:35], s96 offen offset:2048 sc1
    v_mfma_f32_32x32x16_bf16 v[112:127], a[44:47], a[128:131], v[112:127]
    ds_read_b64_tr_b16 a[28:29], v51 offset:61440
    ds_read_b64_tr_b16 a[30:31], v51 offset:62464
    s_waitcnt vmcnt(24) lgkmcnt(12)
    v_mfma_f32_32x32x16_bf16 v[64:79], a[0:3], a[132:135], v[64:79]
    ds_read_b64_tr_b16 a[32:33], v50 offset:55296
    ds_read_b64_tr_b16 a[34:35], v50 offset:56320
    v_mfma_f32_32x32x16_bf16 v[80:95], a[4:7], a[132:135], v[80:95]
    ds_read_b64_tr_b16 a[36:37], v51 offset:55296
    ds_read_b64_tr_b16 a[38:39], v51 offset:56320
    s_add_u32 m0, s47, 123904
    s_mov_b32 s3, 2018304
    buffer_load_dwordx4 v49, s[20:23], s3 offen lds
    s_waitcnt lgkmcnt(12)
    v_mfma_f32_32x32x16_bf16 v[96:111], a[8:11], a[132:135], v[96:111]
    ds_read_b64_tr_b16 a[40:41], v50 offset:63488
    ds_read_b64_tr_b16 a[42:43], v50 offset:64512
    buffer_load_dwordx4 a[172:175], v10, s[32:35], s96 offen offset:3072 sc1
    s_add_u32 s96, s96, 4096
    v_mfma_f32_32x32x16_bf16 v[112:127], a[12:15], a[132:135], v[112:127]
    ds_read_b64_tr_b16 a[44:45], v51 offset:63488
    ds_read_b64_tr_b16 a[46:47], v51 offset:64512
    s_waitcnt vmcnt(23)
    s_barrier
    s_waitcnt lgkmcnt(12)
    v_mfma_f32_32x32x16_bf16 v[64:79], a[16:19], a[136:139], v[64:79]
    ds_read_b64_tr_b16 a[0:1], v52 offset:0
    ds_read_b64_tr_b16 a[2:3], v52 offset:1024
    v_mfma_f32_32x32x16_bf16 v[80:95], a[20:23], a[136:139], v[80:95]
    ds_read_b64_tr_b16 a[4:5], v53 offset:0
    ds_read_b64_tr_b16 a[6:7], v53 offset:1024
    s_add_u32 m0, s47, 0
    s_mov_b32 s3, 128
    buffer_load_dwordx4 v49, s[16:19], s3 offen lds
    s_waitcnt lgkmcnt(12)
    v_mfma_f32_32x32x16_bf16 v[96:111], a[24:27], a[136:139], v[96:111]
    ds_read_b64_tr_b16 a[8:9], v52 offset:8192
    ds_read_b64_tr_b16 a[10:11], v52 offset:9216
    buffer_load_dwordx4 a[176:179], v10, s[32:35], s96 offen offset:0 sc1
    v_mfma_f32_32x32x16_bf16 v[112:127], a[28:31], a[136:139], v[112:127]
    ds_read_b64_tr_b16 a[12:13], v53 offset:8192
    ds_read_b64_tr_b16 a[14:15], v53 offset:9216
    s_waitcnt vmcnt(24) lgkmcnt(12)
    v_mfma_f32_32x32x16_bf16 v[64:79], a[32:35], a[140:143], v[64:79]
    ds_read_b64_tr_b16 a[16:17], v52 offset:2048
    ds_read_b64_tr_b16 a[18:19], v52 offset:3072
    v_mfma_f32_32x32x16_bf16 v[80:95], a[36:39], a[140:143], v[80:95]
    ds_read_b64_tr_b16 a[20:21], v53 offset:2048
    ds_read_b64_tr_b16 a[22:23], v53 offset:3072
    s_add_u32 m0, s47, 1024
    s_mov_b32 s3, 27776
    buffer_load_dwordx4 v49, s[16:19], s3 offen lds
    s_waitcnt lgkmcnt(12)
    v_mfma_f32_32x32x16_bf16 v[96:111], a[40:43], a[140:143], v[96:111]
    ds_read_b64_tr_b16 a[24:25], v52 offset:10240
    ds_read_b64_tr_b16 a[26:27], v52 offset:11264
    buffer_load_dwordx4 a[180:183], v10, s[32:35], s96 offen offset:1024 sc1
    v_mfma_f32_32x32x16_bf16 v[112:127], a[44:47], a[140:143], v[112:127]
    ds_read_b64_tr_b16 a[28:29], v53 offset:10240
    ds_read_b64_tr_b16 a[30:31], v53 offset:11264
    s_waitcnt vmcnt(24) lgkmcnt(12)
    v_mfma_f32_32x32x16_bf16 v[64:79], a[0:3], a[144:147], v[64:79]
    ds_read_b64_tr_b16 a[32:33], v52 offset:4096
    ds_read_b64_tr_b16 a[34:35], v52 offset:5120
    v_mfma_f32_32x32x16_bf16 v[80:95], a[4:7], a[144:147], v[80:95]
    ds_read_b64_tr_b16 a[36:37], v53 offset:4096
    ds_read_b64_tr_b16 a[38:39], v53 offset:5120
    s_add_u32 m0, s47, 8192
    s_mov_b32 s3, 128
    buffer_load_dwordx4 v49, s[20:23], s3 offen lds
    s_waitcnt lgkmcnt(12)
    v_mfma_f32_32x32x16_bf16 v[96:111], a[8:11], a[144:147], v[96:111]
    ds_read_b64_tr_b16 a[40:41], v52 offset:12288
    ds_read_b64_tr_b16 a[42:43], v52 offset:13312
    buffer_load_dwordx4 a[184:187], v10, s[32:35], s96 offen offset:2048 sc1
    v_mfma_f32_32x32x16_bf16 v[112:127], a[12:15], a[144:147], v[112:127]
    ds_read_b64_tr_b16 a[44:45], v53 offset:12288
    ds_read_b64_tr_b16 a[46:47], v53 offset:13312
    s_waitcnt vmcnt(24) lgkmcnt(12)
    v_mfma_f32_32x32x16_bf16 v[64:79], a[16:19], a[148:151], v[64:79]
    ds_read_b64_tr_b16 a[0:1], v52 offset:6144
    ds_read_b64_tr_b16 a[2:3], v52 offset:7168
    v_mfma_f32_32x32x16_bf16 v[80:95], a[20:23], a[148:151], v[80:95]
    ds_read_b64_tr_b16 a[4:5], v53 offset:6144
    ds_read_b64_tr_b16 a[6:7], v53 offset:7168
    s_add_u32 m0, s47, 9216
    s_mov_b32 s3, 27776
    buffer_load_dwordx4 v49, s[20:23], s3 offen lds
    s_waitcnt lgkmcnt(12)
    v_mfma_f32_32x32x16_bf16 v[96:111], a[24:27], a[148:151], v[96:111]
    ds_read_b64_tr_b16 a[8:9], v52 offset:14336
    ds_read_b64_tr_b16 a[10:11], v52 offset:15360
    buffer_load_dwordx4 a[188:191], v10, s[32:35], s96 offen offset:3072 sc1
    s_add_u32 s96, s96, 4096
    v_mfma_f32_32x32x16_bf16 v[112:127], a[28:31], a[148:151], v[112:127]
    ds_read_b64_tr_b16 a[12:13], v53 offset:14336
    ds_read_b64_tr_b16 a[14:15], v53 offset:15360
    s_waitcnt vmcnt(24) lgkmcnt(12)
    v_mfma_f32_32x32x16_bf16 v[64:79], a[32:35], a[152:155], v[64:79]
    ds_read_b64_tr_b16 a[16:17], v52 offset:16384
    ds_read_b64_tr_b16 a[18:19], v52 offset:17408
    v_mfma_f32_32x32x16_bf16 v[80:95], a[36:39], a[152:155], v[80:95]
    ds_read_b64_tr_b16 a[20:21], v53 offset:16384
    ds_read_b64_tr_b16 a[22:23], v53 offset:17408
    s_add_u32 m0, s47, 16384
    s_mov_b32 s3, 221312
    buffer_load_dwordx4 v49, s[16:19], s3 offen lds
    s_waitcnt lgkmcnt(12)
    v_mfma_f32_32x32x16_bf16 v[96:111], a[40:43], a[152:155], v[96:111]
    ds_read_b64_tr_b16 a[24:25], v52 offset:24576
    ds_read_b64_tr_b16 a[26:27], v52 offset:25600
    buffer_load_dwordx4 a[192:195], v10, s[32:35], s96 offen offset:0 sc1
    v_mfma_f32_32x32x16_bf16 v[112:127], a[44:47], a[152:155], v[112:127]
    ds_read_b64_tr_b16 a[28:29], v53 offset:24576
    ds_read_b64_tr_b16 a[30:31], v53 offset:25600
    s_waitcnt vmcnt(24) lgkmcnt(12)
    v_mfma_f32_32x32x16_bf16 v[64:79], a[0:3], a[156:159], v[64:79]
    ds_read_b64_tr_b16 a[32:33], v52 offset:18432
    ds_read_b64_tr_b16 a[34:35], v52 offset:19456
    v_mfma_f32_32x32x16_bf16 v[80:95], a[4:7], a[156:159], v[80:95]
    ds_read_b64_tr_b16 a[36:37], v53 offset:18432
    ds_read_b64_tr_b16 a[38:39], v53 offset:19456
    s_add_u32 m0, s47, 17408
    s_mov_b32 s3, 248960
    buffer_load_dwordx4 v49, s[16:19], s3 offen lds
    s_waitcnt lgkmcnt(12)
    v_mfma_f32_32x32x16_bf16 v[96:111], a[8:11], a[156:159], v[96:111]
    ds_read_b64_tr_b16 a[40:41], v52 offset:26624
    ds_read_b64_tr_b16 a[42:43], v52 offset:27648
    buffer_load_dwordx4 a[196:199], v10, s[32:35], s96 offen offset:1024 sc1
    v_mfma_f32_32x32x16_bf16 v[112:127], a[12:15], a[156:159], v[112:127]
    ds_read_b64_tr_b16 a[44:45], v53 offset:26624
    ds_read_b64_tr_b16 a[46:47], v53 offset:27648
    s_waitcnt vmcnt(24) lgkmcnt(12)
    v_mfma_f32_32x32x16_bf16 v[64:79], a[16:19], a[160:163], v[64:79]
    ds_read_b64_tr_b16 a[0:1], v52 offset:20480
    ds_read_b64_tr_b16 a[2:3], v52 offset:21504
    v_mfma_f32_32x32x16_bf16 v[80:95], a[20:23], a[160:163], v[80:95]
    ds_read_b64_tr_b16 a[4:5], v53 offset:20480
    ds_read_b64_tr_b16 a[6:7], v53 offset:21504
    s_add_u32 m0, s47, 24576
    s_mov_b32 s3, 221312
    buffer_load_dwordx4 v49, s[20:23], s3 offen lds
    s_waitcnt lgkmcnt(12)
    v_mfma_f32_32x32x16_bf16 v[96:111], a[24:27], a[160:163], v[96:111]
    ds_read_b64_tr_b16 a[8:9], v52 offset:28672
    ds_read_b64_tr_b16 a[10:11], v52 offset:29696
    buffer_load_dwordx4 a[200:203], v10, s[32:35], s96 offen offset:2048 sc1
    v_mfma_f32_32x32x16_bf16 v[112:127], a[28:31], a[160:163], v[112:127]
    ds_read_b64_tr_b16 a[12:13], v53 offset:28672
    ds_read_b64_tr_b16 a[14:15], v53 offset:29696
    s_waitcnt vmcnt(24) lgkmcnt(12)
    v_mfma_f32_32x32x16_bf16 v[64:79], a[32:35], a[164:167], v[64:79]
    ds_read_b64_tr_b16 a[16:17], v52 offset:22528
    ds_read_b64_tr_b16 a[18:19], v52 offset:23552
    v_mfma_f32_32x32x16_bf16 v[80:95], a[36:39], a[164:167], v[80:95]
    ds_read_b64_tr_b16 a[20:21], v53 offset:22528
    ds_read_b64_tr_b16 a[22:23], v53 offset:23552
    s_add_u32 m0, s47, 25600
    s_mov_b32 s3, 248960
    buffer_load_dwordx4 v49, s[20:23], s3 offen lds
    s_waitcnt lgkmcnt(12)
    v_mfma_f32_32x32x16_bf16 v[96:111], a[40:43], a[164:167], v[96:111]
    ds_read_b64_tr_b16 a[24:25], v52 offset:30720
    ds_read_b64_tr_b16 a[26:27], v52 offset:31744
    buffer_load_dwordx4 a[204:207], v10, s[32:35], s96 offen offset:3072 sc1
    s_add_u32 s96, s96, 4096
    v_mfma_f32_32x32x16_bf16 v[112:127], a[44:47], a[164:167], v[112:127]
    ds_read_b64_tr_b16 a[28:29], v53 offset:30720
    ds_read_b64_tr_b16 a[30:31], v53 offset:31744
    s_waitcnt vmcnt(17)
    s_barrier
    s_waitcnt lgkmcnt(12)
    v_mfma_f32_32x32x16_bf16 v[64:79], a[0:3], a[168:171], v[64:79]
    ds_read_b64_tr_b16 a[32:33], v52 offset:32768
    ds_read_b64_tr_b16 a[34:35], v52 offset:33792
    v_mfma_f32_32x32x16_bf16 v[80:95], a[4:7], a[168:171], v[80:95]
    ds_read_b64_tr_b16 a[36:37], v53 offset:32768
    ds_read_b64_tr_b16 a[38:39], v53 offset:33792
    s_add_u32 m0, s47, 32768
    s_mov_b32 s3, 442496
    buffer_load_dwordx4 v49, s[16:19], s3 offen lds
    s_waitcnt lgkmcnt(12)
    v_mfma_f32_32x32x16_bf16 v[96:111], a[8:11], a[168:171], v[96:111]
    ds_read_b64_tr_b16 a[40:41], v52 offset:40960
    ds_read_b64_tr_b16 a[42:43], v52 offset:41984
    v_mfma_f32_32x32x16_bf16 v[112:127], a[12:15], a[168:171], v[112:127]
    ds_read_b64_tr_b16 a[44:45], v53 offset:40960
    ds_read_b64_tr_b16 a[46:47], v53 offset:41984
    s_waitcnt vmcnt(17) lgkmcnt(12)
    v_mfma_f32_32x32x16_bf16 v[64:79], a[16:19], a[172:175], v[64:79]
    ds_read_b64_tr_b16 a[0:1], v52 offset:34816
    ds_read_b64_tr_b16 a[2:3], v52 offset:35840
    v_mfma_f32_32x32x16_bf16 v[80:95], a[20:23], a[172:175], v[80:95]
    ds_read_b64_tr_b16 a[4:5], v53 offset:34816
    ds_read_b64_tr_b16 a[6:7], v53 offset:35840
    s_add_u32 m0, s47, 33792
    s_mov_b32 s3, 470144
    buffer_load_dwordx4 v49, s[16:19], s3 offen lds
    s_waitcnt lgkmcnt(12)
    v_mfma_f32_32x32x16_bf16 v[96:111], a[24:27], a[172:175], v[96:111]
    ds_read_b64_tr_b16 a[8:9], v52 offset:43008
    ds_read_b64_tr_b16 a[10:11], v52 offset:44032
    v_mfma_f32_32x32x16_bf16 v[112:127], a[28:31], a[172:175], v[112:127]
    ds_read_b64_tr_b16 a[12:13], v53 offset:43008
    ds_read_b64_tr_b16 a[14:15], v53 offset:44032
    s_waitcnt vmcnt(16) lgkmcnt(12)
    v_mfma_f32_32x32x16_bf16 v[64:79], a[32:35], a[176:179], v[64:79]
    ds_read_b64_tr_b16 a[16:17], v52 offset:36864
    ds_read_b64_tr_b16 a[18:19], v52 offset:37888
    v_mfma_f32_32x32x16_bf16 v[80:95], a[36:39], a[176:179], v[80:95]
    ds_read_b64_tr_b16 a[20:21], v53 offset:36864
    ds_read_b64_tr_b16 a[22:23], v53 offset:37888
    s_add_u32 m0, s47, 40960
    s_mov_b32 s3, 442496
    buffer_load_dwordx4 v49, s[20:23], s3 offen lds
    s_waitcnt lgkmcnt(12)
    v_mfma_f32_32x32x16_bf16 v[96:111], a[40:43], a[176:179], v[96:111]
    ds_read_b64_tr_b16 a[24:25], v52 offset:45056
    ds_read_b64_tr_b16 a[26:27], v52 offset:46080
    v_mfma_f32_32x32x16_bf16 v[112:127], a[44:47], a[176:179], v[112:127]
    ds_read_b64_tr_b16 a[28:29], v53 offset:45056
    ds_read_b64_tr_b16 a[30:31], v53 offset:46080
    s_waitcnt vmcnt(15) lgkmcnt(12)
    v_mfma_f32_32x32x16_bf16 v[64:79], a[0:3], a[180:183], v[64:79]
    ds_read_b64_tr_b16 a[32:33], v52 offset:38912
    ds_read_b64_tr_b16 a[34:35], v52 offset:39936
    v_mfma_f32_32x32x16_bf16 v[80:95], a[4:7], a[180:183], v[80:95]
    ds_read_b64_tr_b16 a[36:37], v53 offset:38912
    ds_read_b64_tr_b16 a[38:39], v53 offset:39936
    s_add_u32 m0, s47, 41984
    s_mov_b32 s3, 470144
    buffer_load_dwordx4 v49, s[20:23], s3 offen lds
    s_waitcnt lgkmcnt(12)
    v_mfma_f32_32x32x16_bf16 v[96:111], a[8:11], a[180:183], v[96:111]
    ds_read_b64_tr_b16 a[40:41], v52 offset:47104
    ds_read_b64_tr_b16 a[42:43], v52 offset:48128
    v_mfma_f32_32x32x16_bf16 v[112:127], a[12:15], a[180:183], v[112:127]
    ds_read_b64_tr_b16 a[44:45], v53 offset:47104
    ds_read_b64_tr_b16 a[46:47], v53 offset:48128
    s_waitcnt vmcnt(14) lgkmcnt(12)
    v_mfma_f32_32x32x16_bf16 v[64:79], a[16:19], a[184:187], v[64:79]
    ds_read_b64_tr_b16 a[0:1], v52 offset:49152
    ds_read_b64_tr_b16 a[2:3], v52 offset:50176
    v_add_f32 v8, v232, v234
    v_mfma_f32_32x32x16_bf16 v[80:95], a[20:23], a[184:187], v[80:95]
    ds_read_b64_tr_b16 a[4:5], v53 offset:49152
    ds_read_b64_tr_b16 a[6:7], v53 offset:50176
    s_add_u32 m0, s47, 49152
    s_mov_b32 s3, 663680
    buffer_load_dwordx4 v49, s[16:19], s3 offen lds
    v_add_f32 v9, v233, v235
    v_add_f32 v8, v8, v236
    s_waitcnt lgkmcnt(12)
    v_mfma_f32_32x32x16_bf16 v[96:111], a[24:27], a[184:187], v[96:111]
    ds_read_b64_tr_b16 a[8:9], v52 offset:57344
    ds_read_b64_tr_b16 a[10:11], v52 offset:58368
    v_add_f32 v9, v9, v237
    v_add_f32 v8, v8, v238
    v_mfma_f32_32x32x16_bf16 v[112:127], a[28:31], a[184:187], v[112:127]
    ds_read_b64_tr_b16 a[12:13], v53 offset:57344
    ds_read_b64_tr_b16 a[14:15], v53 offset:58368
    v_add_f32 v9, v9, v239
    v_add_f32 v8, v8, v240
    s_waitcnt vmcnt(13) lgkmcnt(12)
    v_mfma_f32_32x32x16_bf16 v[64:79], a[32:35], a[188:191], v[64:79]
    ds_read_b64_tr_b16 a[16:17], v52 offset:51200
    ds_read_b64_tr_b16 a[18:19], v52 offset:52224
    v_add_f32 v9, v9, v241
    v_mov_b32 v4, v8
    v_mfma_f32_32x32x16_bf16 v[80:95], a[36:39], a[188:191], v[80:95]
    ds_read_b64_tr_b16 a[20:21], v53 offset:51200
    ds_read_b64_tr_b16 a[22:23], v53 offset:52224
    s_add_u32 m0, s47, 50176
    s_mov_b32 s3, 691328
    buffer_load_dwordx4 v49, s[16:19], s3 offen lds
    v_mov_b32 v5, v9
    v_lshlrev_b32 v14, 4, v3
    s_waitcnt lgkmcnt(12)
    v_mfma_f32_32x32x16_bf16 v[96:111], a[40:43], a[188:191], v[96:111]
    ds_read_b64_tr_b16 a[24:25], v52 offset:59392
    ds_read_b64_tr_b16 a[26:27], v52 offset:60416
    v_add_u32 v14, 139264, v14
    v_permlane32_swap_b32 v8, v4
    v_permlane32_swap_b32 v9, v5
    v_mfma_f32_32x32x16_bf16 v[112:127], a[44:47], a[188:191], v[112:127]
    ds_read_b64_tr_b16 a[28:29], v53 offset:59392
    ds_read_b64_tr_b16 a[30:31], v53 offset:60416
    v_add_f32 v8, v8, v4
    v_add_f32 v9, v9, v5
    s_waitcnt vmcnt(12) lgkmcnt(12)
    v_mfma_f32_32x32x16_bf16 v[64:79], a[0:3], a[192:195], v[64:79]
    ds_read_b64_tr_b16 a[32:33], v52 offset:53248
    ds_read_b64_tr_b16 a[34:35], v52 offset:54272
    s_mov_b32 s70, 0x3acccccd
    s_mov_b32 s71, 0x3727c5ac
    v_mfma_f32_32x32x16_bf16 v[80:95], a[4:7], a[192:195], v[80:95]
    ds_read_b64_tr_b16 a[36:37], v53 offset:53248
    ds_read_b64_tr_b16 a[38:39], v53 offset:54272
    s_add_u32 m0, s47, 57344
    s_mov_b32 s3, 663680
    buffer_load_dwordx4 v49, s[20:23], s3 offen lds
    v_mul_f32 v8, s70, v8
    v_mul_f32 v9, s70, v9
    s_waitcnt lgkmcnt(12)
    v_mfma_f32_32x32x16_bf16 v[96:111], a[8:11], a[192:195], v[96:111]
    ds_read_b64_tr_b16 a[40:41], v52 offset:61440
    ds_read_b64_tr_b16 a[42:43], v52 offset:62464
    v_fma_f32 v9, -v8, v8, v9
    v_max_f32 v9, 0, v9
    v_mfma_f32_32x32x16_bf16 v[112:127], a[12:15], a[192:195], v[112:127]
    ds_read_b64_tr_b16 a[44:45], v53 offset:61440
    ds_read_b64_tr_b16 a[46:47], v53 offset:62464
    v_add_f32 v9, s71, v9
    v_rcp_f32 v12, v9
    s_waitcnt vmcnt(11) lgkmcnt(12)
    v_mfma_f32_32x32x16_bf16 v[64:79], a[16:19], a[196:199], v[64:79]
    ds_read_b64_tr_b16 a[0:1], v52 offset:55296
    ds_read_b64_tr_b16 a[2:3], v52 offset:56320
    v_sub_f32 v8, 0, v8
    s_lshl_b32 s56, s41, 2
    v_mfma_f32_32x32x16_bf16 v[80:95], a[20:23], a[196:199], v[80:95]
    ds_read_b64_tr_b16 a[4:5], v53 offset:55296
    ds_read_b64_tr_b16 a[6:7], v53 offset:56320
    s_add_u32 m0, s47, 58368
    s_mov_b32 s3, 691328
    buffer_load_dwordx4 v49, s[20:23], s3 offen lds
    s_add_u32 s56, s56, s40
    s_mul_i32 s56, s56, 110592
    s_waitcnt lgkmcnt(12)
    v_mfma_f32_32x32x16_bf16 v[96:111], a[24:27], a[196:199], v[96:111]
    ds_read_b64_tr_b16 a[8:9], v52 offset:63488
    ds_read_b64_tr_b16 a[10:11], v52 offset:64512
    s_lshl_b32 s57, s44, 13
    s_add_u32 s56, s56, s57
    v_mfma_f32_32x32x16_bf16 v[112:127], a[28:31], a[196:199], v[112:127]
    ds_read_b64_tr_b16 a[12:13], v53 offset:63488
    ds_read_b64_tr_b16 a[14:15], v53 offset:64512
    s_add_u32 s56, s56, 8388608
    s_waitcnt vmcnt(9)
    s_barrier
    s_waitcnt lgkmcnt(12)
    v_mfma_f32_32x32x16_bf16 v[64:79], a[32:35], a[200:203], v[64:79]
    ds_read_b64_tr_b16 a[16:17], v50 offset:0
    ds_read_b64_tr_b16 a[18:19], v50 offset:1024
    v_mfma_f32_32x32x16_bf16 v[80:95], a[36:39], a[200:203], v[80:95]
    ds_read_b64_tr_b16 a[20:21], v51 offset:0
    ds_read_b64_tr_b16 a[22:23], v51 offset:1024
    s_add_u32 m0, s47, 65536
    s_mov_b32 s3, 884864
    buffer_load_dwordx4 v49, s[16:19], s3 offen lds
    s_waitcnt lgkmcnt(12)
    v_mfma_f32_32x32x16_bf16 v[96:111], a[40:43], a[200:203], v[96:111]
    ds_read_b64_tr_b16 a[24:25], v50 offset:8192
    ds_read_b64_tr_b16 a[26:27], v50 offset:9216
    v_mfma_f32_32x32x16_bf16 v[112:127], a[44:47], a[200:203], v[112:127]
    ds_read_b64_tr_b16 a[28:29], v51 offset:8192
    ds_read_b64_tr_b16 a[30:31], v51 offset:9216
    s_waitcnt vmcnt(9) lgkmcnt(12)
    v_mfma_f32_32x32x16_bf16 v[64:79], a[0:3], a[204:207], v[64:79]
    ds_read_b64_tr_b16 a[32:33], v50 offset:2048
    ds_read_b64_tr_b16 a[34:35], v50 offset:3072
    v_mfma_f32_32x32x16_bf16 v[80:95], a[4:7], a[204:207], v[80:95]
    ds_read_b64_tr_b16 a[36:37], v51 offset:2048
    ds_read_b64_tr_b16 a[38:39], v51 offset:3072
    s_add_u32 m0, s47, 66560
    s_mov_b32 s3, 912512
    buffer_load_dwordx4 v49, s[16:19], s3 offen lds
    s_waitcnt lgkmcnt(12)
    v_mfma_f32_32x32x16_bf16 v[96:111], a[8:11], a[204:207], v[96:111]
    ds_read_b64_tr_b16 a[40:41], v50 offset:10240
    ds_read_b64_tr_b16 a[42:43], v50 offset:11264
    v_mfma_f32_32x32x16_bf16 v[112:127], a[12:15], a[204:207], v[112:127]
    ds_read_b64_tr_b16 a[44:45], v51 offset:10240
    ds_read_b64_tr_b16 a[46:47], v51 offset:11264
    s_waitcnt lgkmcnt(12)
    v_mfma_f32_32x32x16_bf16 v[128:143], a[16:19], a[48:51], 0
    ds_read_b64_tr_b16 a[0:1], v50 offset:4096
    ds_read_b64_tr_b16 a[2:3], v50 offset:5120
    v_mfma_f32_32x32x16_bf16 v[144:159], a[20:23], a[48:51], 0
    ds_read_b64_tr_b16 a[4:5], v51 offset:4096
    ds_read_b64_tr_b16 a[6:7], v51 offset:5120
    s_add_u32 m0, s47, 73728
    s_mov_b32 s3, 884864
    buffer_load_dwordx4 v49, s[20:23], s3 offen lds
    s_waitcnt lgkmcnt(12)
    v_mfma_f32_32x32x16_bf16 v[160:175], a[24:27], a[48:51], 0
    ds_read_b64_tr_b16 a[8:9], v50 offset:12288
    ds_read_b64_tr_b16 a[10:11], v50 offset:13312
    v_mfma_f32_32x32x16_bf16 v[176:191], a[28:31], a[48:51], 0
    ds_read_b64_tr_b16 a[12:13], v51 offset:12288
    ds_read_b64_tr_b16 a[14:15], v51 offset:13312
    s_waitcnt lgkmcnt(12)
    v_mfma_f32_32x32x16_bf16 v[128:143], a[32:35], a[52:55], v[128:143]
    ds_read_b64_tr_b16 a[16:17], v50 offset:6144
    ds_read_b64_tr_b16 a[18:19], v50 offset:7168
    v_mfma_f32_32x32x16_bf16 v[144:159], a[36:39], a[52:55], v[144:159]
    ds_read_b64_tr_b16 a[20:21], v51 offset:6144
    ds_read_b64_tr_b16 a[22:23], v51 offset:7168
    s_add_u32 m0, s47, 74752
    s_mov_b32 s3, 912512
    buffer_load_dwordx4 v49, s[20:23], s3 offen lds
    s_waitcnt lgkmcnt(12)
    v_mfma_f32_32x32x16_bf16 v[160:175], a[40:43], a[52:55], v[160:175]
    ds_read_b64_tr_b16 a[24:25], v50 offset:14336
    ds_read_b64_tr_b16 a[26:27], v50 offset:15360
    v_mfma_f32_32x32x16_bf16 v[176:191], a[44:47], a[52:55], v[176:191]
    ds_read_b64_tr_b16 a[28:29], v51 offset:14336
    ds_read_b64_tr_b16 a[30:31], v51 offset:15360
    s_waitcnt lgkmcnt(12)
    v_mfma_f32_32x32x16_bf16 v[128:143], a[0:3], a[56:59], v[128:143]
    ds_read_b64_tr_b16 a[32:33], v50 offset:16384
    ds_read_b64_tr_b16 a[34:35], v50 offset:17408
    ds_read_b128 v[192:195], v14 offset:0
    ds_read_b128 v[196:199], v14 offset:32
    ds_read_b128 v[200:203], v14 offset:64
    ds_read_b128 v[204:207], v14 offset:96
    ds_read_b128 v[208:211], v14 offset:512
    ds_read_b128 v[212:215], v14 offset:544
    ds_read_b128 v[216:219], v14 offset:576
    ds_read_b128 v[220:223], v14 offset:608
    v_mfma_f32_32x32x16_bf16 v[144:159], a[4:7], a[56:59], v[144:159]
    ds_read_b64_tr_b16 a[36:37], v51 offset:16384
    ds_read_b64_tr_b16 a[38:39], v51 offset:17408
    s_add_u32 m0, s47, 81920
    s_mov_b32 s3, 1106048
    buffer_load_dwordx4 v49, s[16:19], s3 offen lds
    s_waitcnt lgkmcnt(5)
    v_fma_f32 v64, v192, v8, v64
    v_mfma_f32_32x32x16_bf16 v[160:175], a[8:11], a[56:59], v[160:175]
    ds_read_b64_tr_b16 a[40:41], v50 offset:24576
    ds_read_b64_tr_b16 a[42:43], v50 offset:25600
    v_fma_f32 v96, v208, v8, v96
    v_fma_f32 v65, v193, v8, v65
    v_mfma_f32_32x32x16_bf16 v[176:191], a[12:15], a[56:59], v[176:191]
    ds_read_b64_tr_b16 a[44:45], v51 offset:24576
    ds_read_b64_tr_b16 a[46:47], v51 offset:25600
    v_fma_f32 v97, v209, v8, v97
    v_max_f32 v64, 0, v64
    v_mfma_f32_32x32x16_bf16 v[128:143], a[16:19], a[60:63], v[128:143]
    ds_read_b64_tr_b16 a[0:1], v50 offset:18432
    ds_read_b64_tr_b16 a[2:3], v50 offset:19456
    v_mul_f32 v96, v12, v96
    v_max_f32 v65, 0, v65
    v_mfma_f32_32x32x16_bf16 v[144:159], a[20:23], a[60:63], v[144:159]
    ds_read_b64_tr_b16 a[4:5], v51 offset:18432
    ds_read_b64_tr_b16 a[6:7], v51 offset:19456
    s_add_u32 m0, s47, 82944
    s_mov_b32 s3, 1133696
    buffer_load_dwordx4 v49, s[16:19], s3 offen lds
    v_mul_f32 v97, v12, v97
    v_mul_f32 v64, v64, v96
    v_mfma_f32_32x32x16_bf16 v[160:175], a[24:27], a[60:63], v[160:175]
    ds_read_b64_tr_b16 a[8:9], v50 offset:26624
    ds_read_b64_tr_b16 a[10:11], v50 offset:27648
    v_mul_f32 v65, v65, v97
    v_cvt_pk_bf16_f32 v16, v64, v65
    v_mfma_f32_32x32x16_bf16 v[176:191], a[28:31], a[60:63], v[176:191]
    ds_read_b64_tr_b16 a[12:13], v51 offset:26624
    ds_read_b64_tr_b16 a[14:15], v51 offset:27648
    v_fma_f32 v66, v194, v8, v66
    s_waitcnt lgkmcnt(12)
    v_mfma_f32_32x32x16_bf16 v[128:143], a[32:35], a[64:67], v[128:143]
    ds_read_b64_tr_b16 a[16:17], v50 offset:20480
    ds_read_b64_tr_b16 a[18:19], v50 offset:21504
    v_fma_f32 v98, v210, v8, v98
    v_fma_f32 v67, v195, v8, v67
    v_mfma_f32_32x32x16_bf16 v[144:159], a[36:39], a[64:67], v[144:159]
    ds_read_b64_tr_b16 a[20:21], v51 offset:20480
    ds_read_b64_tr_b16 a[22:23], v51 offset:21504
    s_add_u32 m0, s47, 90112
    s_mov_b32 s3, 1106048
    buffer_load_dwordx4 v49, s[20:23], s3 offen lds
    v_fma_f32 v99, v211, v8, v99
    v_max_f32 v66, 0, v66
    s_waitcnt lgkmcnt(12)
    v_mfma_f32_32x32x16_bf16 v[160:175], a[40:43], a[64:67], v[160:175]
    ds_read_b64_tr_b16 a[24:25], v50 offset:28672
    ds_read_b64_tr_b16 a[26:27], v50 offset:29696
    v_mul_f32 v98, v12, v98
    v_max_f32 v67, 0, v67
    v_mfma_f32_32x32x16_bf16 v[176:191], a[44:47], a[64:67], v[176:191]
    ds_read_b64_tr_b16 a[28:29], v51 offset:28672
    ds_read_b64_tr_b16 a[30:31], v51 offset:29696
    v_mul_f32 v99, v12, v99
    v_mul_f32 v66, v66, v98
    s_waitcnt lgkmcnt(12)
    v_mfma_f32_32x32x16_bf16 v[128:143], a[0:3], a[68:71], v[128:143]
    ds_read_b64_tr_b16 a[32:33], v50 offset:22528
    ds_read_b64_tr_b16 a[34:35], v50 offset:23552
    v_mul_f32 v67, v67, v99
    v_cvt_pk_bf16_f32 v17, v66, v67
    v_mfma_f32_32x32x16_bf16 v[144:159], a[4:7], a[68:71], v[144:159]
    ds_read_b64_tr_b16 a[36:37], v51 offset:22528
    ds_read_b64_tr_b16 a[38:39], v51 offset:23552
    s_add_u32 m0, s47, 91136
    s_mov_b32 s3, 1133696
    buffer_load_dwordx4 v49, s[20:23], s3 offen lds
    v_fma_f32 v68, v196, v8, v68
    s_waitcnt lgkmcnt(12)
    v_mfma_f32_32x32x16_bf16 v[160:175], a[8:11], a[68:71], v[160:175]
    ds_read_b64_tr_b16 a[40:41], v50 offset:30720
    ds_read_b64_tr_b16 a[42:43], v50 offset:31744
    v_fma_f32 v100, v212, v8, v100
    v_fma_f32 v69, v197, v8, v69
    v_mfma_f32_32x32x16_bf16 v[176:191], a[12:15], a[68:71], v[176:191]
    ds_read_b64_tr_b16 a[44:45], v51 offset:30720
    ds_read_b64_tr_b16 a[46:47], v51 offset:31744
    v_fma_f32 v101, v213, v8, v101
    v_max_f32 v68, 0, v68
    s_waitcnt vmcnt(8)
    s_barrier
    s_waitcnt lgkmcnt(12)
    v_mfma_f32_32x32x16_bf16 v[128:143], a[16:19], a[72:75], v[128:143]
    ds_read_b64_tr_b16 a[0:1], v50 offset:32768
    ds_read_b64_tr_b16 a[2:3], v50 offset:33792
    v_mul_f32 v100, v12, v100
    v_max_f32 v69, 0, v69
    v_mfma_f32_32x32x16_bf16 v[144:159], a[20:23], a[72:75], v[144:159]
    ds_read_b64_tr_b16 a[4:5], v51 offset:32768
    ds_read_b64_tr_b16 a[6:7], v51 offset:33792
    s_add_u32 m0, s47, 98304
    s_mov_b32 s3, 1327232
    buffer_load_dwordx4 v49, s[16:19], s3 offen lds
    v_mul_f32 v101, v12, v101
    v_mul_f32 v68, v68, v100
    s_waitcnt lgkmcnt(12)
    v_mfma_f32_32x32x16_bf16 v[160:175], a[24:27], a[72:75], v[160:175]
    ds_read_b64_tr_b16 a[8:9], v50 offset:40960
    ds_read_b64_tr_b16 a[10:11], v50 offset:41984
    v_mul_f32 v69, v69, v101
    v_cvt_pk_bf16_f32 v18, v68, v69
    v_mfma_f32_32x32x16_bf16 v[176:191], a[28:31], a[72:75], v[176:191]
    ds_read_b64_tr_b16 a[12:13], v51 offset:40960
    ds_read_b64_tr_b16 a[14:15], v51 offset:41984
    v_fma_f32 v70, v198, v8, v70
    s_waitcnt lgkmcnt(12)
    v_mfma_f32_32x32x16_bf16 v[128:143], a[32:35], a[76:79], v[128:143]
    ds_read_b64_tr_b16 a[16:17], v50 offset:34816
    ds_read_b64_tr_b16 a[18:19], v50 offset:35840
    v_fma_f32 v102, v214, v8, v102
    v_fma_f32 v71, v199, v8, v71
    v_mfma_f32_32x32x16_bf16 v[144:159], a[36:39], a[76:79], v[144:159]
    ds_read_b64_tr_b16 a[20:21], v51 offset:34816
    ds_read_b64_tr_b16 a[22:23], v51 offset:35840
    s_add_u32 m0, s47, 99328
    s_mov_b32 s3, 1354880
    buffer_load_dwordx4 v49, s[16:19], s3 offen lds
    v_fma_f32 v103, v215, v8, v103
    v_max_f32 v70, 0, v70
    s_waitcnt lgkmcnt(12)
    v_mfma_f32_32x32x16_bf16 v[160:175], a[40:43], a[76:79], v[160:175]
    ds_read_b64_tr_b16 a[24:25], v50 offset:43008
    ds_read_b64_tr_b16 a[26:27], v50 offset:44032
    v_mul_f32 v102, v12, v102
    v_max_f32 v71, 0, v71
    v_mfma_f32_32x32x16_bf16 v[176:191], a[44:47], a[76:79], v[176:191]
    ds_read_b64_tr_b16 a[28:29], v51 offset:43008
    ds_read_b64_tr_b16 a[30:31], v51 offset:44032
    v_mul_f32 v103, v12, v103
    v_mul_f32 v70, v70, v102
    s_waitcnt lgkmcnt(12)
    v_mfma_f32_32x32x16_bf16 v[128:143], a[0:3], a[80:83], v[128:143]
    ds_read_b64_tr_b16 a[32:33], v50 offset:36864
    ds_read_b64_tr_b16 a[34:35], v50 offset:37888
    v_mul_f32 v71, v71, v103
    v_cvt_pk_bf16_f32 v19, v70, v71
    v_mfma_f32_32x32x16_bf16 v[144:159], a[4:7], a[80:83], v[144:159]
    ds_read_b64_tr_b16 a[36:37], v51 offset:36864
    ds_read_b64_tr_b16 a[38:39], v51 offset:37888
    s_add_u32 m0, s47, 106496
    s_mov_b32 s3, 1327232
    buffer_load_dwordx4 v49, s[20:23], s3 offen lds
    s_add_u32 s57, s56, 0
    buffer_store_dwordx4 v[16:19], v10, s[32:35], s57 offen sc1
    s_waitcnt lgkmcnt(12)
    v_mfma_f32_32x32x16_bf16 v[160:175], a[8:11], a[80:83], v[160:175]
    ds_read_b64_tr_b16 a[40:41], v50 offset:45056
    ds_read_b64_tr_b16 a[42:43], v50 offset:46080
    v_fma_f32 v72, v200, v8, v72
    v_fma_f32 v104, v216, v8, v104
    v_mfma_f32_32x32x16_bf16 v[176:191], a[12:15], a[80:83], v[176:191]
    ds_read_b64_tr_b16 a[44:45], v51 offset:45056
    ds_read_b64_tr_b16 a[46:47], v51 offset:46080
    v_fma_f32 v73, v201, v8, v73
    v_fma_f32 v105, v217, v8, v105
    s_waitcnt lgkmcnt(12)
    v_mfma_f32_32x32x16_bf16 v[128:143], a[16:19], a[84:87], v[128:143]
    ds_read_b64_tr_b16 a[0:1], v50 offset:38912
    ds_read_b64_tr_b16 a[2:3], v50 offset:39936
    v_max_f32 v72, 0, v72
    v_mul_f32 v104, v12, v104
    v_mfma_f32_32x32x16_bf16 v[144:159], a[20:23], a[84:87], v[144:159]
    ds_read_b64_tr_b16 a[4:5], v51 offset:38912
    ds_read_b64_tr_b16 a[6:7], v51 offset:39936
    s_add_u32 m0, s47, 107520
    s_mov_b32 s3, 1354880
    buffer_load_dwordx4 v49, s[20:23], s3 offen lds
    v_max_f32 v73, 0, v73
    v_mul_f32 v105, v12, v105
    s_waitcnt lgkmcnt(12)
    v_mfma_f32_32x32x16_bf16 v[160:175], a[24:27], a[84:87], v[160:175]
    ds_read_b64_tr_b16 a[8:9], v50 offset:47104
    ds_read_b64_tr_b16 a[10:11], v50 offset:48128
    v_mul_f32 v72, v72, v104
    v_mul_f32 v73, v73, v105
    v_mfma_f32_32x32x16_bf16 v[176:191], a[28:31], a[84:87], v[176:191]
    ds_read_b64_tr_b16 a[12:13], v51 offset:47104
    ds_read_b64_tr_b16 a[14:15], v51 offset:48128
    v_cvt_pk_bf16_f32 v20, v72, v73
    s_waitcnt lgkmcnt(12)
    v_mfma_f32_32x32x16_bf16 v[128:143], a[32:35], a[88:91], v[128:143]
    ds_read_b64_tr_b16 a[16:17], v50 offset:49152
    ds_read_b64_tr_b16 a[18:19], v50 offset:50176
    v_fma_f32 v74, v202, v8, v74
    v_fma_f32 v106, v218, v8, v106
    v_mfma_f32_32x32x16_bf16 v[144:159], a[36:39], a[88:91], v[144:159]
    ds_read_b64_tr_b16 a[20:21], v51 offset:49152
    ds_read_b64_tr_b16 a[22:23], v51 offset:50176
    s_add_u32 m0, s47, 114688
    s_mov_b32 s3, 1548416
    buffer_load_dwordx4 v49, s[16:19], s3 offen lds
    v_fma_f32 v75, v203, v8, v75
    v_fma_f32 v107, v219, v8, v107
    s_waitcnt lgkmcnt(12)
    v_mfma_f32_32x32x16_bf16 v[160:175], a[40:43], a[88:91], v[160:175]
    ds_read_b64_tr_b16 a[24:25], v50 offset:57344
    ds_read_b64_tr_b16 a[26:27], v50 offset:58368
    v_max_f32 v74, 0, v74
    v_mul_f32 v106, v12, v106
    v_mfma_f32_32x32x16_bf16 v[176:191], a[44:47], a[88:91], v[176:191]
    ds_read_b64_tr_b16 a[28:29], v51 offset:57344
    ds_read_b64_tr_b16 a[30:31], v51 offset:58368
    v_max_f32 v75, 0, v75
    v_mul_f32 v107, v12, v107
    s_waitcnt lgkmcnt(12)
    v_mfma_f32_32x32x16_bf16 v[128:143], a[0:3], a[92:95], v[128:143]
    ds_read_b64_tr_b16 a[32:33], v50 offset:51200
    ds_read_b64_tr_b16 a[34:35], v50 offset:52224
    v_mul_f32 v74, v74, v106
    v_mul_f32 v75, v75, v107
    v_mfma_f32_32x32x16_bf16 v[144:159], a[4:7], a[92:95], v[144:159]
    ds_read_b64_tr_b16 a[36:37], v51 offset:51200
    ds_read_b64_tr_b16 a[38:39], v51 offset:52224
    s_add_u32 m0, s47, 115712
    s_mov_b32 s3, 1576064
    buffer_load_dwordx4 v49, s[16:19], s3 offen lds
    v_cvt_pk_bf16_f32 v21, v74, v75
    s_waitcnt lgkmcnt(12)
    v_mfma_f32_32x32x16_bf16 v[160:175], a[8:11], a[92:95], v[160:175]
    ds_read_b64_tr_b16 a[40:41], v50 offset:59392
    ds_read_b64_tr_b16 a[42:43], v50 offset:60416
    v_fma_f32 v76, v204, v8, v76
    v_fma_f32 v108, v220, v8, v108
    v_mfma_f32_32x32x16_bf16 v[176:191], a[12:15], a[92:95], v[176:191]
    ds_read_b64_tr_b16 a[44:45], v51 offset:59392
    ds_read_b64_tr_b16 a[46:47], v51 offset:60416
    v_fma_f32 v77, v205, v8, v77
    v_fma_f32 v109, v221, v8, v109
    s_waitcnt lgkmcnt(12)
    v_mfma_f32_32x32x16_bf16 v[128:143], a[16:19], a[96:99], v[128:143]
    ds_read_b64_tr_b16 a[0:1], v50 offset:53248
    ds_read_b64_tr_b16 a[2:3], v50 offset:54272
    v_max_f32 v76, 0, v76
    v_mul_f32 v108, v12, v108
    v_mfma_f32_32x32x16_bf16 v[144:159], a[20:23], a[96:99], v[144:159]
    ds_read_b64_tr_b16 a[4:5], v51 offset:53248
    ds_read_b64_tr_b16 a[6:7], v51 offset:54272
    s_add_u32 m0, s47, 122880
    s_mov_b32 s3, 1548416
    buffer_load_dwordx4 v49, s[20:23], s3 offen lds
    v_max_f32 v77, 0, v77
    v_mul_f32 v109, v12, v109
    s_waitcnt lgkmcnt(12)
    v_mfma_f32_32x32x16_bf16 v[160:175], a[24:27], a[96:99], v[160:175]
    ds_read_b64_tr_b16 a[8:9], v50 offset:61440
    ds_read_b64_tr_b16 a[10:11], v50 offset:62464
    v_mul_f32 v76, v76, v108
    v_mul_f32 v77, v77, v109
    v_mfma_f32_32x32x16_bf16 v[176:191], a[28:31], a[96:99], v[176:191]
    ds_read_b64_tr_b16 a[12:13], v51 offset:61440
    ds_read_b64_tr_b16 a[14:15], v51 offset:62464
    v_cvt_pk_bf16_f32 v22, v76, v77
    s_waitcnt lgkmcnt(12)
    v_mfma_f32_32x32x16_bf16 v[128:143], a[32:35], a[100:103], v[128:143]
    ds_read_b64_tr_b16 a[16:17], v50 offset:55296
    ds_read_b64_tr_b16 a[18:19], v50 offset:56320
    v_fma_f32 v78, v206, v8, v78
    v_fma_f32 v110, v222, v8, v110
    v_mfma_f32_32x32x16_bf16 v[144:159], a[36:39], a[100:103], v[144:159]
    ds_read_b64_tr_b16 a[20:21], v51 offset:55296
    ds_read_b64_tr_b16 a[22:23], v51 offset:56320
    s_add_u32 m0, s47, 123904
    s_mov_b32 s3, 1576064
    buffer_load_dwordx4 v49, s[20:23], s3 offen lds
    v_fma_f32 v79, v207, v8, v79
    v_fma_f32 v111, v223, v8, v111
    s_waitcnt lgkmcnt(12)
    v_mfma_f32_32x32x16_bf16 v[160:175], a[40:43], a[100:103], v[160:175]
    ds_read_b64_tr_b16 a[24:25], v50 offset:63488
    ds_read_b64_tr_b16 a[26:27], v50 offset:64512
    v_max_f32 v78, 0, v78
    v_mul_f32 v110, v12, v110
    v_mfma_f32_32x32x16_bf16 v[176:191], a[44:47], a[100:103], v[176:191]
    ds_read_b64_tr_b16 a[28:29], v51 offset:63488
    ds_read_b64_tr_b16 a[30:31], v51 offset:64512
    v_max_f32 v79, 0, v79
    v_mul_f32 v111, v12, v111
    s_waitcnt vmcnt(9)
    s_barrier
    s_waitcnt lgkmcnt(12)
    v_mfma_f32_32x32x16_bf16 v[128:143], a[0:3], a[104:107], v[128:143]
    ds_read_b64_tr_b16 a[32:33], v52 offset:0
    ds_read_b64_tr_b16 a[34:35], v52 offset:1024
    v_mul_f32 v78, v78, v110
    v_mul_f32 v79, v79, v111
    v_mfma_f32_32x32x16_bf16 v[144:159], a[4:7], a[104:107], v[144:159]
    ds_read_b64_tr_b16 a[36:37], v53 offset:0
    ds_read_b64_tr_b16 a[38:39], v53 offset:1024
    s_add_u32 m0, s47, 0
    s_mov_b32 s3, 1769600
    buffer_load_dwordx4 v49, s[16:19], s3 offen lds
    v_cvt_pk_bf16_f32 v23, v78, v79
    s_add_u32 s57, s56, 1024
    buffer_store_dwordx4 v[20:23], v10, s[32:35], s57 offen sc1
    s_waitcnt lgkmcnt(12)
    v_mfma_f32_32x32x16_bf16 v[160:175], a[8:11], a[104:107], v[160:175]
    ds_read_b64_tr_b16 a[40:41], v52 offset:8192
    ds_read_b64_tr_b16 a[42:43], v52 offset:9216
    ds_read_b128 v[192:195], v14 offset:128
    ds_read_b128 v[196:199], v14 offset:160
    ds_read_b128 v[200:203], v14 offset:192
    ds_read_b128 v[204:207], v14 offset:224
    ds_read_b128 v[208:211], v14 offset:640
    ds_read_b128 v[212:215], v14 offset:672
    ds_read_b128 v[216:219], v14 offset:704
    ds_read_b128 v[220:223], v14 offset:736
    v_mfma_f32_32x32x16_bf16 v[176:191], a[12:15], a[104:107], v[176:191]
    ds_read_b64_tr_b16 a[44:45], v53 offset:8192
    ds_read_b64_tr_b16 a[46:47], v53 offset:9216
    s_waitcnt lgkmcnt(5)
    v_fma_f32 v80, v192, v8, v80
    v_mfma_f32_32x32x16_bf16 v[128:143], a[16:19], a[108:111], v[128:143]
    ds_read_b64_tr_b16 a[0:1], v52 offset:2048
    ds_read_b64_tr_b16 a[2:3], v52 offset:3072
    v_fma_f32 v112, v208, v8, v112
    v_fma_f32 v81, v193, v8, v81
    v_mfma_f32_32x32x16_bf16 v[144:159], a[20:23], a[108:111], v[144:159]
    ds_read_b64_tr_b16 a[4:5], v53 offset:2048
    ds_read_b64_tr_b16 a[6:7], v53 offset:3072
    s_add_u32 m0, s47, 1024
    s_mov_b32 s3, 1797248
    buffer_load_dwordx4 v49, s[16:19], s3 offen lds
    v_fma_f32 v113, v209, v8, v113
    v_max_f32 v80, 0, v80
    v_mfma_f32_32x32x16_bf16 v[160:175], a[24:27], a[108:111], v[160:175]
    ds_read_b64_tr_b16 a[8:9], v52 offset:10240
    ds_read_b64_tr_b16 a[10:11], v52 offset:11264
    v_mul_f32 v112, v12, v112
    v_max_f32 v81, 0, v81
    v_mfma_f32_32x32x16_bf16 v[176:191], a[28:31], a[108:111], v[176:191]
    ds_read_b64_tr_b16 a[12:13], v53 offset:10240
    ds_read_b64_tr_b16 a[14:15], v53 offset:11264
    v_mul_f32 v113, v12, v113
    v_mul_f32 v80, v80, v112
    v_mfma_f32_32x32x16_bf16 v[128:143], a[32:35], a[112:115], v[128:143]
    ds_read_b64_tr_b16 a[16:17], v52 offset:4096
    ds_read_b64_tr_b16 a[18:19], v52 offset:5120
    v_mul_f32 v81, v81, v113
    v_cvt_pk_bf16_f32 v16, v80, v81
    v_mfma_f32_32x32x16_bf16 v[144:159], a[36:39], a[112:115], v[144:159]
    ds_read_b64_tr_b16 a[20:21], v53 offset:4096
    ds_read_b64_tr_b16 a[22:23], v53 offset:5120
    s_add_u32 m0, s47, 8192
    s_mov_b32 s3, 1769600
    buffer_load_dwordx4 v49, s[20:23], s3 offen lds
    v_fma_f32 v82, v194, v8, v82
    s_waitcnt lgkmcnt(12)
    v_mfma_f32_32x32x16_bf16 v[160:175], a[40:43], a[112:115], v[160:175]
    ds_read_b64_tr_b16 a[24:25], v52 offset:12288
    ds_read_b64_tr_b16 a[26:27], v52 offset:13312
    v_fma_f32 v114, v210, v8, v114
    v_fma_f32 v83, v195, v8, v83
    v_mfma_f32_32x32x16_bf16 v[176:191], a[44:47], a[112:115], v[176:191]
    ds_read_b64_tr_b16 a[28:29], v53 offset:12288
    ds_read_b64_tr_b16 a[30:31], v53 offset:13312
    v_fma_f32 v115, v211, v8, v115
    v_max_f32 v82, 0, v82
    s_waitcnt lgkmcnt(12)
    v_mfma_f32_32x32x16_bf16 v[128:143], a[0:3], a[116:119], v[128:143]
    ds_read_b64_tr_b16 a[32:33], v52 offset:6144
    ds_read_b64_tr_b16 a[34:35], v52 offset:7168
    v_mul_f32 v114, v12, v114
    v_max_f32 v83, 0, v83
    v_mfma_f32_32x32x16_bf16 v[144:159], a[4:7], a[116:119], v[144:159]
    ds_read_b64_tr_b16 a[36:37], v53 offset:6144
    ds_read_b64_tr_b16 a[38:39], v53 offset:7168
    s_add_u32 m0, s47, 9216
    s_mov_b32 s3, 1797248
    buffer_load_dwordx4 v49, s[20:23], s3 offen lds
    v_mul_f32 v115, v12, v115
    v_mul_f32 v82, v82, v114
    s_waitcnt lgkmcnt(12)
    v_mfma_f32_32x32x16_bf16 v[160:175], a[8:11], a[116:119], v[160:175]
    ds_read_b64_tr_b16 a[40:41], v52 offset:14336
    ds_read_b64_tr_b16 a[42:43], v52 offset:15360
    v_mul_f32 v83, v83, v115
    v_cvt_pk_bf16_f32 v17, v82, v83
    v_mfma_f32_32x32x16_bf16 v[176:191], a[12:15], a[116:119], v[176:191]
    ds_read_b64_tr_b16 a[44:45], v53 offset:14336
    ds_read_b64_tr_b16 a[46:47], v53 offset:15360
    v_fma_f32 v84, v196, v8, v84
    s_waitcnt lgkmcnt(12)
    v_mfma_f32_32x32x16_bf16 v[128:143], a[16:19], a[120:123], v[128:143]
    ds_read_b64_tr_b16 a[0:1], v52 offset:16384
    ds_read_b64_tr_b16 a[2:3], v52 offset:17408
    v_fma_f32 v116, v212, v8, v116
    v_fma_f32 v85, v197, v8, v85
    v_mfma_f32_32x32x16_bf16 v[144:159], a[20:23], a[120:123], v[144:159]
    ds_read_b64_tr_b16 a[4:5], v53 offset:16384
    ds_read_b64_tr_b16 a[6:7], v53 offset:17408
    s_add_u32 m0, s47, 16384
    s_mov_b32 s3, 1990784
    buffer_load_dwordx4 v49, s[16:19], s3 offen lds
    v_fma_f32 v117, v213, v8, v117
    v_max_f32 v84, 0, v84
    s_waitcnt lgkmcnt(12)
    v_mfma_f32_32x32x16_bf16 v[160:175], a[24:27], a[120:123], v[160:175]
    ds_read_b64_tr_b16 a[8:9], v52 offset:24576
    ds_read_b64_tr_b16 a[10:11], v52 offset:25600
    v_mul_f32 v116, v12, v116
    v_max_f32 v85, 0, v85
    v_mfma_f32_32x32x16_bf16 v[176:191], a[28:31], a[120:123], v[176:191]
    ds_read_b64_tr_b16 a[12:13], v53 offset:24576
    ds_read_b64_tr_b16 a[14:15], v53 offset:25600
    v_mul_f32 v117, v12, v117
    v_mul_f32 v84, v84, v116
    s_waitcnt lgkmcnt(12)
    v_mfma_f32_32x32x16_bf16 v[128:143], a[32:35], a[124:127], v[128:143]
    ds_read_b64_tr_b16 a[16:17], v52 offset:18432
    ds_read_b64_tr_b16 a[18:19], v52 offset:19456
    v_mul_f32 v85, v85, v117
    v_cvt_pk_bf16_f32 v18, v84, v85
    v_mfma_f32_32x32x16_bf16 v[144:159], a[36:39], a[124:127], v[144:159]
    ds_read_b64_tr_b16 a[20:21], v53 offset:18432
    ds_read_b64_tr_b16 a[22:23], v53 offset:19456
    s_add_u32 m0, s47, 17408
    s_mov_b32 s3, 2018432
    buffer_load_dwordx4 v49, s[16:19], s3 offen lds
    v_fma_f32 v86, v198, v8, v86
    s_waitcnt lgkmcnt(12)
    v_mfma_f32_32x32x16_bf16 v[160:175], a[40:43], a[124:127], v[160:175]
    ds_read_b64_tr_b16 a[24:25], v52 offset:26624
    ds_read_b64_tr_b16 a[26:27], v52 offset:27648
    v_fma_f32 v118, v214, v8, v118
    v_fma_f32 v87, v199, v8, v87
    v_mfma_f32_32x32x16_bf16 v[176:191], a[44:47], a[124:127], v[176:191]
    ds_read_b64_tr_b16 a[28:29], v53 offset:26624
    ds_read_b64_tr_b16 a[30:31], v53 offset:27648
    v_fma_f32 v119, v215, v8, v119
    v_max_f32 v86, 0, v86
    s_waitcnt lgkmcnt(12)
    v_mfma_f32_32x32x16_bf16 v[128:143], a[0:3], a[128:131], v[128:143]
    ds_read_b64_tr_b16 a[32:33], v52 offset:20480
    ds_read_b64_tr_b16 a[34:35], v52 offset:21504
    v_mul_f32 v118, v12, v118
    v_max_f32 v87, 0, v87
    v_mfma_f32_32x32x16_bf16 v[144:159], a[4:7], a[128:131], v[144:159]
    ds_read_b64_tr_b16 a[36:37], v53 offset:20480
    ds_read_b64_tr_b16 a[38:39], v53 offset:21504
    s_add_u32 m0, s47, 24576
    s_mov_b32 s3, 1990784
    buffer_load_dwordx4 v49, s[20:23], s3 offen lds
    v_mul_f32 v119, v12, v119
    v_mul_f32 v86, v86, v118
    s_waitcnt lgkmcnt(12)
    v_mfma_f32_32x32x16_bf16 v[160:175], a[8:11], a[128:131], v[160:175]
    ds_read_b64_tr_b16 a[40:41], v52 offset:28672
    ds_read_b64_tr_b16 a[42:43], v52 offset:29696
    v_mul_f32 v87, v87, v119
    v_cvt_pk_bf16_f32 v19, v86, v87
    v_mfma_f32_32x32x16_bf16 v[176:191], a[12:15], a[128:131], v[176:191]
    ds_read_b64_tr_b16 a[44:45], v53 offset:28672
    ds_read_b64_tr_b16 a[46:47], v53 offset:29696
    s_add_u32 s57, s56, 2048
    buffer_store_dwordx4 v[16:19], v10, s[32:35], s57 offen sc1
    s_waitcnt lgkmcnt(12)
    v_mfma_f32_32x32x16_bf16 v[128:143], a[16:19], a[132:135], v[128:143]
    ds_read_b64_tr_b16 a[0:1], v52 offset:22528
    ds_read_b64_tr_b16 a[2:3], v52 offset:23552
    v_fma_f32 v88, v200, v8, v88
    v_fma_f32 v120, v216, v8, v120
    v_mfma_f32_32x32x16_bf16 v[144:159], a[20:23], a[132:135], v[144:159]
    ds_read_b64_tr_b16 a[4:5], v53 offset:22528
    ds_read_b64_tr_b16 a[6:7], v53 offset:23552
    s_add_u32 m0, s47, 25600
    s_mov_b32 s3, 2018432
    buffer_load_dwordx4 v49, s[20:23], s3 offen lds
    v_fma_f32 v89, v201, v8, v89
    v_fma_f32 v121, v217, v8, v121
    s_waitcnt lgkmcnt(12)
    v_mfma_f32_32x32x16_bf16 v[160:175], a[24:27], a[132:135], v[160:175]
    ds_read_b64_tr_b16 a[8:9], v52 offset:30720
    ds_read_b64_tr_b16 a[10:11], v52 offset:31744
    v_max_f32 v88, 0, v88
    v_mul_f32 v120, v12, v120
    v_mfma_f32_32x32x16_bf16 v[176:191], a[28:31], a[132:135], v[176:191]
    ds_read_b64_tr_b16 a[12:13], v53 offset:30720
    ds_read_b64_tr_b16 a[14:15], v53 offset:31744
    v_max_f32 v89, 0, v89
    v_mul_f32 v121, v12, v121
    s_waitcnt vmcnt(10)
    s_barrier
    s_waitcnt lgkmcnt(12)
    v_mfma_f32_32x32x16_bf16 v[128:143], a[32:35], a[136:139], v[128:143]
    ds_read_b64_tr_b16 a[16:17], v52 offset:32768
    ds_read_b64_tr_b16 a[18:19], v52 offset:33792
    v_mul_f32 v88, v88, v120
    v_mul_f32 v89, v89, v121
    v_mfma_f32_32x32x16_bf16 v[144:159], a[36:39], a[136:139], v[144:159]
    ds_read_b64_tr_b16 a[20:21], v53 offset:32768
    ds_read_b64_tr_b16 a[22:23], v53 offset:33792
    s_add_u32 m0, s46, 32768
    s_mul_i32 s99, s94, 20480
    s_mov_b32 s3, s99
    buffer_load_dwordx4 v48, s[24:27], s3 offen lds
    v_cvt_pk_bf16_f32 v20, v88, v89
    s_waitcnt lgkmcnt(12)
    v_mfma_f32_32x32x16_bf16 v[160:175], a[40:43], a[136:139], v[160:175]
    ds_read_b64_tr_b16 a[24:25], v52 offset:40960
    ds_read_b64_tr_b16 a[26:27], v52 offset:41984
    v_fma_f32 v90, v202, v8, v90
    v_fma_f32 v122, v218, v8, v122
    v_mfma_f32_32x32x16_bf16 v[176:191], a[44:47], a[136:139], v[176:191]
    ds_read_b64_tr_b16 a[28:29], v53 offset:40960
    ds_read_b64_tr_b16 a[30:31], v53 offset:41984
    v_fma_f32 v91, v203, v8, v91
    v_fma_f32 v123, v219, v8, v123
    s_waitcnt lgkmcnt(12)
    v_mfma_f32_32x32x16_bf16 v[128:143], a[0:3], a[140:143], v[128:143]
    ds_read_b64_tr_b16 a[32:33], v52 offset:34816
    ds_read_b64_tr_b16 a[34:35], v52 offset:35840
    v_max_f32 v90, 0, v90
    v_mul_f32 v122, v12, v122
    v_mfma_f32_32x32x16_bf16 v[144:159], a[4:7], a[140:143], v[144:159]
    ds_read_b64_tr_b16 a[36:37], v53 offset:34816
    ds_read_b64_tr_b16 a[38:39], v53 offset:35840
    s_add_u32 m0, s46, 33792
    s_add_u32 s3, s99, 10240
    buffer_load_dwordx4 v48, s[24:27], s3 offen lds
    v_max_f32 v91, 0, v91
    v_mul_f32 v123, v12, v123
    s_waitcnt lgkmcnt(12)
    v_mfma_f32_32x32x16_bf16 v[160:175], a[8:11], a[140:143], v[160:175]
    ds_read_b64_tr_b16 a[40:41], v52 offset:43008
    ds_read_b64_tr_b16 a[42:43], v52 offset:44032
    v_mul_f32 v90, v90, v122
    v_mul_f32 v91, v91, v123
    v_mfma_f32_32x32x16_bf16 v[176:191], a[12:15], a[140:143], v[176:191]
    ds_read_b64_tr_b16 a[44:45], v53 offset:43008
    ds_read_b64_tr_b16 a[46:47], v53 offset:44032
    v_cvt_pk_bf16_f32 v21, v90, v91
    s_waitcnt lgkmcnt(12)
    v_mfma_f32_32x32x16_bf16 v[128:143], a[16:19], a[144:147], v[128:143]
    ds_read_b64_tr_b16 a[0:1], v52 offset:36864
    ds_read_b64_tr_b16 a[2:3], v52 offset:37888
    v_fma_f32 v92, v204, v8, v92
    v_fma_f32 v124, v220, v8, v124
    v_mfma_f32_32x32x16_bf16 v[144:159], a[20:23], a[144:147], v[144:159]
    ds_read_b64_tr_b16 a[4:5], v53 offset:36864
    ds_read_b64_tr_b16 a[6:7], v53 offset:37888
    s_add_u32 m0, s46, 34816
    s_add_u32 s101, s94, 1
    s_cmp_eq_u32 s101, 108
    s_cselect_b32 s101, 0, s101
    s_mul_i32 s99, s101, 20480
    s_mov_b32 s3, s99
    buffer_load_dwordx4 v48, s[24:27], s3 offen lds
    v_fma_f32 v93, v205, v8, v93
    v_fma_f32 v125, v221, v8, v125
    s_waitcnt lgkmcnt(12)
    v_mfma_f32_32x32x16_bf16 v[160:175], a[24:27], a[144:147], v[160:175]
    ds_read_b64_tr_b16 a[8:9], v52 offset:45056
    ds_read_b64_tr_b16 a[10:11], v52 offset:46080
    v_max_f32 v92, 0, v92
    v_mul_f32 v124, v12, v124
    v_mfma_f32_32x32x16_bf16 v[176:191], a[28:31], a[144:147], v[176:191]
    ds_read_b64_tr_b16 a[12:13], v53 offset:45056
    ds_read_b64_tr_b16 a[14:15], v53 offset:46080
    v_max_f32 v93, 0, v93
    v_mul_f32 v125, v12, v125
    s_waitcnt lgkmcnt(12)
    v_mfma_f32_32x32x16_bf16 v[128:143], a[32:35], a[148:151], v[128:143]
    ds_read_b64_tr_b16 a[16:17], v52 offset:38912
    ds_read_b64_tr_b16 a[18:19], v52 offset:39936
    v_mul_f32 v92, v92, v124
    v_mul_f32 v93, v93, v125
    v_mfma_f32_32x32x16_bf16 v[144:159], a[36:39], a[148:151], v[144:159]
    ds_read_b64_tr_b16 a[20:21], v53 offset:38912
    ds_read_b64_tr_b16 a[22:23], v53 offset:39936
    s_add_u32 m0, s46, 35840
    s_add_u32 s3, s99, 10240
    buffer_load_dwordx4 v48, s[24:27], s3 offen lds
    s_add_u32 s94, s94, 8
    s_cmp_ge_u32 s94, 108
    s_cselect_b32 s3, 108, 0
    s_sub_u32 s94, s94, s3
    v_cvt_pk_bf16_f32 v22, v92, v93
    s_waitcnt lgkmcnt(12)
    v_mfma_f32_32x32x16_bf16 v[160:175], a[40:43], a[148:151], v[160:175]
    ds_read_b64_tr_b16 a[24:25], v52 offset:47104
    ds_read_b64_tr_b16 a[26:27], v52 offset:48128
    v_fma_f32 v94, v206, v8, v94
    v_fma_f32 v126, v222, v8, v126
    v_mfma_f32_32x32x16_bf16 v[176:191], a[44:47], a[148:151], v[176:191]
    ds_read_b64_tr_b16 a[28:29], v53 offset:47104
    ds_read_b64_tr_b16 a[30:31], v53 offset:48128
    v_fma_f32 v95, v207, v8, v95
    v_fma_f32 v127, v223, v8, v127
    s_waitcnt lgkmcnt(12)
    v_mfma_f32_32x32x16_bf16 v[128:143], a[0:3], a[152:155], v[128:143]
    ds_read_b64_tr_b16 a[32:33], v52 offset:49152
    ds_read_b64_tr_b16 a[34:35], v52 offset:50176
    v_max_f32 v94, 0, v94
    v_mul_f32 v126, v12, v126
    v_mfma_f32_32x32x16_bf16 v[144:159], a[4:7], a[152:155], v[144:159]
    ds_read_b64_tr_b16 a[36:37], v53 offset:49152
    ds_read_b64_tr_b16 a[38:39], v53 offset:50176
    s_add_u32 m0, s46, 49152
    s_mul_i32 s99, s94, 20480
    s_mov_b32 s3, s99
    buffer_load_dwordx4 v48, s[24:27], s3 offen lds
    v_max_f32 v95, 0, v95
    v_mul_f32 v127, v12, v127
    s_waitcnt lgkmcnt(12)
    v_mfma_f32_32x32x16_bf16 v[160:175], a[8:11], a[152:155], v[160:175]
    ds_read_b64_tr_b16 a[40:41], v52 offset:57344
    ds_read_b64_tr_b16 a[42:43], v52 offset:58368
    v_mul_f32 v94, v94, v126
    v_mul_f32 v95, v95, v127
    v_mfma_f32_32x32x16_bf16 v[176:191], a[12:15], a[152:155], v[176:191]
    ds_read_b64_tr_b16 a[44:45], v53 offset:57344
    ds_read_b64_tr_b16 a[46:47], v53 offset:58368
    v_cvt_pk_bf16_f32 v23, v94, v95
    s_add_u32 s57, s56, 3072
    buffer_store_dwordx4 v[20:23], v10, s[32:35], s57 offen sc1
    s_waitcnt lgkmcnt(12)
    v_mfma_f32_32x32x16_bf16 v[128:143], a[16:19], a[156:159], v[128:143]
    ds_read_b64_tr_b16 a[0:1], v52 offset:51200
    ds_read_b64_tr_b16 a[2:3], v52 offset:52224
    v_mfma_f32_32x32x16_bf16 v[144:159], a[20:23], a[156:159], v[144:159]
    ds_read_b64_tr_b16 a[4:5], v53 offset:51200
    ds_read_b64_tr_b16 a[6:7], v53 offset:52224
    s_add_u32 m0, s46, 50176
    s_add_u32 s3, s99, 10240
    buffer_load_dwordx4 v48, s[24:27], s3 offen lds
    s_waitcnt lgkmcnt(12)
    v_mfma_f32_32x32x16_bf16 v[160:175], a[24:27], a[156:159], v[160:175]
    ds_read_b64_tr_b16 a[8:9], v52 offset:59392
    ds_read_b64_tr_b16 a[10:11], v52 offset:60416
    v_mfma_f32_32x32x16_bf16 v[176:191], a[28:31], a[156:159], v[176:191]
    ds_read_b64_tr_b16 a[12:13], v53 offset:59392
    ds_read_b64_tr_b16 a[14:15], v53 offset:60416
    s_waitcnt lgkmcnt(12)
    v_mfma_f32_32x32x16_bf16 v[128:143], a[32:35], a[160:163], v[128:143]
    ds_read_b64_tr_b16 a[16:17], v52 offset:53248
    ds_read_b64_tr_b16 a[18:19], v52 offset:54272
    v_mfma_f32_32x32x16_bf16 v[144:159], a[36:39], a[160:163], v[144:159]
    ds_read_b64_tr_b16 a[20:21], v53 offset:53248
    ds_read_b64_tr_b16 a[22:23], v53 offset:54272
    s_add_u32 m0, s46, 51200
    s_add_u32 s101, s94, 1
    s_cmp_eq_u32 s101, 108
    s_cselect_b32 s101, 0, s101
    s_mul_i32 s99, s101, 20480
    s_mov_b32 s3, s99
    buffer_load_dwordx4 v48, s[24:27], s3 offen lds
    s_waitcnt lgkmcnt(12)
    v_mfma_f32_32x32x16_bf16 v[160:175], a[40:43], a[160:163], v[160:175]
    ds_read_b64_tr_b16 a[24:25], v52 offset:61440
    ds_read_b64_tr_b16 a[26:27], v52 offset:62464
    v_mfma_f32_32x32x16_bf16 v[176:191], a[44:47], a[160:163], v[176:191]
    ds_read_b64_tr_b16 a[28:29], v53 offset:61440
    ds_read_b64_tr_b16 a[30:31], v53 offset:62464
    s_waitcnt lgkmcnt(12)
    v_mfma_f32_32x32x16_bf16 v[128:143], a[0:3], a[164:167], v[128:143]
    ds_read_b64_tr_b16 a[32:33], v52 offset:55296
    ds_read_b64_tr_b16 a[34:35], v52 offset:56320
    v_mfma_f32_32x32x16_bf16 v[144:159], a[4:7], a[164:167], v[144:159]
    ds_read_b64_tr_b16 a[36:37], v53 offset:55296
    ds_read_b64_tr_b16 a[38:39], v53 offset:56320
    s_add_u32 m0, s46, 52224
    s_add_u32 s3, s99, 10240
    buffer_load_dwordx4 v48, s[24:27], s3 offen lds
    s_add_u32 s94, s94, 8
    s_cmp_ge_u32 s94, 108
    s_cselect_b32 s3, 108, 0
    s_sub_u32 s94, s94, s3
    s_waitcnt lgkmcnt(12)
    v_mfma_f32_32x32x16_bf16 v[160:175], a[8:11], a[164:167], v[160:175]
    ds_read_b64_tr_b16 a[40:41], v52 offset:63488
    ds_read_b64_tr_b16 a[42:43], v52 offset:64512
    v_mfma_f32_32x32x16_bf16 v[176:191], a[12:15], a[164:167], v[176:191]
    ds_read_b64_tr_b16 a[44:45], v53 offset:63488
    ds_read_b64_tr_b16 a[46:47], v53 offset:64512
    s_waitcnt vmcnt(9)
    s_barrier
    s_waitcnt lgkmcnt(12)
    v_mfma_f32_32x32x16_bf16 v[128:143], a[16:19], a[168:171], v[128:143]
    ds_read_b64_tr_b16 a[0:1], v50 offset:0
    ds_read_b64_tr_b16 a[2:3], v50 offset:1024
    v_mfma_f32_32x32x16_bf16 v[144:159], a[20:23], a[168:171], v[144:159]
    ds_read_b64_tr_b16 a[4:5], v51 offset:0
    ds_read_b64_tr_b16 a[6:7], v51 offset:1024
    s_add_u32 m0, s46, 65536
    s_mul_i32 s99, s94, 20480
    s_mov_b32 s3, s99
    buffer_load_dwordx4 v48, s[24:27], s3 offen lds
    s_waitcnt lgkmcnt(12)
    v_mfma_f32_32x32x16_bf16 v[160:175], a[24:27], a[168:171], v[160:175]
    ds_read_b64_tr_b16 a[8:9], v50 offset:8192
    ds_read_b64_tr_b16 a[10:11], v50 offset:9216
    v_mfma_f32_32x32x16_bf16 v[176:191], a[28:31], a[168:171], v[176:191]
    ds_read_b64_tr_b16 a[12:13], v51 offset:8192
    ds_read_b64_tr_b16 a[14:15], v51 offset:9216
    s_waitcnt lgkmcnt(12)
    v_mfma_f32_32x32x16_bf16 v[128:143], a[32:35], a[172:175], v[128:143]
    ds_read_b64_tr_b16 a[16:17], v50 offset:2048
    ds_read_b64_tr_b16 a[18:19], v50 offset:3072
    v_mfma_f32_32x32x16_bf16 v[144:159], a[36:39], a[172:175], v[144:159]
    ds_read_b64_tr_b16 a[20:21], v51 offset:2048
    ds_read_b64_tr_b16 a[22:23], v51 offset:3072
    s_add_u32 m0, s46, 66560
    s_add_u32 s3, s99, 10240
    buffer_load_dwordx4 v48, s[24:27], s3 offen lds
    s_waitcnt lgkmcnt(12)
    v_mfma_f32_32x32x16_bf16 v[160:175], a[40:43], a[172:175], v[160:175]
    ds_read_b64_tr_b16 a[24:25], v50 offset:10240
    ds_read_b64_tr_b16 a[26:27], v50 offset:11264
    v_mfma_f32_32x32x16_bf16 v[176:191], a[44:47], a[172:175], v[176:191]
    ds_read_b64_tr_b16 a[28:29], v51 offset:10240
    ds_read_b64_tr_b16 a[30:31], v51 offset:11264
    s_waitcnt lgkmcnt(12)
    v_mfma_f32_32x32x16_bf16 v[128:143], a[0:3], a[176:179], v[128:143]
    ds_read_b64_tr_b16 a[32:33], v50 offset:4096
    ds_read_b64_tr_b16 a[34:35], v50 offset:5120
    v_mfma_f32_32x32x16_bf16 v[144:159], a[4:7], a[176:179], v[144:159]
    ds_read_b64_tr_b16 a[36:37], v51 offset:4096
    ds_read_b64_tr_b16 a[38:39], v51 offset:5120
    s_add_u32 m0, s46, 67584
    s_add_u32 s101, s94, 1
    s_cmp_eq_u32 s101, 108
    s_cselect_b32 s101, 0, s101
    s_mul_i32 s99, s101, 20480
    s_mov_b32 s3, s99
    buffer_load_dwordx4 v48, s[24:27], s3 offen lds
    s_waitcnt lgkmcnt(12)
    v_mfma_f32_32x32x16_bf16 v[160:175], a[8:11], a[176:179], v[160:175]
    ds_read_b64_tr_b16 a[40:41], v50 offset:12288
    ds_read_b64_tr_b16 a[42:43], v50 offset:13312
    v_mfma_f32_32x32x16_bf16 v[176:191], a[12:15], a[176:179], v[176:191]
    ds_read_b64_tr_b16 a[44:45], v51 offset:12288
    ds_read_b64_tr_b16 a[46:47], v51 offset:13312
    s_waitcnt lgkmcnt(12)
    v_mfma_f32_32x32x16_bf16 v[128:143], a[16:19], a[180:183], v[128:143]
    ds_read_b64_tr_b16 a[0:1], v50 offset:6144
    ds_read_b64_tr_b16 a[2:3], v50 offset:7168
    v_mfma_f32_32x32x16_bf16 v[144:159], a[20:23], a[180:183], v[144:159]
    ds_read_b64_tr_b16 a[4:5], v51 offset:6144
    ds_read_b64_tr_b16 a[6:7], v51 offset:7168
    s_add_u32 m0, s46, 68608
    s_add_u32 s3, s99, 10240
    buffer_load_dwordx4 v48, s[24:27], s3 offen lds
    s_add_u32 s94, s94, 8
    s_cmp_ge_u32 s94, 108
    s_cselect_b32 s3, 108, 0
    s_sub_u32 s94, s94, s3
    s_waitcnt lgkmcnt(12)
    v_mfma_f32_32x32x16_bf16 v[160:175], a[24:27], a[180:183], v[160:175]
    ds_read_b64_tr_b16 a[8:9], v50 offset:14336
    ds_read_b64_tr_b16 a[10:11], v50 offset:15360
    v_mfma_f32_32x32x16_bf16 v[176:191], a[28:31], a[180:183], v[176:191]
    ds_read_b64_tr_b16 a[12:13], v51 offset:14336
    ds_read_b64_tr_b16 a[14:15], v51 offset:15360
    s_waitcnt lgkmcnt(12)
    v_mfma_f32_32x32x16_bf16 v[128:143], a[32:35], a[184:187], v[128:143]
    ds_read_b64_tr_b16 a[16:17], v50 offset:16384
    ds_read_b64_tr_b16 a[18:19], v50 offset:17408
    v_mfma_f32_32x32x16_bf16 v[144:159], a[36:39], a[184:187], v[144:159]
    ds_read_b64_tr_b16 a[20:21], v51 offset:16384
    ds_read_b64_tr_b16 a[22:23], v51 offset:17408
    s_add_u32 m0, s46, 81920
    s_mul_i32 s99, s94, 20480
    s_mov_b32 s3, s99
    buffer_load_dwordx4 v48, s[24:27], s3 offen lds
    s_waitcnt lgkmcnt(12)
    v_mfma_f32_32x32x16_bf16 v[160:175], a[40:43], a[184:187], v[160:175]
    ds_read_b64_tr_b16 a[24:25], v50 offset:24576
    ds_read_b64_tr_b16 a[26:27], v50 offset:25600
    v_mfma_f32_32x32x16_bf16 v[176:191], a[44:47], a[184:187], v[176:191]
    ds_read_b64_tr_b16 a[28:29], v51 offset:24576
    ds_read_b64_tr_b16 a[30:31], v51 offset:25600
    s_waitcnt lgkmcnt(12)
    v_mfma_f32_32x32x16_bf16 v[128:143], a[0:3], a[188:191], v[128:143]
    ds_read_b64_tr_b16 a[32:33], v50 offset:18432
    ds_read_b64_tr_b16 a[34:35], v50 offset:19456
    v_mfma_f32_32x32x16_bf16 v[144:159], a[4:7], a[188:191], v[144:159]
    ds_read_b64_tr_b16 a[36:37], v51 offset:18432
    ds_read_b64_tr_b16 a[38:39], v51 offset:19456
    s_add_u32 m0, s46, 82944
    s_add_u32 s3, s99, 10240
    buffer_load_dwordx4 v48, s[24:27], s3 offen lds
    s_waitcnt lgkmcnt(12)
    v_mfma_f32_32x32x16_bf16 v[160:175], a[8:11], a[188:191], v[160:175]
    ds_read_b64_tr_b16 a[40:41], v50 offset:26624
    ds_read_b64_tr_b16 a[42:43], v50 offset:27648
    v_mfma_f32_32x32x16_bf16 v[176:191], a[12:15], a[188:191], v[176:191]
    ds_read_b64_tr_b16 a[44:45], v51 offset:26624
    ds_read_b64_tr_b16 a[46:47], v51 offset:27648
    s_waitcnt lgkmcnt(12)
    v_mfma_f32_32x32x16_bf16 v[128:143], a[16:19], a[192:195], v[128:143]
    ds_read_b64_tr_b16 a[0:1], v50 offset:20480
    ds_read_b64_tr_b16 a[2:3], v50 offset:21504
    v_mfma_f32_32x32x16_bf16 v[144:159], a[20:23], a[192:195], v[144:159]
    ds_read_b64_tr_b16 a[4:5], v51 offset:20480
    ds_read_b64_tr_b16 a[6:7], v51 offset:21504
    s_add_u32 m0, s46, 83968
    s_add_u32 s101, s94, 1
    s_cmp_eq_u32 s101, 108
    s_cselect_b32 s101, 0, s101
    s_mul_i32 s99, s101, 20480
    s_mov_b32 s3, s99
    buffer_load_dwordx4 v48, s[24:27], s3 offen lds
    s_waitcnt lgkmcnt(12)
    v_mfma_f32_32x32x16_bf16 v[160:175], a[24:27], a[192:195], v[160:175]
    ds_read_b64_tr_b16 a[8:9], v50 offset:28672
    ds_read_b64_tr_b16 a[10:11], v50 offset:29696
    v_mfma_f32_32x32x16_bf16 v[176:191], a[28:31], a[192:195], v[176:191]
    ds_read_b64_tr_b16 a[12:13], v51 offset:28672
    ds_read_b64_tr_b16 a[14:15], v51 offset:29696
    s_waitcnt lgkmcnt(12)
    v_mfma_f32_32x32x16_bf16 v[128:143], a[32:35], a[196:199], v[128:143]
    ds_read_b64_tr_b16 a[16:17], v50 offset:22528
    ds_read_b64_tr_b16 a[18:19], v50 offset:23552
    v_mfma_f32_32x32x16_bf16 v[144:159], a[36:39], a[196:199], v[144:159]
    ds_read_b64_tr_b16 a[20:21], v51 offset:22528
    ds_read_b64_tr_b16 a[22:23], v51 offset:23552
    s_add_u32 m0, s46, 84992
    s_add_u32 s3, s99, 10240
    buffer_load_dwordx4 v48, s[24:27], s3 offen lds
    s_add_u32 s94, s94, 8
    s_cmp_ge_u32 s94, 108
    s_cselect_b32 s3, 108, 0
    s_sub_u32 s94, s94, s3
    s_waitcnt lgkmcnt(12)
    v_mfma_f32_32x32x16_bf16 v[160:175], a[40:43], a[196:199], v[160:175]
    ds_read_b64_tr_b16 a[24:25], v50 offset:30720
    ds_read_b64_tr_b16 a[26:27], v50 offset:31744
    v_mfma_f32_32x32x16_bf16 v[176:191], a[44:47], a[196:199], v[176:191]
    ds_read_b64_tr_b16 a[28:29], v51 offset:30720
    ds_read_b64_tr_b16 a[30:31], v51 offset:31744
    s_waitcnt lgkmcnt(12)
    v_mfma_f32_32x32x16_bf16 v[128:143], a[0:3], a[200:203], v[128:143]
    v_mfma_f32_32x32x16_bf16 v[144:159], a[4:7], a[200:203], v[144:159]
    s_waitcnt lgkmcnt(8)
    v_mfma_f32_32x32x16_bf16 v[160:175], a[8:11], a[200:203], v[160:175]
    v_mfma_f32_32x32x16_bf16 v[176:191], a[12:15], a[200:203], v[176:191]
    s_waitcnt lgkmcnt(4)
    v_mfma_f32_32x32x16_bf16 v[128:143], a[16:19], a[204:207], v[128:143]
    v_mfma_f32_32x32x16_bf16 v[144:159], a[20:23], a[204:207], v[144:159]
    s_waitcnt lgkmcnt(0)
    v_mfma_f32_32x32x16_bf16 v[160:175], a[24:27], a[204:207], v[160:175]
    v_mfma_f32_32x32x16_bf16 v[176:191], a[28:31], a[204:207], v[176:191]
    s_nop 9
    s_cmp_eq_u32 s44, 13
    s_cbranch_scc1 L_hidskip_40
    ds_read_b128 v[192:195], v14 offset:256
    ds_read_b128 v[196:199], v14 offset:288
    ds_read_b128 v[200:203], v14 offset:320
    ds_read_b128 v[204:207], v14 offset:352
    ds_read_b128 v[208:211], v14 offset:768
    ds_read_b128 v[212:215], v14 offset:800
    ds_read_b128 v[216:219], v14 offset:832
    ds_read_b128 v[220:223], v14 offset:864
    s_waitcnt lgkmcnt(3)
    v_pk_fma_f32 v[128:129], v[192:193], v[8:9], v[128:129] op_sel_hi:[1,0,1]
    v_pk_fma_f32 v[160:161], v[208:209], v[8:9], v[160:161] op_sel_hi:[1,0,1]
    v_max_f32 v128, 0, v128
    v_max_f32 v129, 0, v129
    v_pk_mul_f32 v[160:161], v[160:161], v[12:13] op_sel_hi:[1,0]
    v_pk_mul_f32 v[128:129], v[128:129], v[160:161]
    v_cvt_pk_bf16_f32 v16, v128, v129
    v_pk_fma_f32 v[130:131], v[194:195], v[8:9], v[130:131] op_sel_hi:[1,0,1]
    v_pk_fma_f32 v[162:163], v[210:211], v[8:9], v[162:163] op_sel_hi:[1,0,1]
    v_max_f32 v130, 0, v130
    v_max_f32 v131, 0, v131
    v_pk_mul_f32 v[162:163], v[162:163], v[12:13] op_sel_hi:[1,0]
    v_pk_mul_f32 v[130:131], v[130:131], v[162:163]
    v_cvt_pk_bf16_f32 v17, v130, v131
    s_waitcnt lgkmcnt(2)
    v_pk_fma_f32 v[132:133], v[196:197], v[8:9], v[132:133] op_sel_hi:[1,0,1]
    v_pk_fma_f32 v[164:165], v[212:213], v[8:9], v[164:165] op_sel_hi:[1,0,1]
    v_max_f32 v132, 0, v132
    v_max_f32 v133, 0, v133
    v_pk_mul_f32 v[164:165], v[164:165], v[12:13] op_sel_hi:[1,0]
    v_pk_mul_f32 v[132:133], v[132:133], v[164:165]
    v_cvt_pk_bf16_f32 v18, v132, v133
    v_pk_fma_f32 v[134:135], v[198:199], v[8:9], v[134:135] op_sel_hi:[1,0,1]
    v_pk_fma_f32 v[166:167], v[214:215], v[8:9], v[166:167] op_sel_hi:[1,0,1]
    v_max_f32 v134, 0, v134
    v_max_f32 v135, 0, v135
    v_pk_mul_f32 v[166:167], v[166:167], v[12:13] op_sel_hi:[1,0]
    v_pk_mul_f32 v[134:135], v[134:135], v[166:167]
    v_cvt_pk_bf16_f32 v19, v134, v135
    s_add_u32 s57, s56, 4096
    buffer_store_dwordx4 v[16:19], v10, s[32:35], s57 offen sc1
    s_waitcnt lgkmcnt(1)
    v_pk_fma_f32 v[136:137], v[200:201], v[8:9], v[136:137] op_sel_hi:[1,0,1]
    v_pk_fma_f32 v[168:169], v[216:217], v[8:9], v[168:169] op_sel_hi:[1,0,1]
    v_max_f32 v136, 0, v136
    v_max_f32 v137, 0, v137
    v_pk_mul_f32 v[168:169], v[168:169], v[12:13] op_sel_hi:[1,0]
    v_pk_mul_f32 v[136:137], v[136:137], v[168:169]
    v_cvt_pk_bf16_f32 v20, v136, v137
    v_pk_fma_f32 v[138:139], v[202:203], v[8:9], v[138:139] op_sel_hi:[1,0,1]
    v_pk_fma_f32 v[170:171], v[218:219], v[8:9], v[170:171] op_sel_hi:[1,0,1]
    v_max_f32 v138, 0, v138
    v_max_f32 v139, 0, v139
    v_pk_mul_f32 v[170:171], v[170:171], v[12:13] op_sel_hi:[1,0]
    v_pk_mul_f32 v[138:139], v[138:139], v[170:171]
    v_cvt_pk_bf16_f32 v21, v138, v139
    s_waitcnt lgkmcnt(0)
    v_pk_fma_f32 v[140:141], v[204:205], v[8:9], v[140:141] op_sel_hi:[1,0,1]
    v_pk_fma_f32 v[172:173], v[220:221], v[8:9], v[172:173] op_sel_hi:[1,0,1]
    v_max_f32 v140, 0, v140
    v_max_f32 v141, 0, v141
    v_pk_mul_f32 v[172:173], v[172:173], v[12:13] op_sel_hi:[1,0]
    v_pk_mul_f32 v[140:141], v[140:141], v[172:173]
    v_cvt_pk_bf16_f32 v22, v140, v141
    v_pk_fma_f32 v[142:143], v[206:207], v[8:9], v[142:143] op_sel_hi:[1,0,1]
    v_pk_fma_f32 v[174:175], v[222:223], v[8:9], v[174:175] op_sel_hi:[1,0,1]
    v_max_f32 v142, 0, v142
    v_max_f32 v143, 0, v143
    v_pk_mul_f32 v[174:175], v[174:175], v[12:13] op_sel_hi:[1,0]
    v_pk_mul_f32 v[142:143], v[142:143], v[174:175]
    v_cvt_pk_bf16_f32 v23, v142, v143
    s_add_u32 s57, s56, 5120
    buffer_store_dwordx4 v[20:23], v10, s[32:35], s57 offen sc1
    ds_read_b128 v[192:195], v14 offset:384
    ds_read_b128 v[196:199], v14 offset:416
    ds_read_b128 v[200:203], v14 offset:448
    ds_read_b128 v[204:207], v14 offset:480
    ds_read_b128 v[208:211], v14 offset:896
    ds_read_b128 v[212:215], v14 offset:928
    ds_read_b128 v[216:219], v14 offset:960
    ds_read_b128 v[220:223], v14 offset:992
    s_waitcnt lgkmcnt(3)
    v_pk_fma_f32 v[144:145], v[192:193], v[8:9], v[144:145] op_sel_hi:[1,0,1]
    v_pk_fma_f32 v[176:177], v[208:209], v[8:9], v[176:177] op_sel_hi:[1,0,1]
    v_max_f32 v144, 0, v144
    v_max_f32 v145, 0, v145
    v_pk_mul_f32 v[176:177], v[176:177], v[12:13] op_sel_hi:[1,0]
    v_pk_mul_f32 v[144:145], v[144:145], v[176:177]
    v_cvt_pk_bf16_f32 v16, v144, v145
    v_pk_fma_f32 v[146:147], v[194:195], v[8:9], v[146:147] op_sel_hi:[1,0,1]
    v_pk_fma_f32 v[178:179], v[210:211], v[8:9], v[178:179] op_sel_hi:[1,0,1]
    v_max_f32 v146, 0, v146
    v_max_f32 v147, 0, v147
    v_pk_mul_f32 v[178:179], v[178:179], v[12:13] op_sel_hi:[1,0]
    v_pk_mul_f32 v[146:147], v[146:147], v[178:179]
    v_cvt_pk_bf16_f32 v17, v146, v147
    s_waitcnt lgkmcnt(2)
    v_pk_fma_f32 v[148:149], v[196:197], v[8:9], v[148:149] op_sel_hi:[1,0,1]
    v_pk_fma_f32 v[180:181], v[212:213], v[8:9], v[180:181] op_sel_hi:[1,0,1]
    v_max_f32 v148, 0, v148
    v_max_f32 v149, 0, v149
    v_pk_mul_f32 v[180:181], v[180:181], v[12:13] op_sel_hi:[1,0]
    v_pk_mul_f32 v[148:149], v[148:149], v[180:181]
    v_cvt_pk_bf16_f32 v18, v148, v149
    v_pk_fma_f32 v[150:151], v[198:199], v[8:9], v[150:151] op_sel_hi:[1,0,1]
    v_pk_fma_f32 v[182:183], v[214:215], v[8:9], v[182:183] op_sel_hi:[1,0,1]
    v_max_f32 v150, 0, v150
    v_max_f32 v151, 0, v151
    v_pk_mul_f32 v[182:183], v[182:183], v[12:13] op_sel_hi:[1,0]
    v_pk_mul_f32 v[150:151], v[150:151], v[182:183]
    v_cvt_pk_bf16_f32 v19, v150, v151
    s_add_u32 s57, s56, 6144
    buffer_store_dwordx4 v[16:19], v10, s[32:35], s57 offen sc1
    s_waitcnt lgkmcnt(1)
    v_pk_fma_f32 v[152:153], v[200:201], v[8:9], v[152:153] op_sel_hi:[1,0,1]
    v_pk_fma_f32 v[184:185], v[216:217], v[8:9], v[184:185] op_sel_hi:[1,0,1]
    v_max_f32 v152, 0, v152
    v_max_f32 v153, 0, v153
    v_pk_mul_f32 v[184:185], v[184:185], v[12:13] op_sel_hi:[1,0]
    v_pk_mul_f32 v[152:153], v[152:153], v[184:185]
    v_cvt_pk_bf16_f32 v20, v152, v153
    v_pk_fma_f32 v[154:155], v[202:203], v[8:9], v[154:155] op_sel_hi:[1,0,1]
    v_pk_fma_f32 v[186:187], v[218:219], v[8:9], v[186:187] op_sel_hi:[1,0,1]
    v_max_f32 v154, 0, v154
    v_max_f32 v155, 0, v155
    v_pk_mul_f32 v[186:187], v[186:187], v[12:13] op_sel_hi:[1,0]
    v_pk_mul_f32 v[154:155], v[154:155], v[186:187]
    v_cvt_pk_bf16_f32 v21, v154, v155
    s_waitcnt lgkmcnt(0)
    v_pk_fma_f32 v[156:157], v[204:205], v[8:9], v[156:157] op_sel_hi:[1,0,1]
    v_pk_fma_f32 v[188:189], v[220:221], v[8:9], v[188:189] op_sel_hi:[1,0,1]
    v_max_f32 v156, 0, v156
    v_max_f32 v157, 0, v157
    v_pk_mul_f32 v[188:189], v[188:189], v[12:13] op_sel_hi:[1,0]
    v_pk_mul_f32 v[156:157], v[156:157], v[188:189]
    v_cvt_pk_bf16_f32 v22, v156, v157
    v_pk_fma_f32 v[158:159], v[206:207], v[8:9], v[158:159] op_sel_hi:[1,0,1]
    v_pk_fma_f32 v[190:191], v[222:223], v[8:9], v[190:191] op_sel_hi:[1,0,1]
    v_max_f32 v158, 0, v158
    v_max_f32 v159, 0, v159
    v_pk_mul_f32 v[190:191], v[190:191], v[12:13] op_sel_hi:[1,0]
    v_pk_mul_f32 v[158:159], v[158:159], v[190:191]
    v_cvt_pk_bf16_f32 v23, v158, v159
    s_add_u32 s57, s56, 7168
    buffer_store_dwordx4 v[20:23], v10, s[32:35], s57 offen sc1
L_hidskip_40:
    s_waitcnt lgkmcnt(0)
    s_lshl_b32 s63, s41, 11
    s_add_u32 s63, s63, 98304
    v_lshlrev_b32 v46, 7, v1
    v_add_u32 v46, s63, v46
    v_mov_b32 v47, 1
    s_waitcnt vmcnt(0)
    s_barrier
    s_cmp_lg_u32 s40, 0
    s_cbranch_scc1 L_arr_41
    s_mov_b64 exec, 0xffff
    buffer_atomic_add v47, v46, s[32:35], 0 offen
    s_mov_b64 exec, -1
L_arr_41:
    s_add_u32 m0, s46, 98304
    s_mul_i32 s99, s94, 20480
    s_mov_b32 s3, s99
    buffer_load_dwordx4 v48, s[24:27], s3 offen lds
    s_add_u32 m0, s46, 99328
    s_add_u32 s3, s99, 10240
    buffer_load_dwordx4 v48, s[24:27], s3 offen lds
    s_add_u32 m0, s46, 100352
    s_add_u32 s101, s94, 1
    s_cmp_eq_u32 s101, 108
    s_cselect_b32 s101, 0, s101
    s_mul_i32 s99, s101, 20480
    s_mov_b32 s3, s99
    buffer_load_dwordx4 v48, s[24:27], s3 offen lds
    s_add_u32 m0, s46, 101376
    s_add_u32 s3, s99, 10240
    buffer_load_dwordx4 v48, s[24:27], s3 offen lds
    s_add_u32 s94, s94, 8
    s_cmp_ge_u32 s94, 108
    s_cselect_b32 s3, 108, 0
    s_sub_u32 s94, s94, s3
    s_add_u32 m0, s46, 114688
    s_mul_i32 s99, s94, 20480
    s_mov_b32 s3, s99
    buffer_load_dwordx4 v48, s[24:27], s3 offen lds
    s_add_u32 m0, s46, 115712
    s_add_u32 s3, s99, 10240
    buffer_load_dwordx4 v48, s[24:27], s3 offen lds
    s_add_u32 m0, s46, 116736
    s_add_u32 s101, s94, 1
    s_cmp_eq_u32 s101, 108
    s_cselect_b32 s101, 0, s101
    s_mul_i32 s99, s101, 20480
    s_mov_b32 s3, s99
    buffer_load_dwordx4 v48, s[24:27], s3 offen lds
    s_add_u32 m0, s46, 117760
    s_add_u32 s3, s99, 10240
    buffer_load_dwordx4 v48, s[24:27], s3 offen lds
    s_add_u32 s94, s94, 8
    s_cmp_ge_u32 s94, 108
    s_cselect_b32 s3, 108, 0
    s_sub_u32 s94, s94, s3
    s_cmp_lt_u32 s45, 5
    s_cbranch_scc1 L_p4
    s_mov_b32 s26, 2211840
    s_and_b32 s48, s41, 3
    s_lshl_b32 s48, s48, 1
    s_add_u32 s48, s48, s45
    s_sub_u32 s48, s48, 5
    s_lshl_b32 s48, s48, 2
    s_add_u32 s48, s48, s40
    s_mul_i32 s48, s48, 30
    s_add_u32 s48, s48, 768
    s_mul_i32 s48, s48, 1280
    s_lshr_b32 s49, s42, 3
    s_mul_i32 s49, s49, 640
    s_add_u32 s48, s48, s49
    v_mul_u32_u24 v4, 26, v1
    v_lshrrev_b32 v4, 8, v4
    v_mul_u32_u24 v5, 10, v4
    v_sub_u32 v5, v1, v5
    v_mul_u32_u24 v4, 1280, v4
    v_lshlrev_b32 v5, 6, v5
    v_add_u32 v4, v4, v5
    s_mov_b32 exec_lo, -1
    s_mov_b32 exec_hi, 0xfffffff
    buffer_load_dword v43, v4, s[24:27], s48 offen
    s_add_u32 s48, s48, 7680
    buffer_load_dword v43, v4, s[24:27], s48 offen
    s_add_u32 s48, s48, 7680
    buffer_load_dword v43, v4, s[24:27], s48 offen
    s_add_u32 s48, s48, 7680
    buffer_load_dword v43, v4, s[24:27], s48 offen
    s_add_u32 s48, s48, 7680
    buffer_load_dword v43, v4, s[24:27], s48 offen
    s_add_u32 s48, s48, 7680
    s_mov_b64 exec, -1
    s_lshl_b32 s63, s41, 11
    s_add_u32 s63, s63, 98304
    s_lshl_b32 s62, s42, 7
    s_add_u32 s63, s63, s62
    s_cmp_lg_u32 s40, 0
    s_cbranch_scc1 L_polld_43
    v_mov_b32 v4, 0
    s_mov_b32 s100, 0
    s_mov_b64 exec, 1
L_poll_42:
    buffer_load_dword v5, v4, s[32:35], s63 offen sc1
    s_add_u32 s100, s100, 1
    s_waitcnt vmcnt(0)
    v_readfirstlane_b32 s62, v5
    s_cmp_ge_u32 s100, 400000
    s_cbranch_scc1 L_polld_43x
    s_cmp_ge_u32 s62, 14
    s_cbranch_scc1 L_polld_43x
    s_branch L_poll_42
L_polld_43x:
    s_waitcnt vmcnt(0)
    s_mov_b64 exec, -1
L_polld_43:
    s_waitcnt vmcnt(0)
    s_barrier
    s_lshl_b32 s50, s41, 2
    s_add_u32 s50, s50, s40
    s_mul_i32 s50, s50, 110592
    s_add_u32 s50, s50, 8388608
    s_sub_u32 s51, s45, 5
    s_lshl_b32 s51, s51, 12
    s_add_u32 s50, s50, s51
    v_lshlrev_b32 v4, 6, v1
    buffer_load_dword v43, v4, s[32:35], s50 offen sc1
    s_add_u32 s50, s50, 8192
    buffer_load_dword v43, v4, s[32:35], s50 offen sc1
    s_add_u32 s50, s50, 8192
    buffer_load_dword v43, v4, s[32:35], s50 offen sc1
    s_add_u32 s50, s50, 8192
    buffer_load_dword v43, v4, s[32:35], s50 offen sc1
    s_add_u32 s50, s50, 8192
    buffer_load_dword v43, v4, s[32:35], s50 offen sc1
    s_add_u32 s50, s50, 8192
    buffer_load_dword v43, v4, s[32:35], s50 offen sc1
    s_add_u32 s50, s50, 8192
    buffer_load_dword v43, v4, s[32:35], s50 offen sc1
    s_add_u32 s50, s50, 8192
    buffer_load_dword v43, v4, s[32:35], s50 offen sc1
    s_add_u32 s50, s50, 8192
    buffer_load_dword v43, v4, s[32:35], s50 offen sc1
    s_add_u32 s50, s50, 8192
    buffer_load_dword v43, v4, s[32:35], s50 offen sc1
    s_add_u32 s50, s50, 8192
    buffer_load_dword v43, v4, s[32:35], s50 offen sc1
    s_add_u32 s50, s50, 8192
    buffer_load_dword v43, v4, s[32:35], s50 offen sc1
    s_add_u32 s50, s50, 8192
    buffer_load_dword v43, v4, s[32:35], s50 offen sc1
    s_add_u32 s50, s50, 8192
    buffer_load_dword v43, v4, s[32:35], s50 offen sc1
    s_add_u32 s50, s50, 8192
    s_waitcnt vmcnt(0)
    s_branch L_fin
L_p4:
    v_accvgpr_read_b32 v4, a224
    v_lshlrev_b32 v64, 16, v4
    v_and_b32 v65, 0xffff0000, v4
    v_accvgpr_read_b32 v4, a225
    v_lshlrev_b32 v66, 16, v4
    v_and_b32 v67, 0xffff0000, v4
    v_accvgpr_read_b32 v4, a226
    v_lshlrev_b32 v68, 16, v4
    v_and_b32 v69, 0xffff0000, v4
    v_accvgpr_read_b32 v4, a227
    v_lshlrev_b32 v70, 16, v4
    v_and_b32 v71, 0xffff0000, v4
    v_accvgpr_read_b32 v4, a228
    v_lshlrev_b32 v72, 16, v4
    v_and_b32 v73, 0xffff0000, v4
    v_accvgpr_read_b32 v4, a229
    v_lshlrev_b32 v74, 16, v4
    v_and_b32 v75, 0xffff0000, v4
    v_accvgpr_read_b32 v4, a230
    v_lshlrev_b32 v76, 16, v4
    v_and_b32 v77, 0xffff0000, v4
    v_accvgpr_read_b32 v4, a231
    v_lshlrev_b32 v78, 16, v4
    v_and_b32 v79, 0xffff0000, v4
    v_accvgpr_read_b32 v4, a232
    v_lshlrev_b32 v80, 16, v4
    v_and_b32 v81, 0xffff0000, v4
    v_accvgpr_read_b32 v4, a233
    v_lshlrev_b32 v82, 16, v4
    v_and_b32 v83, 0xffff0000, v4
    v_accvgpr_read_b32 v4, a234
    v_lshlrev_b32 v84, 16, v4
    v_and_b32 v85, 0xffff0000, v4
    v_accvgpr_read_b32 v4, a235
    v_lshlrev_b32 v86, 16, v4
    v_and_b32 v87, 0xffff0000, v4
    v_accvgpr_read_b32 v4, a236
    v_lshlrev_b32 v88, 16, v4
    v_and_b32 v89, 0xffff0000, v4
    v_accvgpr_read_b32 v4, a237
    v_lshlrev_b32 v90, 16, v4
    v_and_b32 v91, 0xffff0000, v4
    v_accvgpr_read_b32 v4, a238
    v_lshlrev_b32 v92, 16, v4
    v_and_b32 v93, 0xffff0000, v4
    v_accvgpr_read_b32 v4, a239
    v_lshlrev_b32 v94, 16, v4
    v_and_b32 v95, 0xffff0000, v4
    v_accvgpr_read_b32 v11, a223
    v_lshlrev_b32 v4, 3, v3
    v_add_u32 v11, v11, v4
    s_lshl_b32 s50, s41, 2
    s_add_u32 s50, s50, s40
    s_mul_i32 s50, s50, 110592
    s_add_u32 s50, s50, 8388608
    s_and_b32 s51, s41, 3
    s_mul_i32 s51, s51, 0
    s_mul_i32 s63, s45, 0
    s_add_u32 s51, s51, s63
    s_cmp_ge_u32 s51, 108
    s_cselect_b32 s63, 108, 0
    s_sub_u32 s51, s51, s63
    s_mov_b32 s97, s50
    s_add_u32 s98, s50, 110592
    s_lshl_b32 s63, s51, 10
    s_add_u32 s96, s50, s63
    v_lshlrev_b32 v10, 4, v1
    s_lshl_b32 s63, s41, 11
    s_add_u32 s63, s63, 98304
    s_lshl_b32 s62, s42, 7
    s_add_u32 s63, s63, s62
    s_cmp_lg_u32 s40, 0
    s_cbranch_scc1 L_polld_45
    v_mov_b32 v4, 0
    s_mov_b32 s100, 0
    s_mov_b64 exec, 1
L_poll_44:
    buffer_load_dword v5, v4, s[32:35], s63 offen sc1
    s_add_u32 s100, s100, 1
    s_waitcnt vmcnt(0)
    v_readfirstlane_b32 s62, v5
    s_cmp_ge_u32 s100, 400000
    s_cbranch_scc1 L_polld_45x
    s_cmp_ge_u32 s62, 14
    s_cbranch_scc1 L_polld_45x
    s_branch L_poll_44
L_polld_45x:
    s_waitcnt vmcnt(0)
    s_mov_b64 exec, -1
L_polld_45:
    s_waitcnt vmcnt(0)
    s_barrier
    buffer_load_dwordx4 a[0:3], v10, s[32:35], s96 offen offset:0 sc1
    buffer_load_dwordx4 a[4:7], v10, s[32:35], s96 offen offset:1024 sc1
    buffer_load_dwordx4 a[8:11], v10, s[32:35], s96 offen offset:2048 sc1
    buffer_load_dwordx4 a[12:15], v10, s[32:35], s96 offen offset:3072 sc1
    s_add_u32 s96, s96, 4096
    s_cmp_eq_u32 s96, s98
    s_cselect_b32 s96, s97, s96
    buffer_load_dwordx4 a[16:19], v10, s[32:35], s96 offen offset:0 sc1
    buffer_load_dwordx4 a[20:23], v10, s[32:35], s96 offen offset:1024 sc1
    buffer_load_dwordx4 a[24:27], v10, s[32:35], s96 offen offset:2048 sc1
    buffer_load_dwordx4 a[28:31], v10, s[32:35], s96 offen offset:3072 sc1
    s_add_u32 s96, s96, 4096
    s_cmp_eq_u32 s96, s98
    s_cselect_b32 s96, s97, s96
    buffer_load_dwordx4 a[32:35], v10, s[32:35], s96 offen offset:0 sc1
    buffer_load_dwordx4 a[36:39], v10, s[32:35], s96 offen offset:1024 sc1
    buffer_load_dwordx4 a[40:43], v10, s[32:35], s96 offen offset:2048 sc1
    buffer_load_dwordx4 a[44:47], v10, s[32:35], s96 offen offset:3072 sc1
    s_add_u32 s96, s96, 4096
    s_cmp_eq_u32 s96, s98
    s_cselect_b32 s96, s97, s96
    ds_read_b64_tr_b16 a[160:161], v50 offset:32768
    ds_read_b64_tr_b16 a[162:163], v50 offset:33792
    ds_read_b64_tr_b16 a[164:165], v51 offset:32768
    ds_read_b64_tr_b16 a[166:167], v51 offset:33792
    ds_read_b64_tr_b16 a[168:169], v50 offset:34816
    ds_read_b64_tr_b16 a[170:171], v50 offset:35840
    ds_read_b64_tr_b16 a[172:173], v51 offset:34816
    ds_read_b64_tr_b16 a[174:175], v51 offset:35840
    ds_read_b64_tr_b16 a[176:177], v50 offset:36864
    ds_read_b64_tr_b16 a[178:179], v50 offset:37888
    ds_read_b64_tr_b16 a[180:181], v51 offset:36864
    ds_read_b64_tr_b16 a[182:183], v51 offset:37888
    s_waitcnt vmcnt(11) lgkmcnt(8)
    v_mfma_f32_32x32x16_bf16 v[64:79], a[160:163], a[0:3], v[64:79]
    ds_read_b64_tr_b16 a[184:185], v50 offset:38912
    ds_read_b64_tr_b16 a[186:187], v50 offset:39936
    v_mfma_f32_32x32x16_bf16 v[80:95], a[164:167], a[0:3], v[80:95]
    ds_read_b64_tr_b16 a[188:189], v51 offset:38912
    ds_read_b64_tr_b16 a[190:191], v51 offset:39936
    buffer_load_dwordx4 a[0:3], v10, s[32:35], s96 offen offset:0 sc1
    s_add_u32 m0, s46, 0
    s_mul_i32 s99, s94, 20480
    s_mov_b32 s3, s99
    buffer_load_dwordx4 v48, s[24:27], s3 offen lds
    s_waitcnt vmcnt(12) lgkmcnt(8)
    v_mfma_f32_32x32x16_bf16 v[64:79], a[168:171], a[4:7], v[64:79]
    ds_read_b64_tr_b16 a[160:161], v50 offset:40960
    ds_read_b64_tr_b16 a[162:163], v50 offset:41984
    v_mfma_f32_32x32x16_bf16 v[80:95], a[172:175], a[4:7], v[80:95]
    ds_read_b64_tr_b16 a[164:165], v51 offset:40960
    ds_read_b64_tr_b16 a[166:167], v51 offset:41984
    buffer_load_dwordx4 a[4:7], v10, s[32:35], s96 offen offset:1024 sc1
    s_waitcnt vmcnt(12) lgkmcnt(8)
    v_mfma_f32_32x32x16_bf16 v[64:79], a[176:179], a[8:11], v[64:79]
    ds_read_b64_tr_b16 a[168:169], v50 offset:43008
    ds_read_b64_tr_b16 a[170:171], v50 offset:44032
    v_mfma_f32_32x32x16_bf16 v[80:95], a[180:183], a[8:11], v[80:95]
    ds_read_b64_tr_b16 a[172:173], v51 offset:43008
    ds_read_b64_tr_b16 a[174:175], v51 offset:44032
    buffer_load_dwordx4 a[8:11], v10, s[32:35], s96 offen offset:2048 sc1
    s_add_u32 m0, s46, 1024
    s_add_u32 s3, s99, 10240
    buffer_load_dwordx4 v48, s[24:27], s3 offen lds
    s_waitcnt vmcnt(13) lgkmcnt(8)
    v_mfma_f32_32x32x16_bf16 v[64:79], a[184:187], a[12:15], v[64:79]
    ds_read_b64_tr_b16 a[176:177], v50 offset:45056
    ds_read_b64_tr_b16 a[178:179], v50 offset:46080
    v_mfma_f32_32x32x16_bf16 v[80:95], a[188:191], a[12:15], v[80:95]
    ds_read_b64_tr_b16 a[180:181], v51 offset:45056
    ds_read_b64_tr_b16 a[182:183], v51 offset:46080
    buffer_load_dwordx4 a[12:15], v10, s[32:35], s96 offen offset:3072 sc1
    s_add_u32 s96, s96, 4096
    s_cmp_eq_u32 s96, s98
    s_cselect_b32 s96, s97, s96
    s_waitcnt vmcnt(13) lgkmcnt(8)
    v_mfma_f32_32x32x16_bf16 v[64:79], a[160:163], a[16:19], v[64:79]
    ds_read_b64_tr_b16 a[184:185], v50 offset:47104
    ds_read_b64_tr_b16 a[186:187], v50 offset:48128
    v_mfma_f32_32x32x16_bf16 v[80:95], a[164:167], a[16:19], v[80:95]
    ds_read_b64_tr_b16 a[188:189], v51 offset:47104
    ds_read_b64_tr_b16 a[190:191], v51 offset:48128
    buffer_load_dwordx4 a[16:19], v10, s[32:35], s96 offen offset:0 sc1
    s_add_u32 m0, s46, 2048
    s_add_u32 s101, s94, 1
    s_cmp_eq_u32 s101, 108
    s_cselect_b32 s101, 0, s101
    s_mul_i32 s99, s101, 20480
    s_mov_b32 s3, s99
    buffer_load_dwordx4 v48, s[24:27], s3 offen lds
    s_barrier
    s_add_u32 m0, s46, 3072
    s_add_u32 s3, s99, 10240
    buffer_load_dwordx4 v48, s[24:27], s3 offen lds
    s_add_u32 s94, s94, 8
    s_cmp_ge_u32 s94, 108
    s_cselect_b32 s3, 108, 0
    s_sub_u32 s94, s94, s3
    s_waitcnt vmcnt(15) lgkmcnt(8)
    v_mfma_f32_32x32x16_bf16 v[64:79], a[168:171], a[20:23], v[64:79]
    ds_read_b64_tr_b16 a[160:161], v50 offset:49152
    ds_read_b64_tr_b16 a[162:163], v50 offset:50176
    v_mfma_f32_32x32x16_bf16 v[80:95], a[172:175], a[20:23], v[80:95]
    ds_read_b64_tr_b16 a[164:165], v51 offset:49152
    ds_read_b64_tr_b16 a[166:167], v51 offset:50176
    buffer_load_dwordx4 a[20:23], v10, s[32:35], s96 offen offset:1024 sc1
    s_waitcnt vmcnt(15) lgkmcnt(8)
    v_mfma_f32_32x32x16_bf16 v[64:79], a[176:179], a[24:27], v[64:79]
    ds_read_b64_tr_b16 a[168:169], v50 offset:51200
    ds_read_b64_tr_b16 a[170:171], v50 offset:52224
    v_mfma_f32_32x32x16_bf16 v[80:95], a[180:183], a[24:27], v[80:95]
    ds_read_b64_tr_b16 a[172:173], v51 offset:51200
    ds_read_b64_tr_b16 a[174:175], v51 offset:52224
    buffer_load_dwordx4 a[24:27], v10, s[32:35], s96 offen offset:2048 sc1
    s_add_u32 m0, s46, 16384
    s_mul_i32 s99, s94, 20480
    s_mov_b32 s3, s99
    buffer_load_dwordx4 v48, s[24:27], s3 offen lds
    s_waitcnt vmcnt(16) lgkmcnt(8)
    v_mfma_f32_32x32x16_bf16 v[64:79], a[184:187], a[28:31], v[64:79]
    ds_read_b64_tr_b16 a[176:177], v50 offset:53248
    ds_read_b64_tr_b16 a[178:179], v50 offset:54272
    v_mfma_f32_32x32x16_bf16 v[80:95], a[188:191], a[28:31], v[80:95]
    ds_read_b64_tr_b16 a[180:181], v51 offset:53248
    ds_read_b64_tr_b16 a[182:183], v51 offset:54272
    buffer_load_dwordx4 a[28:31], v10, s[32:35], s96 offen offset:3072 sc1
    s_add_u32 s96, s96, 4096
    s_cmp_eq_u32 s96, s98
    s_cselect_b32 s96, s97, s96
    s_waitcnt vmcnt(16) lgkmcnt(8)
    v_mfma_f32_32x32x16_bf16 v[64:79], a[160:163], a[32:35], v[64:79]
    ds_read_b64_tr_b16 a[184:185], v50 offset:55296
    ds_read_b64_tr_b16 a[186:187], v50 offset:56320
    v_mfma_f32_32x32x16_bf16 v[80:95], a[164:167], a[32:35], v[80:95]
    ds_read_b64_tr_b16 a[188:189], v51 offset:55296
    ds_read_b64_tr_b16 a[190:191], v51 offset:56320
    buffer_load_dwordx4 a[32:35], v10, s[32:35], s96 offen offset:0 sc1
    s_add_u32 m0, s46, 17408
    s_add_u32 s3, s99, 10240
    buffer_load_dwordx4 v48, s[24:27], s3 offen lds
    s_waitcnt vmcnt(17) lgkmcnt(8)
    v_mfma_f32_32x32x16_bf16 v[64:79], a[168:171], a[36:39], v[64:79]
    ds_read_b64_tr_b16 a[160:161], v50 offset:57344
    ds_read_b64_tr_b16 a[162:163], v50 offset:58368
    v_mfma_f32_32x32x16_bf16 v[80:95], a[172:175], a[36:39], v[80:95]
    ds_read_b64_tr_b16 a[164:165], v51 offset:57344
    ds_read_b64_tr_b16 a[166:167], v51 offset:58368
    buffer_load_dwordx4 a[36:39], v10, s[32:35], s96 offen offset:1024 sc1
    s_waitcnt vmcnt(17) lgkmcnt(8)
    v_mfma_f32_32x32x16_bf16 v[64:79], a[176:179], a[40:43], v[64:79]
    ds_read_b64_tr_b16 a[168:169], v50 offset:59392
    ds_read_b64_tr_b16 a[170:171], v50 offset:60416
    v_mfma_f32_32x32x16_bf16 v[80:95], a[180:183], a[40:43], v[80:95]
    ds_read_b64_tr_b16 a[172:173], v51 offset:59392
    ds_read_b64_tr_b16 a[174:175], v51 offset:60416
    buffer_load_dwordx4 a[40:43], v10, s[32:35], s96 offen offset:2048 sc1
    s_add_u32 m0, s46, 18432
    s_add_u32 s101, s94, 1
    s_cmp_eq_u32 s101, 108
    s_cselect_b32 s101, 0, s101
    s_mul_i32 s99, s101, 20480
    s_mov_b32 s3, s99
    buffer_load_dwordx4 v48, s[24:27], s3 offen lds
    s_waitcnt vmcnt(18) lgkmcnt(8)
    v_mfma_f32_32x32x16_bf16 v[64:79], a[184:187], a[44:47], v[64:79]
    ds_read_b64_tr_b16 a[176:177], v50 offset:61440
    ds_read_b64_tr_b16 a[178:179], v50 offset:62464
    v_mfma_f32_32x32x16_bf16 v[80:95], a[188:191], a[44:47], v[80:95]
    ds_read_b64_tr_b16 a[180:181], v51 offset:61440
    ds_read_b64_tr_b16 a[182:183], v51 offset:62464
    buffer_load_dwordx4 a[44:47], v10, s[32:35], s96 offen offset:3072 sc1
    s_add_u32 s96, s96, 4096
    s_cmp_eq_u32 s96, s98
    s_cselect_b32 s96, s97, s96
    s_waitcnt vmcnt(18) lgkmcnt(8)
    v_mfma_f32_32x32x16_bf16 v[64:79], a[160:163], a[0:3], v[64:79]
    ds_read_b64_tr_b16 a[184:185], v50 offset:63488
    ds_read_b64_tr_b16 a[186:187], v50 offset:64512
    v_mfma_f32_32x32x16_bf16 v[80:95], a[164:167], a[0:3], v[80:95]
    ds_read_b64_tr_b16 a[188:189], v51 offset:63488
    ds_read_b64_tr_b16 a[190:191], v51 offset:64512
    buffer_load_dwordx4 a[0:3], v10, s[32:35], s96 offen offset:0 sc1
    s_add_u32 m0, s46, 19456
    s_add_u32 s3, s99, 10240
    buffer_load_dwordx4 v48, s[24:27], s3 offen lds
    s_add_u32 s94, s94, 8
    s_cmp_ge_u32 s94, 108
    s_cselect_b32 s3, 108, 0
    s_sub_u32 s94, s94, s3
    s_barrier
    s_waitcnt vmcnt(18) lgkmcnt(8)
    v_mfma_f32_32x32x16_bf16 v[64:79], a[168:171], a[4:7], v[64:79]
    ds_read_b64_tr_b16 a[160:161], v52 offset:0
    ds_read_b64_tr_b16 a[162:163], v52 offset:1024
    v_mfma_f32_32x32x16_bf16 v[80:95], a[172:175], a[4:7], v[80:95]
    ds_read_b64_tr_b16 a[164:165], v53 offset:0
    ds_read_b64_tr_b16 a[166:167], v53 offset:1024
    buffer_load_dwordx4 a[4:7], v10, s[32:35], s96 offen offset:1024 sc1
    s_waitcnt vmcnt(18) lgkmcnt(8)
    v_mfma_f32_32x32x16_bf16 v[64:79], a[176:179], a[8:11], v[64:79]
    ds_read_b64_tr_b16 a[168:169], v52 offset:2048
    ds_read_b64_tr_b16 a[170:171], v52 offset:3072
    v_mfma_f32_32x32x16_bf16 v[80:95], a[180:183], a[8:11], v[80:95]
    ds_read_b64_tr_b16 a[172:173], v53 offset:2048
    ds_read_b64_tr_b16 a[174:175], v53 offset:3072
    buffer_load_dwordx4 a[8:11], v10, s[32:35], s96 offen offset:2048 sc1
    s_add_u32 m0, s46, 32768
    s_mul_i32 s99, s94, 20480
    s_mov_b32 s3, s99
    buffer_load_dwordx4 v48, s[24:27], s3 offen lds
    s_waitcnt vmcnt(18) lgkmcnt(8)
    v_mfma_f32_32x32x16_bf16 v[64:79], a[184:187], a[12:15], v[64:79]
    ds_read_b64_tr_b16 a[176:177], v52 offset:4096
    ds_read_b64_tr_b16 a[178:179], v52 offset:5120
    v_mfma_f32_32x32x16_bf16 v[80:95], a[188:191], a[12:15], v[80:95]
    ds_read_b64_tr_b16 a[180:181], v53 offset:4096
    ds_read_b64_tr_b16 a[182:183], v53 offset:5120
    buffer_load_dwordx4 a[12:15], v10, s[32:35], s96 offen offset:3072 sc1
    s_add_u32 s96, s96, 4096
    s_cmp_eq_u32 s96, s98
    s_cselect_b32 s96, s97, s96
    s_waitcnt vmcnt(18) lgkmcnt(8)
    v_mfma_f32_32x32x16_bf16 v[64:79], a[160:163], a[16:19], v[64:79]
    ds_read_b64_tr_b16 a[184:185], v52 offset:6144
    ds_read_b64_tr_b16 a[186:187], v52 offset:7168
    v_mfma_f32_32x32x16_bf16 v[80:95], a[164:167], a[16:19], v[80:95]
    ds_read_b64_tr_b16 a[188:189], v53 offset:6144
    ds_read_b64_tr_b16 a[190:191], v53 offset:7168
    buffer_load_dwordx4 a[16:19], v10, s[32:35], s96 offen offset:0 sc1
    s_add_u32 m0, s46, 33792
    s_add_u32 s3, s99, 10240
    buffer_load_dwordx4 v48, s[24:27], s3 offen lds
    s_waitcnt vmcnt(17) lgkmcnt(8)
    v_mfma_f32_32x32x16_bf16 v[64:79], a[168:171], a[20:23], v[64:79]
    ds_read_b64_tr_b16 a[160:161], v52 offset:8192
    ds_read_b64_tr_b16 a[162:163], v52 offset:9216
    v_mfma_f32_32x32x16_bf16 v[80:95], a[172:175], a[20:23], v[80:95]
    ds_read_b64_tr_b16 a[164:165], v53 offset:8192
    ds_read_b64_tr_b16 a[166:167], v53 offset:9216
    buffer_load_dwordx4 a[20:23], v10, s[32:35], s96 offen offset:1024 sc1
    s_waitcnt vmcnt(17) lgkmcnt(8)
    v_mfma_f32_32x32x16_bf16 v[64:79], a[176:179], a[24:27], v[64:79]
    ds_read_b64_tr_b16 a[168:169], v52 offset:10240
    ds_read_b64_tr_b16 a[170:171], v52 offset:11264
    v_mfma_f32_32x32x16_bf16 v[80:95], a[180:183], a[24:27], v[80:95]
    ds_read_b64_tr_b16 a[172:173], v53 offset:10240
    ds_read_b64_tr_b16 a[174:175], v53 offset:11264
    buffer_load_dwordx4 a[24:27], v10, s[32:35], s96 offen offset:2048 sc1
    s_add_u32 m0, s46, 34816
    s_add_u32 s101, s94, 1
    s_cmp_eq_u32 s101, 108
    s_cselect_b32 s101, 0, s101
    s_mul_i32 s99, s101, 20480
    s_mov_b32 s3, s99
    buffer_load_dwordx4 v48, s[24:27], s3 offen lds
    s_waitcnt vmcnt(17) lgkmcnt(8)
    v_mfma_f32_32x32x16_bf16 v[64:79], a[184:187], a[28:31], v[64:79]
    ds_read_b64_tr_b16 a[176:177], v52 offset:12288
    ds_read_b64_tr_b16 a[178:179], v52 offset:13312
    v_mfma_f32_32x32x16_bf16 v[80:95], a[188:191], a[28:31], v[80:95]
    ds_read_b64_tr_b16 a[180:181], v53 offset:12288
    ds_read_b64_tr_b16 a[182:183], v53 offset:13312
    buffer_load_dwordx4 a[28:31], v10, s[32:35], s96 offen offset:3072 sc1
    s_add_u32 s96, s96, 4096
    s_cmp_eq_u32 s96, s98
    s_cselect_b32 s96, s97, s96
    s_waitcnt vmcnt(17) lgkmcnt(8)
    v_mfma_f32_32x32x16_bf16 v[64:79], a[160:163], a[32:35], v[64:79]
    ds_read_b64_tr_b16 a[184:185], v52 offset:14336
    ds_read_b64_tr_b16 a[186:187], v52 offset:15360
    v_mfma_f32_32x32x16_bf16 v[80:95], a[164:167], a[32:35], v[80:95]
    ds_read_b64_tr_b16 a[188:189], v53 offset:14336
    ds_read_b64_tr_b16 a[190:191], v53 offset:15360
    buffer_load_dwordx4 a[32:35], v10, s[32:35], s96 offen offset:0 sc1
    s_add_u32 m0, s46, 35840
    s_add_u32 s3, s99, 10240
    buffer_load_dwordx4 v48, s[24:27], s3 offen lds
    s_add_u32 s94, s94, 8
    s_cmp_ge_u32 s94, 108
    s_cselect_b32 s3, 108, 0
    s_sub_u32 s94, s94, s3
    s_barrier
    s_waitcnt vmcnt(17) lgkmcnt(8)
    v_mfma_f32_32x32x16_bf16 v[64:79], a[168:171], a[36:39], v[64:79]
    ds_read_b64_tr_b16 a[160:161], v52 offset:16384
    ds_read_b64_tr_b16 a[162:163], v52 offset:17408
    v_mfma_f32_32x32x16_bf16 v[80:95], a[172:175], a[36:39], v[80:95]
    ds_read_b64_tr_b16 a[164:165], v53 offset:16384
    ds_read_b64_tr_b16 a[166:167], v53 offset:17408
    buffer_load_dwordx4 a[36:39], v10, s[32:35], s96 offen offset:1024 sc1
    s_waitcnt vmcnt(17) lgkmcnt(8)
    v_mfma_f32_32x32x16_bf16 v[64:79], a[176:179], a[40:43], v[64:79]
    ds_read_b64_tr_b16 a[168:169], v52 offset:18432
    ds_read_b64_tr_b16 a[170:171], v52 offset:19456
    v_mfma_f32_32x32x16_bf16 v[80:95], a[180:183], a[40:43], v[80:95]
    ds_read_b64_tr_b16 a[172:173], v53 offset:18432
    ds_read_b64_tr_b16 a[174:175], v53 offset:19456
    buffer_load_dwordx4 a[40:43], v10, s[32:35], s96 offen offset:2048 sc1
    s_add_u32 m0, s46, 49152
    s_mul_i32 s99, s94, 20480
    s_mov_b32 s3, s99
    buffer_load_dwordx4 v48, s[24:27], s3 offen lds
    s_waitcnt vmcnt(17) lgkmcnt(8)
    v_mfma_f32_32x32x16_bf16 v[64:79], a[184:187], a[44:47], v[64:79]
    ds_read_b64_tr_b16 a[176:177], v52 offset:20480
    ds_read_b64_tr_b16 a[178:179], v52 offset:21504
    v_mfma_f32_32x32x16_bf16 v[80:95], a[188:191], a[44:47], v[80:95]
    ds_read_b64_tr_b16 a[180:181], v53 offset:20480
    ds_read_b64_tr_b16 a[182:183], v53 offset:21504
    buffer_load_dwordx4 a[44:47], v10, s[32:35], s96 offen offset:3072 sc1
    s_add_u32 s96, s96, 4096
    s_cmp_eq_u32 s96, s98
    s_cselect_b32 s96, s97, s96
    s_waitcnt vmcnt(17) lgkmcnt(8)
    v_mfma_f32_32x32x16_bf16 v[64:79], a[160:163], a[0:3], v[64:79]
    ds_read_b64_tr_b16 a[184:185], v52 offset:22528
    ds_read_b64_tr_b16 a[186:187], v52 offset:23552
    v_mfma_f32_32x32x16_bf16 v[80:95], a[164:167], a[0:3], v[80:95]
    ds_read_b64_tr_b16 a[188:189], v53 offset:22528
    ds_read_b64_tr_b16 a[190:191], v53 offset:23552
    buffer_load_dwordx4 a[0:3], v10, s[32:35], s96 offen offset:0 sc1
    s_add_u32 m0, s46, 50176
    s_add_u32 s3, s99, 10240
    buffer_load_dwordx4 v48, s[24:27], s3 offen lds
    s_waitcnt vmcnt(17) lgkmcnt(8)
    v_mfma_f32_32x32x16_bf16 v[64:79], a[168:171], a[4:7], v[64:79]
    ds_read_b64_tr_b16 a[160:161], v52 offset:24576
    ds_read_b64_tr_b16 a[162:163], v52 offset:25600
    v_mfma_f32_32x32x16_bf16 v[80:95], a[172:175], a[4:7], v[80:95]
    ds_read_b64_tr_b16 a[164:165], v53 offset:24576
    ds_read_b64_tr_b16 a[166:167], v53 offset:25600
    buffer_load_dwordx4 a[4:7], v10, s[32:35], s96 offen offset:1024 sc1
    s_waitcnt vmcnt(17) lgkmcnt(8)
    v_mfma_f32_32x32x16_bf16 v[64:79], a[176:179], a[8:11], v[64:79]
    ds_read_b64_tr_b16 a[168:169], v52 offset:26624
    ds_read_b64_tr_b16 a[170:171], v52 offset:27648
    v_mfma_f32_32x32x16_bf16 v[80:95], a[180:183], a[8:11], v[80:95]
    ds_read_b64_tr_b16 a[172:173], v53 offset:26624
    ds_read_b64_tr_b16 a[174:175], v53 offset:27648
    buffer_load_dwordx4 a[8:11], v10, s[32:35], s96 offen offset:2048 sc1
    s_add_u32 m0, s46, 51200
    s_add_u32 s101, s94, 1
    s_cmp_eq_u32 s101, 108
    s_cselect_b32 s101, 0, s101
    s_mul_i32 s99, s101, 20480
    s_mov_b32 s3, s99
    buffer_load_dwordx4 v48, s[24:27], s3 offen lds
    s_waitcnt vmcnt(17) lgkmcnt(8)
    v_mfma_f32_32x32x16_bf16 v[64:79], a[184:187], a[12:15], v[64:79]
    ds_read_b64_tr_b16 a[176:177], v52 offset:28672
    ds_read_b64_tr_b16 a[178:179], v52 offset:29696
    v_mfma_f32_32x32x16_bf16 v[80:95], a[188:191], a[12:15], v[80:95]
    ds_read_b64_tr_b16 a[180:181], v53 offset:28672
    ds_read_b64_tr_b16 a[182:183], v53 offset:29696
    buffer_load_dwordx4 a[12:15], v10, s[32:35], s96 offen offset:3072 sc1
    s_add_u32 s96, s96, 4096
    s_cmp_eq_u32 s96, s98
    s_cselect_b32 s96, s97, s96
    s_waitcnt vmcnt(17) lgkmcnt(8)
    v_mfma_f32_32x32x16_bf16 v[64:79], a[160:163], a[16:19], v[64:79]
    ds_read_b64_tr_b16 a[184:185], v52 offset:30720
    ds_read_b64_tr_b16 a[186:187], v52 offset:31744
    v_mfma_f32_32x32x16_bf16 v[80:95], a[164:167], a[16:19], v[80:95]
    ds_read_b64_tr_b16 a[188:189], v53 offset:30720
    ds_read_b64_tr_b16 a[190:191], v53 offset:31744
    buffer_load_dwordx4 a[16:19], v10, s[32:35], s96 offen offset:0 sc1
    s_add_u32 m0, s46, 52224
    s_add_u32 s3, s99, 10240
    buffer_load_dwordx4 v48, s[24:27], s3 offen lds
    s_add_u32 s94, s94, 8
    s_cmp_ge_u32 s94, 108
    s_cselect_b32 s3, 108, 0
    s_sub_u32 s94, s94, s3
    s_barrier
    s_waitcnt vmcnt(17) lgkmcnt(8)
    v_mfma_f32_32x32x16_bf16 v[64:79], a[168:171], a[20:23], v[64:79]
    ds_read_b64_tr_b16 a[160:161], v52 offset:32768
    ds_read_b64_tr_b16 a[162:163], v52 offset:33792
    v_mfma_f32_32x32x16_bf16 v[80:95], a[172:175], a[20:23], v[80:95]
    ds_read_b64_tr_b16 a[164:165], v53 offset:32768
    ds_read_b64_tr_b16 a[166:167], v53 offset:33792
    buffer_load_dwordx4 a[20:23], v10, s[32:35], s96 offen offset:1024 sc1
    s_waitcnt vmcnt(17) lgkmcnt(8)
    v_mfma_f32_32x32x16_bf16 v[64:79], a[176:179], a[24:27], v[64:79]
    ds_read_b64_tr_b16 a[168:169], v52 offset:34816
    ds_read_b64_tr_b16 a[170:171], v52 offset:35840
    v_mfma_f32_32x32x16_bf16 v[80:95], a[180:183], a[24:27], v[80:95]
    ds_read_b64_tr_b16 a[172:173], v53 offset:34816
    ds_read_b64_tr_b16 a[174:175], v53 offset:35840
    buffer_load_dwordx4 a[24:27], v10, s[32:35], s96 offen offset:2048 sc1
    s_add_u32 m0, s46, 65536
    s_mul_i32 s99, s94, 20480
    s_mov_b32 s3, s99
    buffer_load_dwordx4 v48, s[24:27], s3 offen lds
    s_waitcnt vmcnt(17) lgkmcnt(8)
    v_mfma_f32_32x32x16_bf16 v[64:79], a[184:187], a[28:31], v[64:79]
    ds_read_b64_tr_b16 a[176:177], v52 offset:36864
    ds_read_b64_tr_b16 a[178:179], v52 offset:37888
    v_mfma_f32_32x32x16_bf16 v[80:95], a[188:191], a[28:31], v[80:95]
    ds_read_b64_tr_b16 a[180:181], v53 offset:36864
    ds_read_b64_tr_b16 a[182:183], v53 offset:37888
    buffer_load_dwordx4 a[28:31], v10, s[32:35], s96 offen offset:3072 sc1
    s_add_u32 s96, s96, 4096
    s_cmp_eq_u32 s96, s98
    s_cselect_b32 s96, s97, s96
    s_waitcnt vmcnt(17) lgkmcnt(8)
    v_mfma_f32_32x32x16_bf16 v[64:79], a[160:163], a[32:35], v[64:79]
    ds_read_b64_tr_b16 a[184:185], v52 offset:38912
    ds_read_b64_tr_b16 a[186:187], v52 offset:39936
    v_mfma_f32_32x32x16_bf16 v[80:95], a[164:167], a[32:35], v[80:95]
    ds_read_b64_tr_b16 a[188:189], v53 offset:38912
    ds_read_b64_tr_b16 a[190:191], v53 offset:39936
    buffer_load_dwordx4 a[32:35], v10, s[32:35], s96 offen offset:0 sc1
    s_add_u32 m0, s46, 66560
    s_add_u32 s3, s99, 10240
    buffer_load_dwordx4 v48, s[24:27], s3 offen lds
    s_waitcnt vmcnt(17) lgkmcnt(8)
    v_mfma_f32_32x32x16_bf16 v[64:79], a[168:171], a[36:39], v[64:79]
    ds_read_b64_tr_b16 a[160:161], v52 offset:40960
    ds_read_b64_tr_b16 a[162:163], v52 offset:41984
    v_mfma_f32_32x32x16_bf16 v[80:95], a[172:175], a[36:39], v[80:95]
    ds_read_b64_tr_b16 a[164:165], v53 offset:40960
    ds_read_b64_tr_b16 a[166:167], v53 offset:41984
    buffer_load_dwordx4 a[36:39], v10, s[32:35], s96 offen offset:1024 sc1
    s_waitcnt vmcnt(17) lgkmcnt(8)
    v_mfma_f32_32x32x16_bf16 v[64:79], a[176:179], a[40:43], v[64:79]
    ds_read_b64_tr_b16 a[168:169], v52 offset:43008
    ds_read_b64_tr_b16 a[170:171], v52 offset:44032
    v_mfma_f32_32x32x16_bf16 v[80:95], a[180:183], a[40:43], v[80:95]
    ds_read_b64_tr_b16 a[172:173], v53 offset:43008
    ds_read_b64_tr_b16 a[174:175], v53 offset:44032
    buffer_load_dwordx4 a[40:43], v10, s[32:35], s96 offen offset:2048 sc1
    s_add_u32 m0, s46, 67584
    s_add_u32 s101, s94, 1
    s_cmp_eq_u32 s101, 108
    s_cselect_b32 s101, 0, s101
    s_mul_i32 s99, s101, 20480
    s_mov_b32 s3, s99
    buffer_load_dwordx4 v48, s[24:27], s3 offen lds
    s_waitcnt vmcnt(17) lgkmcnt(8)
    v_mfma_f32_32x32x16_bf16 v[64:79], a[184:187], a[44:47], v[64:79]
    ds_read_b64_tr_b16 a[176:177], v52 offset:45056
    ds_read_b64_tr_b16 a[178:179], v52 offset:46080
    v_mfma_f32_32x32x16_bf16 v[80:95], a[188:191], a[44:47], v[80:95]
    ds_read_b64_tr_b16 a[180:181], v53 offset:45056
    ds_read_b64_tr_b16 a[182:183], v53 offset:46080
    buffer_load_dwordx4 a[44:47], v10, s[32:35], s96 offen offset:3072 sc1
    s_add_u32 s96, s96, 4096
    s_cmp_eq_u32 s96, s98
    s_cselect_b32 s96, s97, s96
    s_waitcnt vmcnt(17) lgkmcnt(8)
    v_mfma_f32_32x32x16_bf16 v[64:79], a[160:163], a[0:3], v[64:79]
    ds_read_b64_tr_b16 a[184:185], v52 offset:47104
    ds_read_b64_tr_b16 a[186:187], v52 offset:48128
    v_mfma_f32_32x32x16_bf16 v[80:95], a[164:167], a[0:3], v[80:95]
    ds_read_b64_tr_b16 a[188:189], v53 offset:47104
    ds_read_b64_tr_b16 a[190:191], v53 offset:48128
    buffer_load_dwordx4 a[0:3], v10, s[32:35], s96 offen offset:0 sc1
    s_add_u32 m0, s46, 68608
    s_add_u32 s3, s99, 10240
    buffer_load_dwordx4 v48, s[24:27], s3 offen lds
    s_add_u32 s94, s94, 8
    s_cmp_ge_u32 s94, 108
    s_cselect_b32 s3, 108, 0
    s_sub_u32 s94, s94, s3
    s_barrier
    s_waitcnt vmcnt(17) lgkmcnt(8)
    v_mfma_f32_32x32x16_bf16 v[64:79], a[168:171], a[4:7], v[64:79]
    ds_read_b64_tr_b16 a[160:161], v52 offset:49152
    ds_read_b64_tr_b16 a[162:163], v52 offset:50176
    v_mfma_f32_32x32x16_bf16 v[80:95], a[172:175], a[4:7], v[80:95]
    ds_read_b64_tr_b16 a[164:165], v53 offset:49152
    ds_read_b64_tr_b16 a[166:167], v53 offset:50176
    buffer_load_dwordx4 a[4:7], v10, s[32:35], s96 offen offset:1024 sc1
    s_waitcnt vmcnt(17) lgkmcnt(8)
    v_mfma_f32_32x32x16_bf16 v[64:79], a[176:179], a[8:11], v[64:79]
    ds_read_b64_tr_b16 a[168:169], v52 offset:51200
    ds_read_b64_tr_b16 a[170:171], v52 offset:52224
    v_mfma_f32_32x32x16_bf16 v[80:95], a[180:183], a[8:11], v[80:95]
    ds_read_b64_tr_b16 a[172:173], v53 offset:51200
    ds_read_b64_tr_b16 a[174:175], v53 offset:52224
    buffer_load_dwordx4 a[8:11], v10, s[32:35], s96 offen offset:2048 sc1
    s_add_u32 m0, s46, 81920
    s_mul_i32 s99, s94, 20480
    s_mov_b32 s3, s99
    buffer_load_dwordx4 v48, s[24:27], s3 offen lds
    s_waitcnt vmcnt(17) lgkmcnt(8)
    v_mfma_f32_32x32x16_bf16 v[64:79], a[184:187], a[12:15], v[64:79]
    ds_read_b64_tr_b16 a[176:177], v52 offset:53248
    ds_read_b64_tr_b16 a[178:179], v52 offset:54272
    v_mfma_f32_32x32x16_bf16 v[80:95], a[188:191], a[12:15], v[80:95]
    ds_read_b64_tr_b16 a[180:181], v53 offset:53248
    ds_read_b64_tr_b16 a[182:183], v53 offset:54272
    buffer_load_dwordx4 a[12:15], v10, s[32:35], s96 offen offset:3072 sc1
    s_add_u32 s96, s96, 4096
    s_cmp_eq_u32 s96, s98
    s_cselect_b32 s96, s97, s96
    s_waitcnt vmcnt(17) lgkmcnt(8)
    v_mfma_f32_32x32x16_bf16 v[64:79], a[160:163], a[16:19], v[64:79]
    ds_read_b64_tr_b16 a[184:185], v52 offset:55296
    ds_read_b64_tr_b16 a[186:187], v52 offset:56320
    v_mfma_f32_32x32x16_bf16 v[80:95], a[164:167], a[16:19], v[80:95]
    ds_read_b64_tr_b16 a[188:189], v53 offset:55296
    ds_read_b64_tr_b16 a[190:191], v53 offset:56320
    buffer_load_dwordx4 a[16:19], v10, s[32:35], s96 offen offset:0 sc1
    s_add_u32 m0, s46, 82944
    s_add_u32 s3, s99, 10240
    buffer_load_dwordx4 v48, s[24:27], s3 offen lds
    s_waitcnt vmcnt(17) lgkmcnt(8)
    v_mfma_f32_32x32x16_bf16 v[64:79], a[168:171], a[20:23], v[64:79]
    ds_read_b64_tr_b16 a[160:161], v52 offset:57344
    ds_read_b64_tr_b16 a[162:163], v52 offset:58368
    v_mfma_f32_32x32x16_bf16 v[80:95], a[172:175], a[20:23], v[80:95]
    ds_read_b64_tr_b16 a[164:165], v53 offset:57344
    ds_read_b64_tr_b16 a[166:167], v53 offset:58368
    buffer_load_dwordx4 a[20:23], v10, s[32:35], s96 offen offset:1024 sc1
    s_waitcnt vmcnt(17) lgkmcnt(8)
    v_mfma_f32_32x32x16_bf16 v[64:79], a[176:179], a[24:27], v[64:79]
    ds_read_b64_tr_b16 a[168:169], v52 offset:59392
    ds_read_b64_tr_b16 a[170:171], v52 offset:60416
    v_mfma_f32_32x32x16_bf16 v[80:95], a[180:183], a[24:27], v[80:95]
    ds_read_b64_tr_b16 a[172:173], v53 offset:59392
    ds_read_b64_tr_b16 a[174:175], v53 offset:60416
    buffer_load_dwordx4 a[24:27], v10, s[32:35], s96 offen offset:2048 sc1
    s_add_u32 m0, s46, 83968
    s_add_u32 s101, s94, 1
    s_cmp_eq_u32 s101, 108
    s_cselect_b32 s101, 0, s101
    s_mul_i32 s99, s101, 20480
    s_mov_b32 s3, s99
    buffer_load_dwordx4 v48, s[24:27], s3 offen lds
    s_waitcnt vmcnt(17) lgkmcnt(8)
    v_mfma_f32_32x32x16_bf16 v[64:79], a[184:187], a[28:31], v[64:79]
    ds_read_b64_tr_b16 a[176:177], v52 offset:61440
    ds_read_b64_tr_b16 a[178:179], v52 offset:62464
    v_mfma_f32_32x32x16_bf16 v[80:95], a[188:191], a[28:31], v[80:95]
    ds_read_b64_tr_b16 a[180:181], v53 offset:61440
    ds_read_b64_tr_b16 a[182:183], v53 offset:62464
    buffer_load_dwordx4 a[28:31], v10, s[32:35], s96 offen offset:3072 sc1
    s_add_u32 s96, s96, 4096
    s_cmp_eq_u32 s96, s98
    s_cselect_b32 s96, s97, s96
    s_waitcnt vmcnt(17) lgkmcnt(8)
    v_mfma_f32_32x32x16_bf16 v[64:79], a[160:163], a[32:35], v[64:79]
    ds_read_b64_tr_b16 a[184:185], v52 offset:63488
    ds_read_b64_tr_b16 a[186:187], v52 offset:64512
    v_mfma_f32_32x32x16_bf16 v[80:95], a[164:167], a[32:35], v[80:95]
    ds_read_b64_tr_b16 a[188:189], v53 offset:63488
    ds_read_b64_tr_b16 a[190:191], v53 offset:64512
    buffer_load_dwordx4 a[32:35], v10, s[32:35], s96 offen offset:0 sc1
    s_add_u32 m0, s46, 84992
    s_add_u32 s3, s99, 10240
    buffer_load_dwordx4 v48, s[24:27], s3 offen lds
    s_add_u32 s94, s94, 8
    s_cmp_ge_u32 s94, 108
    s_cselect_b32 s3, 108, 0
    s_sub_u32 s94, s94, s3
    s_barrier
    s_waitcnt vmcnt(17) lgkmcnt(8)
    v_mfma_f32_32x32x16_bf16 v[64:79], a[168:171], a[36:39], v[64:79]
    ds_read_b64_tr_b16 a[160:161], v50 offset:0
    ds_read_b64_tr_b16 a[162:163], v50 offset:1024
    v_mfma_f32_32x32x16_bf16 v[80:95], a[172:175], a[36:39], v[80:95]
    ds_read_b64_tr_b16 a[164:165], v51 offset:0
    ds_read_b64_tr_b16 a[166:167], v51 offset:1024
    buffer_load_dwordx4 a[36:39], v10, s[32:35], s96 offen offset:1024 sc1
    s_waitcnt vmcnt(17) lgkmcnt(8)
    v_mfma_f32_32x32x16_bf16 v[64:79], a[176:179], a[40:43], v[64:79]
    ds_read_b64_tr_b16 a[168:169], v50 offset:2048
    ds_read_b64_tr_b16 a[170:171], v50 offset:3072
    v_mfma_f32_32x32x16_bf16 v[80:95], a[180:183], a[40:43], v[80:95]
    ds_read_b64_tr_b16 a[172:173], v51 offset:2048
    ds_read_b64_tr_b16 a[174:175], v51 offset:3072
    buffer_load_dwordx4 a[40:43], v10, s[32:35], s96 offen offset:2048 sc1
    s_add_u32 m0, s46, 98304
    s_mul_i32 s99, s94, 20480
    s_mov_b32 s3, s99
    buffer_load_dwordx4 v48, s[24:27], s3 offen lds
    s_waitcnt vmcnt(17) lgkmcnt(8)
    v_mfma_f32_32x32x16_bf16 v[64:79], a[184:187], a[44:47], v[64:79]
    ds_read_b64_tr_b16 a[176:177], v50 offset:4096
    ds_read_b64_tr_b16 a[178:179], v50 offset:5120
    v_mfma_f32_32x32x16_bf16 v[80:95], a[188:191], a[44:47], v[80:95]
    ds_read_b64_tr_b16 a[180:181], v51 offset:4096
    ds_read_b64_tr_b16 a[182:183], v51 offset:5120
    buffer_load_dwordx4 a[44:47], v10, s[32:35], s96 offen offset:3072 sc1
    s_add_u32 s96, s96, 4096
    s_cmp_eq_u32 s96, s98
    s_cselect_b32 s96, s97, s96
    s_waitcnt vmcnt(17) lgkmcnt(8)
    v_mfma_f32_32x32x16_bf16 v[64:79], a[160:163], a[0:3], v[64:79]
    ds_read_b64_tr_b16 a[184:185], v50 offset:6144
    ds_read_b64_tr_b16 a[186:187], v50 offset:7168
    v_mfma_f32_32x32x16_bf16 v[80:95], a[164:167], a[0:3], v[80:95]
    ds_read_b64_tr_b16 a[188:189], v51 offset:6144
    ds_read_b64_tr_b16 a[190:191], v51 offset:7168
    buffer_load_dwordx4 a[0:3], v10, s[32:35], s96 offen offset:0 sc1
    s_add_u32 m0, s46, 99328
    s_add_u32 s3, s99, 10240
    buffer_load_dwordx4 v48, s[24:27], s3 offen lds
    s_waitcnt vmcnt(17) lgkmcnt(8)
    v_mfma_f32_32x32x16_bf16 v[64:79], a[168:171], a[4:7], v[64:79]
    ds_read_b64_tr_b16 a[160:161], v50 offset:8192
    ds_read_b64_tr_b16 a[162:163], v50 offset:9216
    v_mfma_f32_32x32x16_bf16 v[80:95], a[172:175], a[4:7], v[80:95]
    ds_read_b64_tr_b16 a[164:165], v51 offset:8192
    ds_read_b64_tr_b16 a[166:167], v51 offset:9216
    buffer_load_dwordx4 a[4:7], v10, s[32:35], s96 offen offset:1024 sc1
    s_waitcnt vmcnt(17) lgkmcnt(8)
    v_mfma_f32_32x32x16_bf16 v[64:79], a[176:179], a[8:11], v[64:79]
    ds_read_b64_tr_b16 a[168:169], v50 offset:10240
    ds_read_b64_tr_b16 a[170:171], v50 offset:11264
    v_mfma_f32_32x32x16_bf16 v[80:95], a[180:183], a[8:11], v[80:95]
    ds_read_b64_tr_b16 a[172:173], v51 offset:10240
    ds_read_b64_tr_b16 a[174:175], v51 offset:11264
    buffer_load_dwordx4 a[8:11], v10, s[32:35], s96 offen offset:2048 sc1
    s_add_u32 m0, s46, 100352
    s_add_u32 s101, s94, 1
    s_cmp_eq_u32 s101, 108
    s_cselect_b32 s101, 0, s101
    s_mul_i32 s99, s101, 20480
    s_mov_b32 s3, s99
    buffer_load_dwordx4 v48, s[24:27], s3 offen lds
    s_waitcnt vmcnt(17) lgkmcnt(8)
    v_mfma_f32_32x32x16_bf16 v[64:79], a[184:187], a[12:15], v[64:79]
    ds_read_b64_tr_b16 a[176:177], v50 offset:12288
    ds_read_b64_tr_b16 a[178:179], v50 offset:13312
    v_mfma_f32_32x32x16_bf16 v[80:95], a[188:191], a[12:15], v[80:95]
    ds_read_b64_tr_b16 a[180:181], v51 offset:12288
    ds_read_b64_tr_b16 a[182:183], v51 offset:13312
    buffer_load_dwordx4 a[12:15], v10, s[32:35], s96 offen offset:3072 sc1
    s_add_u32 s96, s96, 4096
    s_cmp_eq_u32 s96, s98
    s_cselect_b32 s96, s97, s96
    s_waitcnt vmcnt(17) lgkmcnt(8)
    v_mfma_f32_32x32x16_bf16 v[64:79], a[160:163], a[16:19], v[64:79]
    ds_read_b64_tr_b16 a[184:185], v50 offset:14336
    ds_read_b64_tr_b16 a[186:187], v50 offset:15360
    v_mfma_f32_32x32x16_bf16 v[80:95], a[164:167], a[16:19], v[80:95]
    ds_read_b64_tr_b16 a[188:189], v51 offset:14336
    ds_read_b64_tr_b16 a[190:191], v51 offset:15360
    buffer_load_dwordx4 a[16:19], v10, s[32:35], s96 offen offset:0 sc1
    s_add_u32 m0, s46, 101376
    s_add_u32 s3, s99, 10240
    buffer_load_dwordx4 v48, s[24:27], s3 offen lds
    s_add_u32 s94, s94, 8
    s_cmp_ge_u32 s94, 108
    s_cselect_b32 s3, 108, 0
    s_sub_u32 s94, s94, s3
    s_barrier
    s_waitcnt vmcnt(17) lgkmcnt(8)
    v_mfma_f32_32x32x16_bf16 v[64:79], a[168:171], a[20:23], v[64:79]
    ds_read_b64_tr_b16 a[160:161], v50 offset:16384
    ds_read_b64_tr_b16 a[162:163], v50 offset:17408
    v_mfma_f32_32x32x16_bf16 v[80:95], a[172:175], a[20:23], v[80:95]
    ds_read_b64_tr_b16 a[164:165], v51 offset:16384
    ds_read_b64_tr_b16 a[166:167], v51 offset:17408
    buffer_load_dwordx4 a[20:23], v10, s[32:35], s96 offen offset:1024 sc1
    s_waitcnt vmcnt(17) lgkmcnt(8)
    v_mfma_f32_32x32x16_bf16 v[64:79], a[176:179], a[24:27], v[64:79]
    ds_read_b64_tr_b16 a[168:169], v50 offset:18432
    ds_read_b64_tr_b16 a[170:171], v50 offset:19456
    v_mfma_f32_32x32x16_bf16 v[80:95], a[180:183], a[24:27], v[80:95]
    ds_read_b64_tr_b16 a[172:173], v51 offset:18432
    ds_read_b64_tr_b16 a[174:175], v51 offset:19456
    buffer_load_dwordx4 a[24:27], v10, s[32:35], s96 offen offset:2048 sc1
    s_add_u32 m0, s46, 114688
    s_mul_i32 s99, s94, 20480
    s_mov_b32 s3, s99
    buffer_load_dwordx4 v48, s[24:27], s3 offen lds
    s_waitcnt vmcnt(17) lgkmcnt(8)
    v_mfma_f32_32x32x16_bf16 v[64:79], a[184:187], a[28:31], v[64:79]
    ds_read_b64_tr_b16 a[176:177], v50 offset:20480
    ds_read_b64_tr_b16 a[178:179], v50 offset:21504
    v_mfma_f32_32x32x16_bf16 v[80:95], a[188:191], a[28:31], v[80:95]
    ds_read_b64_tr_b16 a[180:181], v51 offset:20480
    ds_read_b64_tr_b16 a[182:183], v51 offset:21504
    buffer_load_dwordx4 a[28:31], v10, s[32:35], s96 offen offset:3072 sc1
    s_add_u32 s96, s96, 4096
    s_cmp_eq_u32 s96, s98
    s_cselect_b32 s96, s97, s96
    s_waitcnt vmcnt(17) lgkmcnt(8)
    v_mfma_f32_32x32x16_bf16 v[64:79], a[160:163], a[32:35], v[64:79]
    ds_read_b64_tr_b16 a[184:185], v50 offset:22528
    ds_read_b64_tr_b16 a[186:187], v50 offset:23552
    v_mfma_f32_32x32x16_bf16 v[80:95], a[164:167], a[32:35], v[80:95]
    ds_read_b64_tr_b16 a[188:189], v51 offset:22528
    ds_read_b64_tr_b16 a[190:191], v51 offset:23552
    buffer_load_dwordx4 a[32:35], v10, s[32:35], s96 offen offset:0 sc1
    s_add_u32 m0, s46, 115712
    s_add_u32 s3, s99, 10240
    buffer_load_dwordx4 v48, s[24:27], s3 offen lds
    s_waitcnt vmcnt(17) lgkmcnt(8)
    v_mfma_f32_32x32x16_bf16 v[64:79], a[168:171], a[36:39], v[64:79]
    ds_read_b64_tr_b16 a[160:161], v50 offset:24576
    ds_read_b64_tr_b16 a[162:163], v50 offset:25600
    v_mfma_f32_32x32x16_bf16 v[80:95], a[172:175], a[36:39], v[80:95]
    ds_read_b64_tr_b16 a[164:165], v51 offset:24576
    ds_read_b64_tr_b16 a[166:167], v51 offset:25600
    buffer_load_dwordx4 a[36:39], v10, s[32:35], s96 offen offset:1024 sc1
    s_waitcnt vmcnt(17) lgkmcnt(8)
    v_mfma_f32_32x32x16_bf16 v[64:79], a[176:179], a[40:43], v[64:79]
    ds_read_b64_tr_b16 a[168:169], v50 offset:26624
    ds_read_b64_tr_b16 a[170:171], v50 offset:27648
    v_mfma_f32_32x32x16_bf16 v[80:95], a[180:183], a[40:43], v[80:95]
    ds_read_b64_tr_b16 a[172:173], v51 offset:26624
    ds_read_b64_tr_b16 a[174:175], v51 offset:27648
    buffer_load_dwordx4 a[40:43], v10, s[32:35], s96 offen offset:2048 sc1
    s_add_u32 m0, s46, 116736
    s_add_u32 s101, s94, 1
    s_cmp_eq_u32 s101, 108
    s_cselect_b32 s101, 0, s101
    s_mul_i32 s99, s101, 20480
    s_mov_b32 s3, s99
    buffer_load_dwordx4 v48, s[24:27], s3 offen lds
    s_waitcnt vmcnt(17) lgkmcnt(8)
    v_mfma_f32_32x32x16_bf16 v[64:79], a[184:187], a[44:47], v[64:79]
    ds_read_b64_tr_b16 a[176:177], v50 offset:28672
    ds_read_b64_tr_b16 a[178:179], v50 offset:29696
    v_mfma_f32_32x32x16_bf16 v[80:95], a[188:191], a[44:47], v[80:95]
    ds_read_b64_tr_b16 a[180:181], v51 offset:28672
    ds_read_b64_tr_b16 a[182:183], v51 offset:29696
    buffer_load_dwordx4 a[44:47], v10, s[32:35], s96 offen offset:3072 sc1
    s_add_u32 s96, s96, 4096
    s_cmp_eq_u32 s96, s98
    s_cselect_b32 s96, s97, s96
    s_waitcnt vmcnt(17) lgkmcnt(8)
    v_mfma_f32_32x32x16_bf16 v[64:79], a[160:163], a[0:3], v[64:79]
    ds_read_b64_tr_b16 a[184:185], v50 offset:30720
    ds_read_b64_tr_b16 a[186:187], v50 offset:31744
    v_mfma_f32_32x32x16_bf16 v[80:95], a[164:167], a[0:3], v[80:95]
    ds_read_b64_tr_b16 a[188:189], v51 offset:30720
    ds_read_b64_tr_b16 a[190:191], v51 offset:31744
    buffer_load_dwordx4 a[0:3], v10, s[32:35], s96 offen offset:0 sc1
    s_add_u32 m0, s46, 117760
    s_add_u32 s3, s99, 10240
    buffer_load_dwordx4 v48, s[24:27], s3 offen lds
    s_add_u32 s94, s94, 8
    s_cmp_ge_u32 s94, 108
    s_cselect_b32 s3, 108, 0
    s_sub_u32 s94, s94, s3
    s_barrier
    s_waitcnt vmcnt(17) lgkmcnt(8)
    v_mfma_f32_32x32x16_bf16 v[64:79], a[168:171], a[4:7], v[64:79]
    ds_read_b64_tr_b16 a[160:161], v50 offset:32768
    ds_read_b64_tr_b16 a[162:163], v50 offset:33792
    v_mfma_f32_32x32x16_bf16 v[80:95], a[172:175], a[4:7], v[80:95]
    ds_read_b64_tr_b16 a[164:165], v51 offset:32768
    ds_read_b64_tr_b16 a[166:167], v51 offset:33792
    buffer_load_dwordx4 a[4:7], v10, s[32:35], s96 offen offset:1024 sc1
    s_waitcnt vmcnt(17) lgkmcnt(8)
    v_mfma_f32_32x32x16_bf16 v[64:79], a[176:179], a[8:11], v[64:79]
    ds_read_b64_tr_b16 a[168:169], v50 offset:34816
    ds_read_b64_tr_b16 a[170:171], v50 offset:35840
    v_mfma_f32_32x32x16_bf16 v[80:95], a[180:183], a[8:11], v[80:95]
    ds_read_b64_tr_b16 a[172:173], v51 offset:34816
    ds_read_b64_tr_b16 a[174:175], v51 offset:35840
    buffer_load_dwordx4 a[8:11], v10, s[32:35], s96 offen offset:2048 sc1
    s_waitcnt vmcnt(16) lgkmcnt(8)
    v_mfma_f32_32x32x16_bf16 v[64:79], a[184:187], a[12:15], v[64:79]
    ds_read_b64_tr_b16 a[176:177], v50 offset:36864
    ds_read_b64_tr_b16 a[178:179], v50 offset:37888
    v_mfma_f32_32x32x16_bf16 v[80:95], a[188:191], a[12:15], v[80:95]
    ds_read_b64_tr_b16 a[180:181], v51 offset:36864
    ds_read_b64_tr_b16 a[182:183], v51 offset:37888
    buffer_load_dwordx4 a[12:15], v10, s[32:35], s96 offen offset:3072 sc1
    s_add_u32 s96, s96, 4096
    s_cmp_eq_u32 s96, s98
    s_cselect_b32 s96, s97, s96
    s_waitcnt vmcnt(16) lgkmcnt(8)
    v_mfma_f32_32x32x16_bf16 v[64:79], a[160:163], a[16:19], v[64:79]
    ds_read_b64_tr_b16 a[184:185], v50 offset:38912
    ds_read_b64_tr_b16 a[186:187], v50 offset:39936
    v_mfma_f32_32x32x16_bf16 v[80:95], a[164:167], a[16:19], v[80:95]
    ds_read_b64_tr_b16 a[188:189], v51 offset:38912
    ds_read_b64_tr_b16 a[190:191], v51 offset:39936
    buffer_load_dwordx4 a[16:19], v10, s[32:35], s96 offen offset:0 sc1
    s_waitcnt vmcnt(15) lgkmcnt(8)
    v_mfma_f32_32x32x16_bf16 v[64:79], a[168:171], a[20:23], v[64:79]
    ds_read_b64_tr_b16 a[160:161], v50 offset:40960
    ds_read_b64_tr_b16 a[162:163], v50 offset:41984
    v_mfma_f32_32x32x16_bf16 v[80:95], a[172:175], a[20:23], v[80:95]
    ds_read_b64_tr_b16 a[164:165], v51 offset:40960
    ds_read_b64_tr_b16 a[166:167], v51 offset:41984
    buffer_load_dwordx4 a[20:23], v10, s[32:35], s96 offen offset:1024 sc1
    s_waitcnt vmcnt(15) lgkmcnt(8)
    v_mfma_f32_32x32x16_bf16 v[64:79], a[176:179], a[24:27], v[64:79]
    ds_read_b64_tr_b16 a[168:169], v50 offset:43008
    ds_read_b64_tr_b16 a[170:171], v50 offset:44032
    v_mfma_f32_32x32x16_bf16 v[80:95], a[180:183], a[24:27], v[80:95]
    ds_read_b64_tr_b16 a[172:173], v51 offset:43008
    ds_read_b64_tr_b16 a[174:175], v51 offset:44032
    buffer_load_dwordx4 a[24:27], v10, s[32:35], s96 offen offset:2048 sc1
    s_waitcnt vmcnt(14) lgkmcnt(8)
    v_mfma_f32_32x32x16_bf16 v[64:79], a[184:187], a[28:31], v[64:79]
    ds_read_b64_tr_b16 a[176:177], v50 offset:45056
    ds_read_b64_tr_b16 a[178:179], v50 offset:46080
    v_mfma_f32_32x32x16_bf16 v[80:95], a[188:191], a[28:31], v[80:95]
    ds_read_b64_tr_b16 a[180:181], v51 offset:45056
    ds_read_b64_tr_b16 a[182:183], v51 offset:46080
    buffer_load_dwordx4 a[28:31], v10, s[32:35], s96 offen offset:3072 sc1
    s_add_u32 s96, s96, 4096
    s_cmp_eq_u32 s96, s98
    s_cselect_b32 s96, s97, s96
    s_waitcnt vmcnt(14) lgkmcnt(8)
    v_mfma_f32_32x32x16_bf16 v[64:79], a[160:163], a[32:35], v[64:79]
    ds_read_b64_tr_b16 a[184:185], v50 offset:47104
    ds_read_b64_tr_b16 a[186:187], v50 offset:48128
    v_mfma_f32_32x32x16_bf16 v[80:95], a[164:167], a[32:35], v[80:95]
    ds_read_b64_tr_b16 a[188:189], v51 offset:47104
    ds_read_b64_tr_b16 a[190:191], v51 offset:48128
    buffer_load_dwordx4 a[32:35], v10, s[32:35], s96 offen offset:0 sc1
    s_barrier
    s_waitcnt vmcnt(13) lgkmcnt(8)
    v_mfma_f32_32x32x16_bf16 v[64:79], a[168:171], a[36:39], v[64:79]
    ds_read_b64_tr_b16 a[160:161], v50 offset:49152
    ds_read_b64_tr_b16 a[162:163], v50 offset:50176
    v_mfma_f32_32x32x16_bf16 v[80:95], a[172:175], a[36:39], v[80:95]
    ds_read_b64_tr_b16 a[164:165], v51 offset:49152
    ds_read_b64_tr_b16 a[166:167], v51 offset:50176
    buffer_load_dwordx4 a[36:39], v10, s[32:35], s96 offen offset:1024 sc1
    s_waitcnt vmcnt(13) lgkmcnt(8)
    v_mfma_f32_32x32x16_bf16 v[64:79], a[176:179], a[40:43], v[64:79]
    ds_read_b64_tr_b16 a[168:169], v50 offset:51200
    ds_read_b64_tr_b16 a[170:171], v50 offset:52224
    v_mfma_f32_32x32x16_bf16 v[80:95], a[180:183], a[40:43], v[80:95]
    ds_read_b64_tr_b16 a[172:173], v51 offset:51200
    ds_read_b64_tr_b16 a[174:175], v51 offset:52224
    buffer_load_dwordx4 a[40:43], v10, s[32:35], s96 offen offset:2048 sc1
    s_waitcnt vmcnt(12) lgkmcnt(8)
    v_mfma_f32_32x32x16_bf16 v[64:79], a[184:187], a[44:47], v[64:79]
    ds_read_b64_tr_b16 a[176:177], v50 offset:53248
    ds_read_b64_tr_b16 a[178:179], v50 offset:54272
    v_mfma_f32_32x32x16_bf16 v[80:95], a[188:191], a[44:47], v[80:95]
    ds_read_b64_tr_b16 a[180:181], v51 offset:53248
    ds_read_b64_tr_b16 a[182:183], v51 offset:54272
    buffer_load_dwordx4 a[44:47], v10, s[32:35], s96 offen offset:3072 sc1
    s_add_u32 s96, s96, 4096
    s_cmp_eq_u32 s96, s98
    s_cselect_b32 s96, s97, s96
    s_waitcnt vmcnt(12) lgkmcnt(8)
    v_mfma_f32_32x32x16_bf16 v[64:79], a[160:163], a[0:3], v[64:79]
    ds_read_b64_tr_b16 a[184:185], v50 offset:55296
    ds_read_b64_tr_b16 a[186:187], v50 offset:56320
    v_mfma_f32_32x32x16_bf16 v[80:95], a[164:167], a[0:3], v[80:95]
    ds_read_b64_tr_b16 a[188:189], v51 offset:55296
    ds_read_b64_tr_b16 a[190:191], v51 offset:56320
    buffer_load_dwordx4 a[0:3], v10, s[32:35], s96 offen offset:0 sc1
    s_waitcnt vmcnt(11) lgkmcnt(8)
    v_mfma_f32_32x32x16_bf16 v[64:79], a[168:171], a[4:7], v[64:79]
    ds_read_b64_tr_b16 a[160:161], v50 offset:57344
    ds_read_b64_tr_b16 a[162:163], v50 offset:58368
    v_mfma_f32_32x32x16_bf16 v[80:95], a[172:175], a[4:7], v[80:95]
    ds_read_b64_tr_b16 a[164:165], v51 offset:57344
    ds_read_b64_tr_b16 a[166:167], v51 offset:58368
    buffer_load_dwordx4 a[4:7], v10, s[32:35], s96 offen offset:1024 sc1
    s_waitcnt vmcnt(11) lgkmcnt(8)
    v_mfma_f32_32x32x16_bf16 v[64:79], a[176:179], a[8:11], v[64:79]
    ds_read_b64_tr_b16 a[168:169], v50 offset:59392
    ds_read_b64_tr_b16 a[170:171], v50 offset:60416
    v_mfma_f32_32x32x16_bf16 v[80:95], a[180:183], a[8:11], v[80:95]
    ds_read_b64_tr_b16 a[172:173], v51 offset:59392
    ds_read_b64_tr_b16 a[174:175], v51 offset:60416
    buffer_load_dwordx4 a[8:11], v10, s[32:35], s96 offen offset:2048 sc1
    s_waitcnt vmcnt(11) lgkmcnt(8)
    v_mfma_f32_32x32x16_bf16 v[64:79], a[184:187], a[12:15], v[64:79]
    ds_read_b64_tr_b16 a[176:177], v50 offset:61440
    ds_read_b64_tr_b16 a[178:179], v50 offset:62464
    v_mfma_f32_32x32x16_bf16 v[80:95], a[188:191], a[12:15], v[80:95]
    ds_read_b64_tr_b16 a[180:181], v51 offset:61440
    ds_read_b64_tr_b16 a[182:183], v51 offset:62464
    buffer_load_dwordx4 a[12:15], v10, s[32:35], s96 offen offset:3072 sc1
    s_add_u32 s96, s96, 4096
    s_cmp_eq_u32 s96, s98
    s_cselect_b32 s96, s97, s96
    s_waitcnt vmcnt(11) lgkmcnt(8)
    v_mfma_f32_32x32x16_bf16 v[64:79], a[160:163], a[16:19], v[64:79]
    ds_read_b64_tr_b16 a[184:185], v50 offset:63488
    ds_read_b64_tr_b16 a[186:187], v50 offset:64512
    v_mfma_f32_32x32x16_bf16 v[80:95], a[164:167], a[16:19], v[80:95]
    ds_read_b64_tr_b16 a[188:189], v51 offset:63488
    ds_read_b64_tr_b16 a[190:191], v51 offset:64512
    buffer_load_dwordx4 a[16:19], v10, s[32:35], s96 offen offset:0 sc1
    s_barrier
    s_waitcnt vmcnt(11) lgkmcnt(8)
    v_mfma_f32_32x32x16_bf16 v[64:79], a[168:171], a[20:23], v[64:79]
    ds_read_b64_tr_b16 a[160:161], v52 offset:0
    ds_read_b64_tr_b16 a[162:163], v52 offset:1024
    v_mfma_f32_32x32x16_bf16 v[80:95], a[172:175], a[20:23], v[80:95]
    ds_read_b64_tr_b16 a[164:165], v53 offset:0
    ds_read_b64_tr_b16 a[166:167], v53 offset:1024
    buffer_load_dwordx4 a[20:23], v10, s[32:35], s96 offen offset:1024 sc1
    s_waitcnt vmcnt(11) lgkmcnt(8)
    v_mfma_f32_32x32x16_bf16 v[64:79], a[176:179], a[24:27], v[64:79]
    ds_read_b64_tr_b16 a[168:169], v52 offset:2048
    ds_read_b64_tr_b16 a[170:171], v52 offset:3072
    v_mfma_f32_32x32x16_bf16 v[80:95], a[180:183], a[24:27], v[80:95]
    ds_read_b64_tr_b16 a[172:173], v53 offset:2048
    ds_read_b64_tr_b16 a[174:175], v53 offset:3072
    buffer_load_dwordx4 a[24:27], v10, s[32:35], s96 offen offset:2048 sc1
    s_waitcnt vmcnt(11) lgkmcnt(8)
    v_mfma_f32_32x32x16_bf16 v[64:79], a[184:187], a[28:31], v[64:79]
    ds_read_b64_tr_b16 a[176:177], v52 offset:4096
    ds_read_b64_tr_b16 a[178:179], v52 offset:5120
    v_mfma_f32_32x32x16_bf16 v[80:95], a[188:191], a[28:31], v[80:95]
    ds_read_b64_tr_b16 a[180:181], v53 offset:4096
    ds_read_b64_tr_b16 a[182:183], v53 offset:5120
    buffer_load_dwordx4 a[28:31], v10, s[32:35], s96 offen offset:3072 sc1
    s_add_u32 s96, s96, 4096
    s_cmp_eq_u32 s96, s98
    s_cselect_b32 s96, s97, s96
    s_waitcnt vmcnt(11) lgkmcnt(8)
    v_mfma_f32_32x32x16_bf16 v[64:79], a[160:163], a[32:35], v[64:79]
    ds_read_b64_tr_b16 a[184:185], v52 offset:6144
    ds_read_b64_tr_b16 a[186:187], v52 offset:7168
    v_mfma_f32_32x32x16_bf16 v[80:95], a[164:167], a[32:35], v[80:95]
    ds_read_b64_tr_b16 a[188:189], v53 offset:6144
    ds_read_b64_tr_b16 a[190:191], v53 offset:7168
    buffer_load_dwordx4 a[32:35], v10, s[32:35], s96 offen offset:0 sc1
    s_waitcnt vmcnt(11) lgkmcnt(8)
    v_mfma_f32_32x32x16_bf16 v[64:79], a[168:171], a[36:39], v[64:79]
    ds_read_b64_tr_b16 a[160:161], v52 offset:8192
    ds_read_b64_tr_b16 a[162:163], v52 offset:9216
    v_mfma_f32_32x32x16_bf16 v[80:95], a[172:175], a[36:39], v[80:95]
    ds_read_b64_tr_b16 a[164:165], v53 offset:8192
    ds_read_b64_tr_b16 a[166:167], v53 offset:9216
    buffer_load_dwordx4 a[36:39], v10, s[32:35], s96 offen offset:1024 sc1
    s_waitcnt vmcnt(11) lgkmcnt(8)
    v_mfma_f32_32x32x16_bf16 v[64:79], a[176:179], a[40:43], v[64:79]
    ds_read_b64_tr_b16 a[168:169], v52 offset:10240
    ds_read_b64_tr_b16 a[170:171], v52 offset:11264
    v_mfma_f32_32x32x16_bf16 v[80:95], a[180:183], a[40:43], v[80:95]
    ds_read_b64_tr_b16 a[172:173], v53 offset:10240
    ds_read_b64_tr_b16 a[174:175], v53 offset:11264
    buffer_load_dwordx4 a[40:43], v10, s[32:35], s96 offen offset:2048 sc1
    s_waitcnt vmcnt(11) lgkmcnt(8)
    v_mfma_f32_32x32x16_bf16 v[64:79], a[184:187], a[44:47], v[64:79]
    ds_read_b64_tr_b16 a[176:177], v52 offset:12288
    ds_read_b64_tr_b16 a[178:179], v52 offset:13312
    v_mfma_f32_32x32x16_bf16 v[80:95], a[188:191], a[44:47], v[80:95]
    ds_read_b64_tr_b16 a[180:181], v53 offset:12288
    ds_read_b64_tr_b16 a[182:183], v53 offset:13312
    buffer_load_dwordx4 a[44:47], v10, s[32:35], s96 offen offset:3072 sc1
    s_add_u32 s96, s96, 4096
    s_cmp_eq_u32 s96, s98
    s_cselect_b32 s96, s97, s96
    s_waitcnt vmcnt(11) lgkmcnt(8)
    v_mfma_f32_32x32x16_bf16 v[64:79], a[160:163], a[0:3], v[64:79]
    ds_read_b64_tr_b16 a[184:185], v52 offset:14336
    ds_read_b64_tr_b16 a[186:187], v52 offset:15360
    v_mfma_f32_32x32x16_bf16 v[80:95], a[164:167], a[0:3], v[80:95]
    ds_read_b64_tr_b16 a[188:189], v53 offset:14336
    ds_read_b64_tr_b16 a[190:191], v53 offset:15360
    buffer_load_dwordx4 a[0:3], v10, s[32:35], s96 offen offset:0 sc1
    s_barrier
    s_waitcnt vmcnt(11) lgkmcnt(8)
    v_mfma_f32_32x32x16_bf16 v[64:79], a[168:171], a[4:7], v[64:79]
    ds_read_b64_tr_b16 a[160:161], v52 offset:16384
    ds_read_b64_tr_b16 a[162:163], v52 offset:17408
    v_mfma_f32_32x32x16_bf16 v[80:95], a[172:175], a[4:7], v[80:95]
    ds_read_b64_tr_b16 a[164:165], v53 offset:16384
    ds_read_b64_tr_b16 a[166:167], v53 offset:17408
    buffer_load_dwordx4 a[4:7], v10, s[32:35], s96 offen offset:1024 sc1
    s_waitcnt vmcnt(11) lgkmcnt(8)
    v_mfma_f32_32x32x16_bf16 v[64:79], a[176:179], a[8:11], v[64:79]
    ds_read_b64_tr_b16 a[168:169], v52 offset:18432
    ds_read_b64_tr_b16 a[170:171], v52 offset:19456
    v_mfma_f32_32x32x16_bf16 v[80:95], a[180:183], a[8:11], v[80:95]
    ds_read_b64_tr_b16 a[172:173], v53 offset:18432
    ds_read_b64_tr_b16 a[174:175], v53 offset:19456
    buffer_load_dwordx4 a[8:11], v10, s[32:35], s96 offen offset:2048 sc1
    s_waitcnt vmcnt(11) lgkmcnt(8)
    v_mfma_f32_32x32x16_bf16 v[64:79], a[184:187], a[12:15], v[64:79]
    ds_read_b64_tr_b16 a[176:177], v52 offset:20480
    ds_read_b64_tr_b16 a[178:179], v52 offset:21504
    v_mfma_f32_32x32x16_bf16 v[80:95], a[188:191], a[12:15], v[80:95]
    ds_read_b64_tr_b16 a[180:181], v53 offset:20480
    ds_read_b64_tr_b16 a[182:183], v53 offset:21504
    buffer_load_dwordx4 a[12:15], v10, s[32:35], s96 offen offset:3072 sc1
    s_add_u32 s96, s96, 4096
    s_cmp_eq_u32 s96, s98
    s_cselect_b32 s96, s97, s96
    s_waitcnt vmcnt(11) lgkmcnt(8)
    v_mfma_f32_32x32x16_bf16 v[64:79], a[160:163], a[16:19], v[64:79]
    ds_read_b64_tr_b16 a[184:185], v52 offset:22528
    ds_read_b64_tr_b16 a[186:187], v52 offset:23552
    v_mfma_f32_32x32x16_bf16 v[80:95], a[164:167], a[16:19], v[80:95]
    ds_read_b64_tr_b16 a[188:189], v53 offset:22528
    ds_read_b64_tr_b16 a[190:191], v53 offset:23552
    buffer_load_dwordx4 a[16:19], v10, s[32:35], s96 offen offset:0 sc1
    s_waitcnt vmcnt(11) lgkmcnt(8)
    v_mfma_f32_32x32x16_bf16 v[64:79], a[168:171], a[20:23], v[64:79]
    ds_read_b64_tr_b16 a[160:161], v52 offset:24576
    ds_read_b64_tr_b16 a[162:163], v52 offset:25600
    v_mfma_f32_32x32x16_bf16 v[80:95], a[172:175], a[20:23], v[80:95]
    ds_read_b64_tr_b16 a[164:165], v53 offset:24576
    ds_read_b64_tr_b16 a[166:167], v53 offset:25600
    buffer_load_dwordx4 a[20:23], v10, s[32:35], s96 offen offset:1024 sc1
    s_waitcnt vmcnt(11) lgkmcnt(8)
    v_mfma_f32_32x32x16_bf16 v[64:79], a[176:179], a[24:27], v[64:79]
    ds_read_b64_tr_b16 a[168:169], v52 offset:26624
    ds_read_b64_tr_b16 a[170:171], v52 offset:27648
    v_mfma_f32_32x32x16_bf16 v[80:95], a[180:183], a[24:27], v[80:95]
    ds_read_b64_tr_b16 a[172:173], v53 offset:26624
    ds_read_b64_tr_b16 a[174:175], v53 offset:27648
    buffer_load_dwordx4 a[24:27], v10, s[32:35], s96 offen offset:2048 sc1
    s_waitcnt vmcnt(11) lgkmcnt(8)
    v_mfma_f32_32x32x16_bf16 v[64:79], a[184:187], a[28:31], v[64:79]
    ds_read_b64_tr_b16 a[176:177], v52 offset:28672
    ds_read_b64_tr_b16 a[178:179], v52 offset:29696
    v_mfma_f32_32x32x16_bf16 v[80:95], a[188:191], a[28:31], v[80:95]
    ds_read_b64_tr_b16 a[180:181], v53 offset:28672
    ds_read_b64_tr_b16 a[182:183], v53 offset:29696
    buffer_load_dwordx4 a[28:31], v10, s[32:35], s96 offen offset:3072 sc1
    s_add_u32 s96, s96, 4096
    s_cmp_eq_u32 s96, s98
    s_cselect_b32 s96, s97, s96
    s_waitcnt vmcnt(11) lgkmcnt(8)
    v_mfma_f32_32x32x16_bf16 v[64:79], a[160:163], a[32:35], v[64:79]
    ds_read_b64_tr_b16 a[184:185], v52 offset:30720
    ds_read_b64_tr_b16 a[186:187], v52 offset:31744
    v_mfma_f32_32x32x16_bf16 v[80:95], a[164:167], a[32:35], v[80:95]
    ds_read_b64_tr_b16 a[188:189], v53 offset:30720
    ds_read_b64_tr_b16 a[190:191], v53 offset:31744
    buffer_load_dwordx4 a[32:35], v10, s[32:35], s96 offen offset:0 sc1
    s_barrier
    s_waitcnt vmcnt(11) lgkmcnt(8)
    v_mfma_f32_32x32x16_bf16 v[64:79], a[168:171], a[36:39], v[64:79]
    ds_read_b64_tr_b16 a[160:161], v52 offset:32768
    ds_read_b64_tr_b16 a[162:163], v52 offset:33792
    v_mfma_f32_32x32x16_bf16 v[80:95], a[172:175], a[36:39], v[80:95]
    ds_read_b64_tr_b16 a[164:165], v53 offset:32768
    ds_read_b64_tr_b16 a[166:167], v53 offset:33792
    buffer_load_dwordx4 a[36:39], v10, s[32:35], s96 offen offset:1024 sc1
    s_waitcnt vmcnt(11) lgkmcnt(8)
    v_mfma_f32_32x32x16_bf16 v[64:79], a[176:179], a[40:43], v[64:79]
    ds_read_b64_tr_b16 a[168:169], v52 offset:34816
    ds_read_b64_tr_b16 a[170:171], v52 offset:35840
    v_mfma_f32_32x32x16_bf16 v[80:95], a[180:183], a[40:43], v[80:95]
    ds_read_b64_tr_b16 a[172:173], v53 offset:34816
    ds_read_b64_tr_b16 a[174:175], v53 offset:35840
    buffer_load_dwordx4 a[40:43], v10, s[32:35], s96 offen offset:2048 sc1
    s_waitcnt vmcnt(11) lgkmcnt(8)
    v_mfma_f32_32x32x16_bf16 v[64:79], a[184:187], a[44:47], v[64:79]
    ds_read_b64_tr_b16 a[176:177], v52 offset:36864
    ds_read_b64_tr_b16 a[178:179], v52 offset:37888
    v_mfma_f32_32x32x16_bf16 v[80:95], a[188:191], a[44:47], v[80:95]
    ds_read_b64_tr_b16 a[180:181], v53 offset:36864
    ds_read_b64_tr_b16 a[182:183], v53 offset:37888
    buffer_load_dwordx4 a[44:47], v10, s[32:35], s96 offen offset:3072 sc1
    s_add_u32 s96, s96, 4096
    s_cmp_eq_u32 s96, s98
    s_cselect_b32 s96, s97, s96
    s_waitcnt vmcnt(11) lgkmcnt(8)
    v_mfma_f32_32x32x16_bf16 v[64:79], a[160:163], a[0:3], v[64:79]
    ds_read_b64_tr_b16 a[184:185], v52 offset:38912
    ds_read_b64_tr_b16 a[186:187], v52 offset:39936
    v_mfma_f32_32x32x16_bf16 v[80:95], a[164:167], a[0:3], v[80:95]
    ds_read_b64_tr_b16 a[188:189], v53 offset:38912
    ds_read_b64_tr_b16 a[190:191], v53 offset:39936
    s_waitcnt vmcnt(10) lgkmcnt(8)
    v_mfma_f32_32x32x16_bf16 v[64:79], a[168:171], a[4:7], v[64:79]
    ds_read_b64_tr_b16 a[160:161], v52 offset:40960
    ds_read_b64_tr_b16 a[162:163], v52 offset:41984
    v_mfma_f32_32x32x16_bf16 v[80:95], a[172:175], a[4:7], v[80:95]
    ds_read_b64_tr_b16 a[164:165], v53 offset:40960
    ds_read_b64_tr_b16 a[166:167], v53 offset:41984
    s_waitcnt vmcnt(9) lgkmcnt(8)
    v_mfma_f32_32x32x16_bf16 v[64:79], a[176:179], a[8:11], v[64:79]
    ds_read_b64_tr_b16 a[168:169], v52 offset:43008
    ds_read_b64_tr_b16 a[170:171], v52 offset:44032
    v_mfma_f32_32x32x16_bf16 v[80:95], a[180:183], a[8:11], v[80:95]
    ds_read_b64_tr_b16 a[172:173], v53 offset:43008
    ds_read_b64_tr_b16 a[174:175], v53 offset:44032
    s_waitcnt vmcnt(8) lgkmcnt(8)
    v_mfma_f32_32x32x16_bf16 v[64:79], a[184:187], a[12:15], v[64:79]
    ds_read_b64_tr_b16 a[176:177], v52 offset:45056
    ds_read_b64_tr_b16 a[178:179], v52 offset:46080
    v_mfma_f32_32x32x16_bf16 v[80:95], a[188:191], a[12:15], v[80:95]
    ds_read_b64_tr_b16 a[180:181], v53 offset:45056
    ds_read_b64_tr_b16 a[182:183], v53 offset:46080
    s_waitcnt vmcnt(7) lgkmcnt(8)
    v_mfma_f32_32x32x16_bf16 v[64:79], a[160:163], a[16:19], v[64:79]
    ds_read_b64_tr_b16 a[184:185], v52 offset:47104
    ds_read_b64_tr_b16 a[186:187], v52 offset:48128
    v_mfma_f32_32x32x16_bf16 v[80:95], a[164:167], a[16:19], v[80:95]
    ds_read_b64_tr_b16 a[188:189], v53 offset:47104
    ds_read_b64_tr_b16 a[190:191], v53 offset:48128
    s_barrier
    s_waitcnt vmcnt(6) lgkmcnt(8)
    v_mfma_f32_32x32x16_bf16 v[64:79], a[168:171], a[20:23], v[64:79]
    ds_read_b64_tr_b16 a[160:161], v52 offset:49152
    ds_read_b64_tr_b16 a[162:163], v52 offset:50176
    v_mfma_f32_32x32x16_bf16 v[80:95], a[172:175], a[20:23], v[80:95]
    ds_read_b64_tr_b16 a[164:165], v53 offset:49152
    ds_read_b64_tr_b16 a[166:167], v53 offset:50176
    s_waitcnt vmcnt(5) lgkmcnt(8)
    v_mfma_f32_32x32x16_bf16 v[64:79], a[176:179], a[24:27], v[64:79]
    ds_read_b64_tr_b16 a[168:169], v52 offset:51200
    ds_read_b64_tr_b16 a[170:171], v52 offset:52224
    v_mfma_f32_32x32x16_bf16 v[80:95], a[180:183], a[24:27], v[80:95]
    ds_read_b64_tr_b16 a[172:173], v53 offset:51200
    ds_read_b64_tr_b16 a[174:175], v53 offset:52224
    s_waitcnt vmcnt(4) lgkmcnt(8)
    v_mfma_f32_32x32x16_bf16 v[64:79], a[184:187], a[28:31], v[64:79]
    ds_read_b64_tr_b16 a[176:177], v52 offset:53248
    ds_read_b64_tr_b16 a[178:179], v52 offset:54272
    v_mfma_f32_32x32x16_bf16 v[80:95], a[188:191], a[28:31], v[80:95]
    ds_read_b64_tr_b16 a[180:181], v53 offset:53248
    ds_read_b64_tr_b16 a[182:183], v53 offset:54272
    s_waitcnt vmcnt(3) lgkmcnt(8)
    v_mfma_f32_32x32x16_bf16 v[64:79], a[160:163], a[32:35], v[64:79]
    ds_read_b64_tr_b16 a[184:185], v52 offset:55296
    ds_read_b64_tr_b16 a[186:187], v52 offset:56320
    v_mfma_f32_32x32x16_bf16 v[80:95], a[164:167], a[32:35], v[80:95]
    ds_read_b64_tr_b16 a[188:189], v53 offset:55296
    ds_read_b64_tr_b16 a[190:191], v53 offset:56320
    s_waitcnt vmcnt(2) lgkmcnt(8)
    v_mfma_f32_32x32x16_bf16 v[64:79], a[168:171], a[36:39], v[64:79]
    v_mfma_f32_32x32x16_bf16 v[80:95], a[172:175], a[36:39], v[80:95]
    s_waitcnt vmcnt(1) lgkmcnt(4)
    v_mfma_f32_32x32x16_bf16 v[64:79], a[176:179], a[40:43], v[64:79]
    v_mfma_f32_32x32x16_bf16 v[80:95], a[180:183], a[40:43], v[80:95]
    s_waitcnt vmcnt(0) lgkmcnt(0)
    v_mfma_f32_32x32x16_bf16 v[64:79], a[184:187], a[44:47], v[64:79]
    v_mfma_f32_32x32x16_bf16 v[80:95], a[188:191], a[44:47], v[80:95]
    s_nop 11
    v_cvt_pk_bf16_f32 v16, v64, v65
    v_cvt_pk_bf16_f32 v17, v66, v67
    v_cvt_pk_bf16_f32 v18, v68, v69
    v_cvt_pk_bf16_f32 v19, v70, v71
    s_nop 1
    v_permlane32_swap_b32 v16, v18
    v_permlane32_swap_b32 v17, v19
    buffer_store_dwordx4 v[16:19], v11, s[28:31], 0 offen offset:0
    v_cvt_pk_bf16_f32 v20, v72, v73
    v_cvt_pk_bf16_f32 v21, v74, v75
    v_cvt_pk_bf16_f32 v22, v76, v77
    v_cvt_pk_bf16_f32 v23, v78, v79
    s_nop 1
    v_permlane32_swap_b32 v20, v22
    v_permlane32_swap_b32 v21, v23
    buffer_store_dwordx4 v[20:23], v11, s[28:31], 0 offen offset:32
    v_cvt_pk_bf16_f32 v16, v80, v81
    v_cvt_pk_bf16_f32 v17, v82, v83
    v_cvt_pk_bf16_f32 v18, v84, v85
    v_cvt_pk_bf16_f32 v19, v86, v87
    s_nop 1
    v_permlane32_swap_b32 v16, v18
    v_permlane32_swap_b32 v17, v19
    buffer_store_dwordx4 v[16:19], v11, s[28:31], 0 offen offset:64
    v_cvt_pk_bf16_f32 v20, v88, v89
    v_cvt_pk_bf16_f32 v21, v90, v91
    v_cvt_pk_bf16_f32 v22, v92, v93
    v_cvt_pk_bf16_f32 v23, v94, v95
    s_nop 1
    v_permlane32_swap_b32 v20, v22
    v_permlane32_swap_b32 v21, v23
    buffer_store_dwordx4 v[20:23], v11, s[28:31], 0 offen offset:96
L_fin:
L_end:
    s_endpgm
.section .rodata,"a"
.p2align 6
.amdhsa_kernel sequential_preLN__linear_attn_block__glu_gated_reglu__prompt_kernel
  .amdhsa_next_free_vgpr 512
  .amdhsa_next_free_sgpr 102
  .amdhsa_accum_offset 256
  .amdhsa_group_segment_fixed_size 0
  .amdhsa_kernarg_size 80
  .amdhsa_user_sgpr_count 2
  .amdhsa_user_sgpr_kernarg_segment_ptr 1
  .amdhsa_system_sgpr_workgroup_id_x 1
.end_amdhsa_kernel
```
